```python
import torch

def _softmax(x, axis=-1):
    return torch.softmax(x, dim=axis)

def _gelu(x):
    return torch.nn.functional.gelu(x, approximate='tanh')

def _silu(x):
    return torch.nn.functional.silu(x)

def _sigmoid(x):
    return torch.sigmoid(x)

def _layernorm(x, axis=-1, eps=1e-05):
    m = x.mean(dim=axis, keepdim=True)
    v = x.var(dim=axis, keepdim=True, unbiased=False)
    return (x - m) / torch.sqrt(v + eps)

def _scatter_add(tgt, idx, src, axis=0):
    return tgt.clone().index_add_(axis, idx, src)

def _segment_sum(src, seg, n):
    out = torch.zeros((n,) + src.shape[1:], dtype=src.dtype)
    return out.index_add_(0, seg, src)

def _pad(x, pw):
    flat = tuple((v for pair in reversed(pw) for v in pair))
    return torch.nn.functional.pad(x, flat)
kernel_name = 'parallel_sum__softmax_full_mha__mixer_gmlp__prompt'

def setup_inputs():

    _w = lambda a: (lambda t: t.to(torch.bfloat16) if t.is_floating_point() else t)(torch.as_tensor(a))

    def _A_setup():
        B, S, D = (1, 2048, 512)
        return {'x': _w((lambda *s: torch.randn(*s, dtype=torch.bfloat16) * 0.05)(B, S, D)), 'wqkv': _w((lambda *s: torch.randn(*s, dtype=torch.bfloat16) * 0.2)(D, 3 * D)), 'wo': _w((lambda *s: torch.randn(*s, dtype=torch.bfloat16) * 0.2)(D, D))}
    _A_in = _A_setup()

    def _B_setup():
        B, S, D, F = (1, 2048, 512, 1792)
        Fh = F // 2
        return {'x': _w((lambda *s: torch.randn(*s, dtype=torch.bfloat16) * 0.05)(B, S, D)), 'w_in': _w((lambda *s: torch.randn(*s, dtype=torch.bfloat16) * 0.8)(D, 2 * Fh)), 'w_sp': _w(0.01 * (lambda *s: torch.randn(*s, dtype=torch.bfloat16) * 0.8)(S, S)), 'b_sp': _w(1.0 + 0.01 * (lambda *s: torch.randn(*s, dtype=torch.bfloat16) * 0.2)(S)), 'w_out': _w((lambda *s: torch.randn(*s, dtype=torch.bfloat16) * 0.2)(Fh, D))}
    _B_in = _B_setup()
    return {'A_x': _A_in['x'], 'A_wqkv': _A_in['wqkv'], 'A_wo': _A_in['wo'], 'B_x': _B_in['x'], 'B_w_in': _B_in['w_in'], 'B_w_sp': _B_in['w_sp'], 'B_b_sp': _B_in['b_sp'], 'B_w_out': _B_in['w_out']}

def reference(A_x, A_wqkv, A_wo, B_x, B_w_in, B_w_sp, B_b_sp, B_w_out):

    def _A_ref(x, wqkv, wo):
        B, S, D = x.shape
        H = 32
        Dh = D // H
        qkv = (lambda x, *d: x.permute(*d))((x @ wqkv).reshape(B, S, 3, H, Dh), 2, 0, 3, 1, 4)
        q, k, v = (qkv[0], qkv[1], qkv[2])
        scale = Dh ** (-0.5)
        scores = torch.einsum('bhqd,bhkd->bhqk', q, k) * scale
        p = _softmax(scores, axis=-1)
        o = torch.einsum('bhqk,bhkd->bhqd', p, v)
        return (lambda x, *d: x.permute(*d))(o, 0, 2, 1, 3).reshape(B, S, D) @ wo

    def _B_ref(x, w_in, w_sp, b_sp, w_out):
        B, S, D = x.shape
        F = w_in.shape[-1]
        Fh = F // 2
        z = _gelu(torch.einsum('bsd,df->bsf', x, w_in))
        z1 = z[..., :Fh].clone()
        z2 = _layernorm(z[..., Fh:], axis=-1)
        g = torch.einsum('ts,bsf->btf', w_sp, z2) + b_sp[None, :, None]
        return torch.einsum('bsf,fd->bsd', z1 * g, w_out)
    x = A_x
    xn = _layernorm(x, axis=-1)
    return x + _A_ref(xn, A_wqkv, A_wo) + _B_ref(xn, B_w_in, B_w_sp, B_b_sp, B_w_out)
```

```asm
; @launch kernel=k1_kernel grid=(256,1,1) block=(512,1,1) lds=163840
; @launch kernel=k2_kernel grid=(512,1,1) block=(256,1,1) lds=81920
.amdgcn_target "amdgcn-amd-amdhsa--gfx950"
.text
.globl k1_kernel
.p2align 8
.type k1_kernel,@function
k1_kernel:
  s_cmp_ge_u32 s2, 256
  s_cbranch_scc1 L_k1_end
  s_load_dwordx4 s[4:7], s[0:1], 0
  s_load_dwordx4 s[8:11], s[0:1], 32
  s_load_dwordx4 s[48:51], s[0:1], 72
  s_load_dwordx2 s[44:45], s[0:1], 16
  s_load_dwordx2 s[46:47], s[0:1], 56

  v_lshrrev_b32 v2, 6, v0
  v_and_b32 v1, 63, v0
  s_and_b32 s43, s2, 7
  v_readfirstlane_b32 s36, v2
  s_lshr_b32 s52, s2, 3
  s_and_b32 s61, s52, 3
  s_lshr_b32 s39, s43, 1
  s_lshl_b32 s39, s39, 2
  s_add_u32 s39, s39, s61
  s_and_b32 s40, s43, 1
  s_mul_i32 s40, s40, 1
  s_lshr_b32 s43, s52, 2
  s_add_u32 s40, s40, s43
  s_add_u32 s40, s40, s43
  s_and_b32 s37, s36, 3
  s_lshr_b32 s38, s36, 2
  v_lshlrev_b32 v19, 4, v1
  s_cmp_ge_u32 s52, 28
  s_cbranch_scc1 L_k1_helper
  s_lshl_b32 s86, s61, 1
  s_add_u32 s86, s86, s43
  s_and_b32 s86, s86, 7
  s_lshl_b32 s56, s39, 2
  s_add_u32 s56, s56, s37
  s_sub_u32 s41, s40, 2
  s_add_u32 s43, s40, 0
  s_cmp_lt_u32 s40, 5
  s_cselect_b32 s41, s43, s41
  s_sub_u32 s43, s40, 5
  s_cmp_lt_u32 s43, 2
  s_cselect_b32 s42, 0, 1
  s_mov_b32 s58, 0xffff0000
  s_cmp_eq_u32 s38, 0
  s_cbranch_scc1 L_k1_zw

  s_lshl_b32 s82, s86, 7
  s_lshl_b32 s80, s56, 15
  s_lshl_b32 s81, s37, 12
  s_lshl_b32 s55, s37, 11
  v_lshrrev_b32 v2, 3, v1
  v_and_b32 v3, 7, v1
  v_lshrrev_b32 v4, 4, v1
  v_xor_b32 v3, v3, v4
  v_lshlrev_b32 v3, 4, v3
  v_lshl_add_u32 v74, v2, 10, v3
  v_xor_b32 v75, 64, v74
  v_add_u32 v75, 8192, v75
  v_and_b32 v3, 15, v1
  v_lshlrev_b32 v2, 2, v4
  v_xor_b32 v3, v3, v2
  v_lshlrev_b32 v3, 4, v3
  s_movk_i32 s43, 3584
  v_mad_u32_u24 v5, v4, s43, v3
  s_movk_i32 s43, 3072
  v_mad_u32_u24 v6, v4, s43, v3
  s_mul_i32 s53, s37, 28672
  s_lshl_b32 s43, s40, 8
  s_add_u32 s53, s53, s43
  s_add_u32 s83, s53, 1835008
  s_mul_i32 s43, s86, 229376
  s_add_u32 s53, s53, s43
  s_mul_i32 s54, s37, 24576
  s_lshl_b32 s43, s41, 8
  s_add_u32 s54, s54, s43
  s_add_u32 s84, s54, 1572864
  s_mul_i32 s43, s86, 196608
  s_add_u32 s54, s54, s43
  s_waitcnt lgkmcnt(0)

  s_mov_b32 s12, s4
  s_and_b32 s13, s5, 0xffff
  s_mov_b32 s14, 0x200000
  s_mov_b32 s15, 0x20000
  s_mov_b32 s16, s8
  s_and_b32 s17, s9, 0xffff
  s_mov_b32 s18, 0x1c0000
  s_mov_b32 s19, 0x20000
  s_add_u32 s59, s80, s82
  s_add_u32 m0, s81, 0
  s_add_u32 s82, s82, 128
  buffer_load_dwordx4 v74, s[12:15], s59 offen lds
  s_add_u32 m0, s81, 1024
  s_and_b32 s82, s82, 1023
  buffer_load_dwordx4 v75, s[12:15], s59 offen lds
  s_add_u32 s59, s59, 16384
  s_add_u32 m0, s81, 2048
  s_nop 0
  buffer_load_dwordx4 v74, s[12:15], s59 offen lds
  s_add_u32 m0, s81, 3072
  s_nop 0
  buffer_load_dwordx4 v75, s[12:15], s59 offen lds
  s_add_u32 m0, s55, 65536
  s_add_u32 s88, s53, 14336
  buffer_load_dwordx4 v5, s[16:19], s53 offen lds
  s_add_u32 m0, s55, 66560
  s_add_u32 s87, s53, 114688
  buffer_load_dwordx4 v5, s[16:19], s88 offen lds
  s_sub_u32 s53, s87, 1835008
  s_cmp_lt_u32 s87, s83
  s_cselect_b32 s53, s87, s53
  s_add_u32 m0, s55, 73728
  s_add_u32 s88, s53, 14336
  buffer_load_dwordx4 v5, s[16:19], s53 offen lds
  s_add_u32 m0, s55, 74752
  s_add_u32 s87, s53, 114688
  buffer_load_dwordx4 v5, s[16:19], s88 offen lds
  s_sub_u32 s53, s87, 1835008
  s_cmp_lt_u32 s87, s83
  s_cselect_b32 s53, s87, s53
  s_mov_b32 s20, s6
  s_and_b32 s21, s7, 0xffff
  s_mov_b32 s22, 0x180000
  s_mov_b32 s23, 0x20000
  s_mov_b32 s24, s50
  s_and_b32 s25, s51, 0xffff
  s_mov_b32 s26, 0x1b00000
  s_mov_b32 s27, 0x20000
  v_lshrrev_b32 v2, 5, v1
  v_bfe_u32 v3, v1, 1, 3
  v_xor_b32 v3, v3, v2
  v_and_b32 v2, 31, v1
  s_lshl_b32 s43, s37, 12
  v_lshl_add_u32 v2, v2, 7, s43

  v_xor_b32 v4, 0, v3
  v_lshl_add_u32 v76, v4, 4, v2
  v_xor_b32 v4, 2, v3
  v_lshl_add_u32 v77, v4, 4, v2
  v_xor_b32 v4, 4, v3
  v_lshl_add_u32 v78, v4, 4, v2
  v_xor_b32 v4, 6, v3
  v_lshl_add_u32 v79, v4, 4, v2
  v_lshrrev_b32 v2, 5, v1
  v_bfe_u32 v3, v1, 2, 2
  v_lshl_add_u32 v2, v2, 3, v3
  v_lshlrev_b32 v2, 8, v2
  v_bfe_u32 v4, v1, 4, 1
  v_lshl_add_u32 v2, v4, 5, v2
  v_and_b32 v4, 3, v1
  v_lshl_add_u32 v2, v4, 3, v2

  v_xor_b32 v3, s37, v3
  v_xor_b32 v4, 0, v3
  v_lshl_add_u32 v7, v4, 6, v2
  v_add_u32 v11, 0x10000, v7
  v_add_u32 v15, 0x20000, v7
  v_xor_b32 v4, 1, v3
  v_lshl_add_u32 v8, v4, 6, v2
  v_add_u32 v12, 0x10000, v8
  v_add_u32 v16, 0x20000, v8
  v_xor_b32 v4, 2, v3
  v_lshl_add_u32 v9, v4, 6, v2
  v_add_u32 v13, 0x10000, v9
  v_add_u32 v17, 0x20000, v9
  v_xor_b32 v4, 3, v3
  v_lshl_add_u32 v10, v4, 6, v2
  v_add_u32 v14, 0x10000, v10
  v_add_u32 v18, 0x20000, v10
  v_bfe_u32 v2, v1, 4, 1
  v_lshlrev_b32 v2, 16, v2
  v_lshrrev_b32 v3, 5, v1
  v_lshl_add_u32 v2, v3, 8, v2
  v_and_b32 v3, 15, v1
  v_lshl_add_u32 v20, v3, 4, v2
  v_bfe_u32 v2, v1, 4, 1
  v_cmp_eq_u32 vcc, v2, v3
  v_mov_b32 v4, 0x3f803f80
  v_cndmask_b32 v22, 0, v4, vcc
  v_cndmask_b32 v23, 0, v4, vcc
  v_cndmask_b32 v24, 0, v4, vcc
  v_cndmask_b32 v25, 0, v4, vcc
  s_mov_b32 s4, 0x00030003
  s_mov_b32 s5, 0x00030003
  v_mov_b32 v21, 159744

  v_mov_b32 v26, 0
  v_mov_b32 v64, 0
  v_mov_b32 v27, 0
  v_mov_b32 v65, 0
  v_mov_b32 v28, 0
  v_mov_b32 v66, 0
  v_mov_b32 v29, 0
  v_mov_b32 v67, 0
  s_add_u32 s59, s80, s82
  s_add_u32 m0, s81, 16384
  s_add_u32 s82, s82, 128
  buffer_load_dwordx4 v74, s[12:15], s59 offen lds
  s_add_u32 m0, s81, 17408
  s_and_b32 s82, s82, 1023
  buffer_load_dwordx4 v75, s[12:15], s59 offen lds
  s_add_u32 s59, s59, 16384
  s_add_u32 m0, s81, 18432
  s_nop 0
  buffer_load_dwordx4 v74, s[12:15], s59 offen lds
  s_add_u32 m0, s81, 19456
  s_nop 0
  buffer_load_dwordx4 v75, s[12:15], s59 offen lds
  s_add_u32 m0, s55, 81920
  s_add_u32 s88, s53, 14336
  buffer_load_dwordx4 v5, s[16:19], s53 offen lds
  s_add_u32 m0, s55, 82944
  s_add_u32 s87, s53, 114688
  buffer_load_dwordx4 v5, s[16:19], s88 offen lds
  s_sub_u32 s53, s87, 1835008
  s_cmp_lt_u32 s87, s83
  s_cselect_b32 s53, s87, s53
  s_add_u32 m0, s55, 90112
  s_add_u32 s88, s53, 14336
  buffer_load_dwordx4 v5, s[16:19], s53 offen lds
  s_add_u32 m0, s55, 91136
  s_add_u32 s87, s53, 114688
  buffer_load_dwordx4 v5, s[16:19], s88 offen lds
  s_sub_u32 s53, s87, 1835008
  s_cmp_lt_u32 s87, s83
  s_cselect_b32 s53, s87, s53
  s_add_u32 s59, s80, s82
  s_add_u32 m0, s81, 32768
  s_add_u32 s82, s82, 128
  buffer_load_dwordx4 v74, s[12:15], s59 offen lds
  s_add_u32 m0, s81, 33792
  s_and_b32 s82, s82, 1023
  buffer_load_dwordx4 v75, s[12:15], s59 offen lds
  s_add_u32 s59, s59, 16384
  s_add_u32 m0, s81, 34816
  s_nop 0
  buffer_load_dwordx4 v74, s[12:15], s59 offen lds
  s_add_u32 m0, s81, 35840
  s_nop 0
  buffer_load_dwordx4 v75, s[12:15], s59 offen lds
  s_add_u32 m0, s55, 98304
  s_add_u32 s88, s53, 14336
  buffer_load_dwordx4 v5, s[16:19], s53 offen lds
  s_add_u32 m0, s55, 99328
  s_add_u32 s87, s53, 114688
  buffer_load_dwordx4 v5, s[16:19], s88 offen lds
  s_sub_u32 s53, s87, 1835008
  s_cmp_lt_u32 s87, s83
  s_cselect_b32 s53, s87, s53
  s_add_u32 m0, s55, 106496
  s_add_u32 s88, s53, 14336
  buffer_load_dwordx4 v5, s[16:19], s53 offen lds
  s_add_u32 m0, s55, 107520
  s_add_u32 s87, s53, 114688
  buffer_load_dwordx4 v5, s[16:19], s88 offen lds
  s_sub_u32 s53, s87, 1835008
  s_cmp_lt_u32 s87, s83
  s_cselect_b32 s53, s87, s53
  s_waitcnt vmcnt(16)
  s_barrier
  ds_read_b128 v[132:135], v77 offset:0
  ds_read_b128 v[140:143], v79 offset:0
  ds_read_b128 v[128:131], v76 offset:0
  ds_read_b128 v[136:139], v78 offset:0
  ds_read_b64_tr_b16 v[80:81], v11 offset:0
  ds_read_b64_tr_b16 v[82:83], v11 offset:1024
  ds_read_b64_tr_b16 v[84:85], v11 offset:4096
  ds_read_b64_tr_b16 v[86:87], v11 offset:5120
  ds_read_b64_tr_b16 v[88:89], v11 offset:8192
  ds_read_b64_tr_b16 v[90:91], v11 offset:9216
  ds_read_b64_tr_b16 v[92:93], v11 offset:12288
  ds_read_b64_tr_b16 v[94:95], v11 offset:13312
  s_add_u32 s59, s80, s82
  s_add_u32 m0, s81, 49152
  s_add_u32 s82, s82, 128
  buffer_load_dwordx4 v74, s[12:15], s59 offen lds
  s_add_u32 m0, s81, 50176
  s_and_b32 s82, s82, 1023
  buffer_load_dwordx4 v75, s[12:15], s59 offen lds
  s_waitcnt lgkmcnt(11)
  v_lshlrev_b32 v68, 16, v132
  v_and_b32 v69, s58, v132
  v_add_f32 v64, v64, v68
  v_add_f32 v65, v65, v69
  v_fmac_f32 v66, v68, v68
  v_fmac_f32 v67, v69, v69
  s_add_u32 s59, s59, 16384
  s_add_u32 m0, s81, 51200
  s_nop 0
  buffer_load_dwordx4 v74, s[12:15], s59 offen lds
  v_lshlrev_b32 v70, 16, v133
  v_and_b32 v71, s58, v133
  v_add_f32 v64, v64, v70
  v_add_f32 v65, v65, v71
  v_fmac_f32 v66, v70, v70
  v_fmac_f32 v67, v71, v71
  s_add_u32 m0, s81, 52224
  s_nop 0
  buffer_load_dwordx4 v75, s[12:15], s59 offen lds
  v_lshlrev_b32 v68, 16, v134
  v_and_b32 v69, s58, v134
  v_add_f32 v64, v64, v68
  v_add_f32 v65, v65, v69
  v_fmac_f32 v66, v68, v68
  v_fmac_f32 v67, v69, v69
  s_add_u32 m0, s55, 114688
  s_add_u32 s88, s53, 14336
  buffer_load_dwordx4 v5, s[16:19], s53 offen lds
  v_lshlrev_b32 v70, 16, v135
  v_and_b32 v71, s58, v135
  v_add_f32 v64, v64, v70
  v_add_f32 v65, v65, v71
  v_fmac_f32 v66, v70, v70
  v_fmac_f32 v67, v71, v71
  s_waitcnt lgkmcnt(0)
  v_lshlrev_b32 v68, 16, v140
  v_and_b32 v69, s58, v140
  v_add_f32 v64, v64, v68
  v_add_f32 v65, v65, v69
  v_fmac_f32 v66, v68, v68
  v_fmac_f32 v67, v69, v69
  v_mfma_f32_16x16x32_bf16 v[26:29], v[80:83], v[22:25], v[26:29]
  s_add_u32 m0, s55, 115712
  s_add_u32 s87, s53, 114688
  buffer_load_dwordx4 v5, s[16:19], s88 offen lds
  s_sub_u32 s53, s87, 1835008
  s_cmp_lt_u32 s87, s83
  s_cselect_b32 s53, s87, s53
  v_lshlrev_b32 v70, 16, v141
  v_and_b32 v71, s58, v141
  v_add_f32 v64, v64, v70
  v_add_f32 v65, v65, v71
  v_fmac_f32 v66, v70, v70
  v_fmac_f32 v67, v71, v71
  v_mfma_f32_16x16x32_bf16 v[26:29], v[84:87], v[22:25], v[26:29]
  s_add_u32 m0, s55, 122880
  s_add_u32 s88, s53, 14336
  buffer_load_dwordx4 v5, s[16:19], s53 offen lds
  v_lshlrev_b32 v68, 16, v142
  v_and_b32 v69, s58, v142
  v_add_f32 v64, v64, v68
  v_add_f32 v65, v65, v69
  v_fmac_f32 v66, v68, v68
  v_fmac_f32 v67, v69, v69
  v_mfma_f32_16x16x32_bf16 v[26:29], v[88:91], v[22:25], v[26:29]
  s_add_u32 m0, s55, 123904
  s_add_u32 s87, s53, 114688
  buffer_load_dwordx4 v5, s[16:19], s88 offen lds
  s_sub_u32 s53, s87, 1835008
  s_cmp_lt_u32 s87, s83
  s_cselect_b32 s53, s87, s53
  v_lshlrev_b32 v70, 16, v143
  v_and_b32 v71, s58, v143
  v_add_f32 v64, v64, v70
  v_add_f32 v65, v65, v71
  v_fmac_f32 v66, v70, v70
  v_fmac_f32 v67, v71, v71
  v_mfma_f32_16x16x32_bf16 v[26:29], v[92:95], v[22:25], v[26:29]
  s_waitcnt vmcnt(16)
  s_barrier
  ds_read_b128 v[148:151], v77 offset:16384
  ds_read_b128 v[156:159], v79 offset:16384
  ds_read_b128 v[144:147], v76 offset:16384
  ds_read_b128 v[152:155], v78 offset:16384
  ds_read_b64_tr_b16 v[80:81], v11 offset:16384
  ds_read_b64_tr_b16 v[82:83], v11 offset:17408
  ds_read_b64_tr_b16 v[84:85], v11 offset:20480
  ds_read_b64_tr_b16 v[86:87], v11 offset:21504
  ds_read_b64_tr_b16 v[88:89], v11 offset:24576
  ds_read_b64_tr_b16 v[90:91], v11 offset:25600
  ds_read_b64_tr_b16 v[92:93], v11 offset:28672
  ds_read_b64_tr_b16 v[94:95], v11 offset:29696
  s_add_u32 s59, s80, s82
  s_add_u32 m0, s81, 0
  s_add_u32 s82, s82, 128
  buffer_load_dwordx4 v74, s[12:15], s59 offen lds
  s_add_u32 m0, s81, 1024
  s_and_b32 s82, s82, 1023
  buffer_load_dwordx4 v75, s[12:15], s59 offen lds
  s_waitcnt lgkmcnt(11)
  v_lshlrev_b32 v68, 16, v148
  v_and_b32 v69, s58, v148
  v_add_f32 v64, v64, v68
  v_add_f32 v65, v65, v69
  v_fmac_f32 v66, v68, v68
  v_fmac_f32 v67, v69, v69
  s_add_u32 s59, s59, 16384
  s_add_u32 m0, s81, 2048
  s_nop 0
  buffer_load_dwordx4 v74, s[12:15], s59 offen lds
  v_lshlrev_b32 v70, 16, v149
  v_and_b32 v71, s58, v149
  v_add_f32 v64, v64, v70
  v_add_f32 v65, v65, v71
  v_fmac_f32 v66, v70, v70
  v_fmac_f32 v67, v71, v71
  s_add_u32 m0, s81, 3072
  s_nop 0
  buffer_load_dwordx4 v75, s[12:15], s59 offen lds
  v_lshlrev_b32 v68, 16, v150
  v_and_b32 v69, s58, v150
  v_add_f32 v64, v64, v68
  v_add_f32 v65, v65, v69
  v_fmac_f32 v66, v68, v68
  v_fmac_f32 v67, v69, v69
  s_add_u32 m0, s55, 65536
  s_add_u32 s88, s53, 14336
  buffer_load_dwordx4 v5, s[16:19], s53 offen lds
  v_lshlrev_b32 v70, 16, v151
  v_and_b32 v71, s58, v151
  v_add_f32 v64, v64, v70
  v_add_f32 v65, v65, v71
  v_fmac_f32 v66, v70, v70
  v_fmac_f32 v67, v71, v71
  s_waitcnt lgkmcnt(0)
  v_lshlrev_b32 v68, 16, v156
  v_and_b32 v69, s58, v156
  v_add_f32 v64, v64, v68
  v_add_f32 v65, v65, v69
  v_fmac_f32 v66, v68, v68
  v_fmac_f32 v67, v69, v69
  v_mfma_f32_16x16x32_bf16 v[26:29], v[80:83], v[22:25], v[26:29]
  s_add_u32 m0, s55, 66560
  s_add_u32 s87, s53, 114688
  buffer_load_dwordx4 v5, s[16:19], s88 offen lds
  s_sub_u32 s53, s87, 1835008
  s_cmp_lt_u32 s87, s83
  s_cselect_b32 s53, s87, s53
  v_lshlrev_b32 v70, 16, v157
  v_and_b32 v71, s58, v157
  v_add_f32 v64, v64, v70
  v_add_f32 v65, v65, v71
  v_fmac_f32 v66, v70, v70
  v_fmac_f32 v67, v71, v71
  v_mfma_f32_16x16x32_bf16 v[26:29], v[84:87], v[22:25], v[26:29]
  s_add_u32 m0, s55, 73728
  s_add_u32 s88, s53, 14336
  buffer_load_dwordx4 v5, s[16:19], s53 offen lds
  v_lshlrev_b32 v68, 16, v158
  v_and_b32 v69, s58, v158
  v_add_f32 v64, v64, v68
  v_add_f32 v65, v65, v69
  v_fmac_f32 v66, v68, v68
  v_fmac_f32 v67, v69, v69
  v_mfma_f32_16x16x32_bf16 v[26:29], v[88:91], v[22:25], v[26:29]
  s_add_u32 m0, s55, 74752
  s_add_u32 s87, s53, 114688
  buffer_load_dwordx4 v5, s[16:19], s88 offen lds
  s_sub_u32 s53, s87, 1835008
  s_cmp_lt_u32 s87, s83
  s_cselect_b32 s53, s87, s53
  v_lshlrev_b32 v70, 16, v159
  v_and_b32 v71, s58, v159
  v_add_f32 v64, v64, v70
  v_add_f32 v65, v65, v71
  v_fmac_f32 v66, v70, v70
  v_fmac_f32 v67, v71, v71
  v_mfma_f32_16x16x32_bf16 v[26:29], v[92:95], v[22:25], v[26:29]
  s_waitcnt vmcnt(16)
  s_barrier
  ds_read_b128 v[164:167], v77 offset:32768
  ds_read_b128 v[172:175], v79 offset:32768
  ds_read_b128 v[160:163], v76 offset:32768
  ds_read_b128 v[168:171], v78 offset:32768
  ds_read_b64_tr_b16 v[80:81], v11 offset:32768
  ds_read_b64_tr_b16 v[82:83], v11 offset:33792
  ds_read_b64_tr_b16 v[84:85], v11 offset:36864
  ds_read_b64_tr_b16 v[86:87], v11 offset:37888
  ds_read_b64_tr_b16 v[88:89], v11 offset:40960
  ds_read_b64_tr_b16 v[90:91], v11 offset:41984
  ds_read_b64_tr_b16 v[92:93], v11 offset:45056
  ds_read_b64_tr_b16 v[94:95], v11 offset:46080
  s_add_u32 s59, s80, s82
  s_add_u32 m0, s81, 16384
  s_add_u32 s82, s82, 128
  buffer_load_dwordx4 v74, s[12:15], s59 offen lds
  s_add_u32 m0, s81, 17408
  s_and_b32 s82, s82, 1023
  buffer_load_dwordx4 v75, s[12:15], s59 offen lds
  s_waitcnt lgkmcnt(11)
  v_lshlrev_b32 v68, 16, v164
  v_and_b32 v69, s58, v164
  v_add_f32 v64, v64, v68
  v_add_f32 v65, v65, v69
  v_fmac_f32 v66, v68, v68
  v_fmac_f32 v67, v69, v69
  s_add_u32 s59, s59, 16384
  s_add_u32 m0, s81, 18432
  s_nop 0
  buffer_load_dwordx4 v74, s[12:15], s59 offen lds
  v_lshlrev_b32 v70, 16, v165
  v_and_b32 v71, s58, v165
  v_add_f32 v64, v64, v70
  v_add_f32 v65, v65, v71
  v_fmac_f32 v66, v70, v70
  v_fmac_f32 v67, v71, v71
  s_add_u32 m0, s81, 19456
  s_nop 0
  buffer_load_dwordx4 v75, s[12:15], s59 offen lds
  v_lshlrev_b32 v68, 16, v166
  v_and_b32 v69, s58, v166
  v_add_f32 v64, v64, v68
  v_add_f32 v65, v65, v69
  v_fmac_f32 v66, v68, v68
  v_fmac_f32 v67, v69, v69
  s_add_u32 m0, s55, 81920
  s_add_u32 s88, s53, 14336
  buffer_load_dwordx4 v5, s[16:19], s53 offen lds
  v_lshlrev_b32 v70, 16, v167
  v_and_b32 v71, s58, v167
  v_add_f32 v64, v64, v70
  v_add_f32 v65, v65, v71
  v_fmac_f32 v66, v70, v70
  v_fmac_f32 v67, v71, v71
  s_waitcnt lgkmcnt(0)
  v_lshlrev_b32 v68, 16, v172
  v_and_b32 v69, s58, v172
  v_add_f32 v64, v64, v68
  v_add_f32 v65, v65, v69
  v_fmac_f32 v66, v68, v68
  v_fmac_f32 v67, v69, v69
  v_mfma_f32_16x16x32_bf16 v[26:29], v[80:83], v[22:25], v[26:29]
  s_add_u32 m0, s55, 82944
  s_add_u32 s87, s53, 114688
  buffer_load_dwordx4 v5, s[16:19], s88 offen lds
  s_sub_u32 s53, s87, 1835008
  s_cmp_lt_u32 s87, s83
  s_cselect_b32 s53, s87, s53
  v_lshlrev_b32 v70, 16, v173
  v_and_b32 v71, s58, v173
  v_add_f32 v64, v64, v70
  v_add_f32 v65, v65, v71
  v_fmac_f32 v66, v70, v70
  v_fmac_f32 v67, v71, v71
  v_mfma_f32_16x16x32_bf16 v[26:29], v[84:87], v[22:25], v[26:29]
  s_add_u32 m0, s55, 90112
  s_add_u32 s88, s53, 14336
  buffer_load_dwordx4 v5, s[16:19], s53 offen lds
  v_lshlrev_b32 v68, 16, v174
  v_and_b32 v69, s58, v174
  v_add_f32 v64, v64, v68
  v_add_f32 v65, v65, v69
  v_fmac_f32 v66, v68, v68
  v_fmac_f32 v67, v69, v69
  v_mfma_f32_16x16x32_bf16 v[26:29], v[88:91], v[22:25], v[26:29]
  s_add_u32 m0, s55, 91136
  s_add_u32 s87, s53, 114688
  buffer_load_dwordx4 v5, s[16:19], s88 offen lds
  s_sub_u32 s53, s87, 1835008
  s_cmp_lt_u32 s87, s83
  s_cselect_b32 s53, s87, s53
  v_lshlrev_b32 v70, 16, v175
  v_and_b32 v71, s58, v175
  v_add_f32 v64, v64, v70
  v_add_f32 v65, v65, v71
  v_fmac_f32 v66, v70, v70
  v_fmac_f32 v67, v71, v71
  v_mfma_f32_16x16x32_bf16 v[26:29], v[92:95], v[22:25], v[26:29]
  s_waitcnt vmcnt(16)
  s_barrier
  ds_read_b128 v[180:183], v77 offset:49152
  ds_read_b128 v[188:191], v79 offset:49152
  ds_read_b128 v[176:179], v76 offset:49152
  ds_read_b128 v[184:187], v78 offset:49152
  ds_read_b64_tr_b16 v[80:81], v11 offset:49152
  ds_read_b64_tr_b16 v[82:83], v11 offset:50176
  ds_read_b64_tr_b16 v[84:85], v11 offset:53248
  ds_read_b64_tr_b16 v[86:87], v11 offset:54272
  ds_read_b64_tr_b16 v[88:89], v11 offset:57344
  ds_read_b64_tr_b16 v[90:91], v11 offset:58368
  ds_read_b64_tr_b16 v[92:93], v11 offset:61440
  ds_read_b64_tr_b16 v[94:95], v11 offset:62464
  s_add_u32 s59, s80, s82
  s_add_u32 m0, s81, 32768
  s_add_u32 s82, s82, 128
  buffer_load_dwordx4 v74, s[12:15], s59 offen lds
  s_add_u32 m0, s81, 33792
  s_and_b32 s82, s82, 1023
  buffer_load_dwordx4 v75, s[12:15], s59 offen lds
  s_waitcnt lgkmcnt(11)
  v_lshlrev_b32 v68, 16, v180
  v_and_b32 v69, s58, v180
  v_add_f32 v64, v64, v68
  v_add_f32 v65, v65, v69
  v_fmac_f32 v66, v68, v68
  v_fmac_f32 v67, v69, v69
  s_add_u32 s59, s59, 16384
  s_add_u32 m0, s81, 34816
  s_nop 0
  buffer_load_dwordx4 v74, s[12:15], s59 offen lds
  v_lshlrev_b32 v70, 16, v181
  v_and_b32 v71, s58, v181
  v_add_f32 v64, v64, v70
  v_add_f32 v65, v65, v71
  v_fmac_f32 v66, v70, v70
  v_fmac_f32 v67, v71, v71
  s_add_u32 m0, s81, 35840
  s_nop 0
  buffer_load_dwordx4 v75, s[12:15], s59 offen lds
  v_lshlrev_b32 v68, 16, v182
  v_and_b32 v69, s58, v182
  v_add_f32 v64, v64, v68
  v_add_f32 v65, v65, v69
  v_fmac_f32 v66, v68, v68
  v_fmac_f32 v67, v69, v69
  s_add_u32 m0, s55, 98304
  s_add_u32 s88, s53, 14336
  buffer_load_dwordx4 v5, s[16:19], s53 offen lds
  v_lshlrev_b32 v70, 16, v183
  v_and_b32 v71, s58, v183
  v_add_f32 v64, v64, v70
  v_add_f32 v65, v65, v71
  v_fmac_f32 v66, v70, v70
  v_fmac_f32 v67, v71, v71
  s_waitcnt lgkmcnt(0)
  v_lshlrev_b32 v68, 16, v188
  v_and_b32 v69, s58, v188
  v_add_f32 v64, v64, v68
  v_add_f32 v65, v65, v69
  v_fmac_f32 v66, v68, v68
  v_fmac_f32 v67, v69, v69
  v_mfma_f32_16x16x32_bf16 v[26:29], v[80:83], v[22:25], v[26:29]
  s_add_u32 m0, s55, 99328
  s_add_u32 s87, s53, 114688
  buffer_load_dwordx4 v5, s[16:19], s88 offen lds
  s_sub_u32 s53, s87, 1835008
  s_cmp_lt_u32 s87, s83
  s_cselect_b32 s53, s87, s53
  v_lshlrev_b32 v70, 16, v189
  v_and_b32 v71, s58, v189
  v_add_f32 v64, v64, v70
  v_add_f32 v65, v65, v71
  v_fmac_f32 v66, v70, v70
  v_fmac_f32 v67, v71, v71
  v_mfma_f32_16x16x32_bf16 v[26:29], v[84:87], v[22:25], v[26:29]
  s_add_u32 m0, s55, 106496
  s_add_u32 s88, s53, 14336
  buffer_load_dwordx4 v5, s[16:19], s53 offen lds
  v_lshlrev_b32 v68, 16, v190
  v_and_b32 v69, s58, v190
  v_add_f32 v64, v64, v68
  v_add_f32 v65, v65, v69
  v_fmac_f32 v66, v68, v68
  v_fmac_f32 v67, v69, v69
  v_mfma_f32_16x16x32_bf16 v[26:29], v[88:91], v[22:25], v[26:29]
  s_add_u32 m0, s55, 107520
  s_add_u32 s87, s53, 114688
  buffer_load_dwordx4 v5, s[16:19], s88 offen lds
  s_sub_u32 s53, s87, 1835008
  s_cmp_lt_u32 s87, s83
  s_cselect_b32 s53, s87, s53
  v_lshlrev_b32 v70, 16, v191
  v_and_b32 v71, s58, v191
  v_add_f32 v64, v64, v70
  v_add_f32 v65, v65, v71
  v_fmac_f32 v66, v70, v70
  v_fmac_f32 v67, v71, v71
  v_mfma_f32_16x16x32_bf16 v[26:29], v[92:95], v[22:25], v[26:29]
  s_waitcnt vmcnt(16)
  s_barrier
  ds_read_b128 v[196:199], v77 offset:0
  ds_read_b128 v[204:207], v79 offset:0
  ds_read_b128 v[192:195], v76 offset:0
  ds_read_b128 v[200:203], v78 offset:0
  ds_read_b64_tr_b16 v[80:81], v11 offset:0
  ds_read_b64_tr_b16 v[82:83], v11 offset:1024
  ds_read_b64_tr_b16 v[84:85], v11 offset:4096
  ds_read_b64_tr_b16 v[86:87], v11 offset:5120
  ds_read_b64_tr_b16 v[88:89], v11 offset:8192
  ds_read_b64_tr_b16 v[90:91], v11 offset:9216
  ds_read_b64_tr_b16 v[92:93], v11 offset:12288
  ds_read_b64_tr_b16 v[94:95], v11 offset:13312
  s_add_u32 s59, s80, s82
  s_add_u32 m0, s81, 49152
  s_add_u32 s82, s82, 128
  buffer_load_dwordx4 v74, s[12:15], s59 offen lds
  s_add_u32 m0, s81, 50176
  s_and_b32 s82, s82, 1023
  buffer_load_dwordx4 v75, s[12:15], s59 offen lds
  s_waitcnt lgkmcnt(11)
  v_lshlrev_b32 v68, 16, v196
  v_and_b32 v69, s58, v196
  v_add_f32 v64, v64, v68
  v_add_f32 v65, v65, v69
  v_fmac_f32 v66, v68, v68
  v_fmac_f32 v67, v69, v69
  s_add_u32 s59, s59, 16384
  s_add_u32 m0, s81, 51200
  s_nop 0
  buffer_load_dwordx4 v74, s[12:15], s59 offen lds
  v_lshlrev_b32 v70, 16, v197
  v_and_b32 v71, s58, v197
  v_add_f32 v64, v64, v70
  v_add_f32 v65, v65, v71
  v_fmac_f32 v66, v70, v70
  v_fmac_f32 v67, v71, v71
  s_add_u32 m0, s81, 52224
  s_nop 0
  buffer_load_dwordx4 v75, s[12:15], s59 offen lds
  v_lshlrev_b32 v68, 16, v198
  v_and_b32 v69, s58, v198
  v_add_f32 v64, v64, v68
  v_add_f32 v65, v65, v69
  v_fmac_f32 v66, v68, v68
  v_fmac_f32 v67, v69, v69
  s_add_u32 m0, s55, 114688
  s_add_u32 s88, s53, 14336
  buffer_load_dwordx4 v5, s[16:19], s53 offen lds
  v_lshlrev_b32 v70, 16, v199
  v_and_b32 v71, s58, v199
  v_add_f32 v64, v64, v70
  v_add_f32 v65, v65, v71
  v_fmac_f32 v66, v70, v70
  v_fmac_f32 v67, v71, v71
  s_waitcnt lgkmcnt(0)
  v_lshlrev_b32 v68, 16, v204
  v_and_b32 v69, s58, v204
  v_add_f32 v64, v64, v68
  v_add_f32 v65, v65, v69
  v_fmac_f32 v66, v68, v68
  v_fmac_f32 v67, v69, v69
  v_mfma_f32_16x16x32_bf16 v[26:29], v[80:83], v[22:25], v[26:29]
  s_add_u32 m0, s55, 115712
  s_add_u32 s87, s53, 114688
  buffer_load_dwordx4 v5, s[16:19], s88 offen lds
  s_sub_u32 s53, s87, 1835008
  s_cmp_lt_u32 s87, s83
  s_cselect_b32 s53, s87, s53
  v_lshlrev_b32 v70, 16, v205
  v_and_b32 v71, s58, v205
  v_add_f32 v64, v64, v70
  v_add_f32 v65, v65, v71
  v_fmac_f32 v66, v70, v70
  v_fmac_f32 v67, v71, v71
  v_mfma_f32_16x16x32_bf16 v[26:29], v[84:87], v[22:25], v[26:29]
  s_add_u32 m0, s55, 122880
  s_add_u32 s88, s53, 14336
  buffer_load_dwordx4 v5, s[16:19], s53 offen lds
  v_lshlrev_b32 v68, 16, v206
  v_and_b32 v69, s58, v206
  v_add_f32 v64, v64, v68
  v_add_f32 v65, v65, v69
  v_fmac_f32 v66, v68, v68
  v_fmac_f32 v67, v69, v69
  v_mfma_f32_16x16x32_bf16 v[26:29], v[88:91], v[22:25], v[26:29]
  s_add_u32 m0, s55, 123904
  s_add_u32 s87, s53, 114688
  buffer_load_dwordx4 v5, s[16:19], s88 offen lds
  s_sub_u32 s53, s87, 1835008
  s_cmp_lt_u32 s87, s83
  s_cselect_b32 s53, s87, s53
  v_lshlrev_b32 v70, 16, v207
  v_and_b32 v71, s58, v207
  v_add_f32 v64, v64, v70
  v_add_f32 v65, v65, v71
  v_fmac_f32 v66, v70, v70
  v_fmac_f32 v67, v71, v71
  v_mfma_f32_16x16x32_bf16 v[26:29], v[92:95], v[22:25], v[26:29]
  s_waitcnt vmcnt(16)
  s_barrier
  ds_read_b128 v[212:215], v77 offset:16384
  ds_read_b128 v[220:223], v79 offset:16384
  ds_read_b128 v[208:211], v76 offset:16384
  ds_read_b128 v[216:219], v78 offset:16384
  ds_read_b64_tr_b16 v[80:81], v11 offset:16384
  ds_read_b64_tr_b16 v[82:83], v11 offset:17408
  ds_read_b64_tr_b16 v[84:85], v11 offset:20480
  ds_read_b64_tr_b16 v[86:87], v11 offset:21504
  ds_read_b64_tr_b16 v[88:89], v11 offset:24576
  ds_read_b64_tr_b16 v[90:91], v11 offset:25600
  ds_read_b64_tr_b16 v[92:93], v11 offset:28672
  ds_read_b64_tr_b16 v[94:95], v11 offset:29696
  s_cmp_eq_u32 s42, 0
  s_cbranch_scc1 L_k1_nq_1
  s_add_u32 m0, s55, 65536
  s_add_u32 s88, s54, 12288
  buffer_load_dwordx4 v6, s[20:23], s54 offen lds
L_k1_nq_1:
  s_cmp_eq_u32 s42, 0
  s_cbranch_scc1 L_k1_nq_2
  s_add_u32 m0, s55, 66560
  s_add_u32 s87, s54, 98304
  buffer_load_dwordx4 v6, s[20:23], s88 offen lds
  s_sub_u32 s54, s87, 1572864
  s_cmp_lt_u32 s87, s84
  s_cselect_b32 s54, s87, s54
L_k1_nq_2:
  s_waitcnt lgkmcnt(11)
  v_lshlrev_b32 v68, 16, v212
  v_and_b32 v69, s58, v212
  v_add_f32 v64, v64, v68
  v_add_f32 v65, v65, v69
  v_fmac_f32 v66, v68, v68
  v_fmac_f32 v67, v69, v69
  s_cmp_eq_u32 s42, 0
  s_cbranch_scc1 L_k1_nq_3
  s_add_u32 m0, s55, 73728
  s_add_u32 s88, s54, 12288
  buffer_load_dwordx4 v6, s[20:23], s54 offen lds
L_k1_nq_3:
  v_lshlrev_b32 v70, 16, v213
  v_and_b32 v71, s58, v213
  v_add_f32 v64, v64, v70
  v_add_f32 v65, v65, v71
  v_fmac_f32 v66, v70, v70
  v_fmac_f32 v67, v71, v71
  s_cmp_eq_u32 s42, 0
  s_cbranch_scc1 L_k1_nq_4
  s_add_u32 m0, s55, 74752
  s_add_u32 s87, s54, 98304
  buffer_load_dwordx4 v6, s[20:23], s88 offen lds
  s_sub_u32 s54, s87, 1572864
  s_cmp_lt_u32 s87, s84
  s_cselect_b32 s54, s87, s54
L_k1_nq_4:
  v_lshlrev_b32 v68, 16, v214
  v_and_b32 v69, s58, v214
  v_add_f32 v64, v64, v68
  v_add_f32 v65, v65, v69
  v_fmac_f32 v66, v68, v68
  v_fmac_f32 v67, v69, v69
  s_cmp_eq_u32 s42, 0
  s_cbranch_scc1 L_k1_nq_5
  s_add_u32 m0, s55, 131072
  s_add_u32 s88, s54, 12288
  buffer_load_dwordx4 v6, s[20:23], s54 offen lds
L_k1_nq_5:
  v_lshlrev_b32 v70, 16, v215
  v_and_b32 v71, s58, v215
  v_add_f32 v64, v64, v70
  v_add_f32 v65, v65, v71
  v_fmac_f32 v66, v70, v70
  v_fmac_f32 v67, v71, v71
  s_waitcnt lgkmcnt(0)
  v_lshlrev_b32 v68, 16, v220
  v_and_b32 v69, s58, v220
  v_add_f32 v64, v64, v68
  v_add_f32 v65, v65, v69
  v_fmac_f32 v66, v68, v68
  v_fmac_f32 v67, v69, v69
  v_mfma_f32_16x16x32_bf16 v[26:29], v[80:83], v[22:25], v[26:29]
  s_cmp_eq_u32 s42, 0
  s_cbranch_scc1 L_k1_nq_6
  s_add_u32 m0, s55, 132096
  s_add_u32 s87, s54, 98304
  buffer_load_dwordx4 v6, s[20:23], s88 offen lds
  s_sub_u32 s54, s87, 1572864
  s_cmp_lt_u32 s87, s84
  s_cselect_b32 s54, s87, s54
L_k1_nq_6:
  v_lshlrev_b32 v70, 16, v221
  v_and_b32 v71, s58, v221
  v_add_f32 v64, v64, v70
  v_add_f32 v65, v65, v71
  v_fmac_f32 v66, v70, v70
  v_fmac_f32 v67, v71, v71
  v_mfma_f32_16x16x32_bf16 v[26:29], v[84:87], v[22:25], v[26:29]
  s_cmp_eq_u32 s42, 0
  s_cbranch_scc1 L_k1_nq_7
  s_add_u32 m0, s55, 139264
  s_add_u32 s88, s54, 12288
  buffer_load_dwordx4 v6, s[20:23], s54 offen lds
L_k1_nq_7:
  v_lshlrev_b32 v68, 16, v222
  v_and_b32 v69, s58, v222
  v_add_f32 v64, v64, v68
  v_add_f32 v65, v65, v69
  v_fmac_f32 v66, v68, v68
  v_fmac_f32 v67, v69, v69
  v_mfma_f32_16x16x32_bf16 v[26:29], v[88:91], v[22:25], v[26:29]
  s_cmp_eq_u32 s42, 0
  s_cbranch_scc1 L_k1_nq_8
  s_add_u32 m0, s55, 140288
  s_add_u32 s87, s54, 98304
  buffer_load_dwordx4 v6, s[20:23], s88 offen lds
  s_sub_u32 s54, s87, 1572864
  s_cmp_lt_u32 s87, s84
  s_cselect_b32 s54, s87, s54
L_k1_nq_8:
  v_lshlrev_b32 v70, 16, v223
  v_and_b32 v71, s58, v223
  v_add_f32 v64, v64, v70
  v_add_f32 v65, v65, v71
  v_fmac_f32 v66, v70, v70
  v_fmac_f32 v67, v71, v71
  v_mfma_f32_16x16x32_bf16 v[26:29], v[92:95], v[22:25], v[26:29]
  s_cmp_lg_u32 s42, 0
  s_cbranch_scc1 L_k1_nq_9
  s_waitcnt vmcnt(8)
L_k1_nq_9:
  s_waitcnt vmcnt(16)
  s_barrier
  ds_read_b128 v[228:231], v77 offset:32768
  ds_read_b128 v[236:239], v79 offset:32768
  ds_read_b128 v[224:227], v76 offset:32768
  ds_read_b128 v[232:235], v78 offset:32768
  ds_read_b64_tr_b16 v[80:81], v11 offset:32768
  ds_read_b64_tr_b16 v[82:83], v11 offset:33792
  ds_read_b64_tr_b16 v[84:85], v11 offset:36864
  ds_read_b64_tr_b16 v[86:87], v11 offset:37888
  ds_read_b64_tr_b16 v[88:89], v11 offset:40960
  ds_read_b64_tr_b16 v[90:91], v11 offset:41984
  ds_read_b64_tr_b16 v[92:93], v11 offset:45056
  ds_read_b64_tr_b16 v[94:95], v11 offset:46080
  s_cmp_eq_u32 s42, 0
  s_cbranch_scc1 L_k1_nq_10
  s_add_u32 m0, s55, 81920
  s_add_u32 s88, s54, 12288
  buffer_load_dwordx4 v6, s[20:23], s54 offen lds
L_k1_nq_10:
  s_cmp_eq_u32 s42, 0
  s_cbranch_scc1 L_k1_nq_11
  s_add_u32 m0, s55, 82944
  s_add_u32 s87, s54, 98304
  buffer_load_dwordx4 v6, s[20:23], s88 offen lds
  s_sub_u32 s54, s87, 1572864
  s_cmp_lt_u32 s87, s84
  s_cselect_b32 s54, s87, s54
L_k1_nq_11:
  s_waitcnt lgkmcnt(11)
  v_lshlrev_b32 v68, 16, v228
  v_and_b32 v69, s58, v228
  v_add_f32 v64, v64, v68
  v_add_f32 v65, v65, v69
  v_fmac_f32 v66, v68, v68
  v_fmac_f32 v67, v69, v69
  s_cmp_eq_u32 s42, 0
  s_cbranch_scc1 L_k1_nq_12
  s_add_u32 m0, s55, 90112
  s_add_u32 s88, s54, 12288
  buffer_load_dwordx4 v6, s[20:23], s54 offen lds
L_k1_nq_12:
  v_lshlrev_b32 v70, 16, v229
  v_and_b32 v71, s58, v229
  v_add_f32 v64, v64, v70
  v_add_f32 v65, v65, v71
  v_fmac_f32 v66, v70, v70
  v_fmac_f32 v67, v71, v71
  s_cmp_eq_u32 s42, 0
  s_cbranch_scc1 L_k1_nq_13
  s_add_u32 m0, s55, 91136
  s_add_u32 s87, s54, 98304
  buffer_load_dwordx4 v6, s[20:23], s88 offen lds
  s_sub_u32 s54, s87, 1572864
  s_cmp_lt_u32 s87, s84
  s_cselect_b32 s54, s87, s54
L_k1_nq_13:
  v_lshlrev_b32 v68, 16, v230
  v_and_b32 v69, s58, v230
  v_add_f32 v64, v64, v68
  v_add_f32 v65, v65, v69
  v_fmac_f32 v66, v68, v68
  v_fmac_f32 v67, v69, v69
  s_cmp_eq_u32 s42, 0
  s_cbranch_scc1 L_k1_nq_14
  s_add_u32 m0, s55, 147456
  s_add_u32 s88, s54, 12288
  buffer_load_dwordx4 v6, s[20:23], s54 offen lds
L_k1_nq_14:
  v_lshlrev_b32 v70, 16, v231
  v_and_b32 v71, s58, v231
  v_add_f32 v64, v64, v70
  v_add_f32 v65, v65, v71
  v_fmac_f32 v66, v70, v70
  v_fmac_f32 v67, v71, v71
  s_waitcnt lgkmcnt(0)
  v_lshlrev_b32 v68, 16, v236
  v_and_b32 v69, s58, v236
  v_add_f32 v64, v64, v68
  v_add_f32 v65, v65, v69
  v_fmac_f32 v66, v68, v68
  v_fmac_f32 v67, v69, v69
  v_mfma_f32_16x16x32_bf16 v[26:29], v[80:83], v[22:25], v[26:29]
  s_cmp_eq_u32 s42, 0
  s_cbranch_scc1 L_k1_nq_15
  s_add_u32 m0, s55, 148480
  s_add_u32 s87, s54, 98304
  buffer_load_dwordx4 v6, s[20:23], s88 offen lds
  s_sub_u32 s54, s87, 1572864
  s_cmp_lt_u32 s87, s84
  s_cselect_b32 s54, s87, s54
L_k1_nq_15:
  v_lshlrev_b32 v70, 16, v237
  v_and_b32 v71, s58, v237
  v_add_f32 v64, v64, v70
  v_add_f32 v65, v65, v71
  v_fmac_f32 v66, v70, v70
  v_fmac_f32 v67, v71, v71
  v_mfma_f32_16x16x32_bf16 v[26:29], v[84:87], v[22:25], v[26:29]
  s_cmp_eq_u32 s42, 0
  s_cbranch_scc1 L_k1_nq_16
  s_add_u32 m0, s55, 0
  s_add_u32 s88, s54, 12288
  buffer_load_dwordx4 v6, s[20:23], s54 offen lds
L_k1_nq_16:
  v_lshlrev_b32 v68, 16, v238
  v_and_b32 v69, s58, v238
  v_add_f32 v64, v64, v68
  v_add_f32 v65, v65, v69
  v_fmac_f32 v66, v68, v68
  v_fmac_f32 v67, v69, v69
  v_mfma_f32_16x16x32_bf16 v[26:29], v[88:91], v[22:25], v[26:29]
  s_cmp_eq_u32 s42, 0
  s_cbranch_scc1 L_k1_nq_17
  s_add_u32 m0, s55, 1024
  s_add_u32 s87, s54, 98304
  buffer_load_dwordx4 v6, s[20:23], s88 offen lds
  s_sub_u32 s54, s87, 1572864
  s_cmp_lt_u32 s87, s84
  s_cselect_b32 s54, s87, s54
L_k1_nq_17:
  v_lshlrev_b32 v70, 16, v239
  v_and_b32 v71, s58, v239
  v_add_f32 v64, v64, v70
  v_add_f32 v65, v65, v71
  v_fmac_f32 v66, v70, v70
  v_fmac_f32 v67, v71, v71
  v_mfma_f32_16x16x32_bf16 v[26:29], v[92:95], v[22:25], v[26:29]
  s_cmp_lg_u32 s42, 0
  s_cbranch_scc1 L_k1_nq_18
  s_waitcnt vmcnt(0)
L_k1_nq_18:
  s_waitcnt vmcnt(16)
  s_barrier
  ds_read_b128 v[244:247], v77 offset:49152
  ds_read_b128 v[252:255], v79 offset:49152
  ds_read_b128 v[240:243], v76 offset:49152
  ds_read_b128 v[248:251], v78 offset:49152
  ds_read_b64_tr_b16 v[80:81], v11 offset:49152
  ds_read_b64_tr_b16 v[82:83], v11 offset:50176
  ds_read_b64_tr_b16 v[84:85], v11 offset:53248
  ds_read_b64_tr_b16 v[86:87], v11 offset:54272
  ds_read_b64_tr_b16 v[88:89], v11 offset:57344
  ds_read_b64_tr_b16 v[90:91], v11 offset:58368
  ds_read_b64_tr_b16 v[92:93], v11 offset:61440
  ds_read_b64_tr_b16 v[94:95], v11 offset:62464
  s_cmp_eq_u32 s42, 0
  s_cbranch_scc1 L_k1_nq_19
  s_add_u32 m0, s55, 98304
  s_add_u32 s88, s54, 12288
  buffer_load_dwordx4 v6, s[20:23], s54 offen lds
L_k1_nq_19:
  s_cmp_eq_u32 s42, 0
  s_cbranch_scc1 L_k1_nq_20
  s_add_u32 m0, s55, 99328
  s_add_u32 s87, s54, 98304
  buffer_load_dwordx4 v6, s[20:23], s88 offen lds
  s_sub_u32 s54, s87, 1572864
  s_cmp_lt_u32 s87, s84
  s_cselect_b32 s54, s87, s54
L_k1_nq_20:
  s_waitcnt lgkmcnt(11)
  v_lshlrev_b32 v68, 16, v244
  v_and_b32 v69, s58, v244
  v_add_f32 v64, v64, v68
  v_add_f32 v65, v65, v69
  v_fmac_f32 v66, v68, v68
  v_fmac_f32 v67, v69, v69
  s_cmp_eq_u32 s42, 0
  s_cbranch_scc1 L_k1_nq_21
  s_add_u32 m0, s55, 106496
  s_add_u32 s88, s54, 12288
  buffer_load_dwordx4 v6, s[20:23], s54 offen lds
L_k1_nq_21:
  v_lshlrev_b32 v70, 16, v245
  v_and_b32 v71, s58, v245
  v_add_f32 v64, v64, v70
  v_add_f32 v65, v65, v71
  v_fmac_f32 v66, v70, v70
  v_fmac_f32 v67, v71, v71
  s_cmp_eq_u32 s42, 0
  s_cbranch_scc1 L_k1_nq_22
  s_add_u32 m0, s55, 107520
  s_add_u32 s87, s54, 98304
  buffer_load_dwordx4 v6, s[20:23], s88 offen lds
  s_sub_u32 s54, s87, 1572864
  s_cmp_lt_u32 s87, s84
  s_cselect_b32 s54, s87, s54
L_k1_nq_22:
  v_lshlrev_b32 v68, 16, v246
  v_and_b32 v69, s58, v246
  v_add_f32 v64, v64, v68
  v_add_f32 v65, v65, v69
  v_fmac_f32 v66, v68, v68
  v_fmac_f32 v67, v69, v69
  s_cmp_eq_u32 s42, 0
  s_cbranch_scc1 L_k1_nq_23
  s_add_u32 m0, s55, 8192
  s_add_u32 s88, s54, 12288
  buffer_load_dwordx4 v6, s[20:23], s54 offen lds
L_k1_nq_23:
  v_lshlrev_b32 v70, 16, v247
  v_and_b32 v71, s58, v247
  v_add_f32 v64, v64, v70
  v_add_f32 v65, v65, v71
  v_fmac_f32 v66, v70, v70
  v_fmac_f32 v67, v71, v71
  s_waitcnt lgkmcnt(0)
  v_lshlrev_b32 v68, 16, v252
  v_and_b32 v69, s58, v252
  v_add_f32 v64, v64, v68
  v_add_f32 v65, v65, v69
  v_fmac_f32 v66, v68, v68
  v_fmac_f32 v67, v69, v69
  v_mfma_f32_16x16x32_bf16 v[26:29], v[80:83], v[22:25], v[26:29]
  s_cmp_eq_u32 s42, 0
  s_cbranch_scc1 L_k1_nq_24
  s_add_u32 m0, s55, 9216
  s_add_u32 s87, s54, 98304
  buffer_load_dwordx4 v6, s[20:23], s88 offen lds
  s_sub_u32 s54, s87, 1572864
  s_cmp_lt_u32 s87, s84
  s_cselect_b32 s54, s87, s54
L_k1_nq_24:
  v_lshlrev_b32 v70, 16, v253
  v_and_b32 v71, s58, v253
  v_add_f32 v64, v64, v70
  v_add_f32 v65, v65, v71
  v_fmac_f32 v66, v70, v70
  v_fmac_f32 v67, v71, v71
  v_mfma_f32_16x16x32_bf16 v[26:29], v[84:87], v[22:25], v[26:29]
  s_cmp_eq_u32 s42, 0
  s_cbranch_scc1 L_k1_nq_25
  s_add_u32 m0, s55, 16384
  s_add_u32 s88, s54, 12288
  buffer_load_dwordx4 v6, s[20:23], s54 offen lds
L_k1_nq_25:
  v_lshlrev_b32 v68, 16, v254
  v_and_b32 v69, s58, v254
  v_add_f32 v64, v64, v68
  v_add_f32 v65, v65, v69
  v_fmac_f32 v66, v68, v68
  v_fmac_f32 v67, v69, v69
  v_mfma_f32_16x16x32_bf16 v[26:29], v[88:91], v[22:25], v[26:29]
  s_cmp_eq_u32 s42, 0
  s_cbranch_scc1 L_k1_nq_26
  s_add_u32 m0, s55, 17408
  s_add_u32 s87, s54, 98304
  buffer_load_dwordx4 v6, s[20:23], s88 offen lds
  s_sub_u32 s54, s87, 1572864
  s_cmp_lt_u32 s87, s84
  s_cselect_b32 s54, s87, s54
L_k1_nq_26:
  v_lshlrev_b32 v70, 16, v255
  v_and_b32 v71, s58, v255
  v_add_f32 v64, v64, v70
  v_add_f32 v65, v65, v71
  v_fmac_f32 v66, v70, v70
  v_fmac_f32 v67, v71, v71
  v_mfma_f32_16x16x32_bf16 v[26:29], v[92:95], v[22:25], v[26:29]
  v_add_f32 v64, v64, v65
  v_add_f32 v66, v66, v67
  v_mov_b32 v65, v64
  v_mov_b32 v67, v66
  s_lshl_b32 s43, s37, 9
  v_permlane32_swap_b32 v64, v65
  v_permlane32_swap_b32 v66, v67
  s_add_u32 s43, s43, 155648
  v_and_b32 v4, 31, v1
  v_add_f32 v64, v64, v65
  v_add_f32 v65, v66, v67
  v_lshl_add_u32 v4, v4, 3, s43
  ds_write_b64 v4, v[64:65] offset:256

  v_and_b32 v2, 1, v1
  v_lshlrev_b32 v2, 6, v2
  v_lshrrev_b32 v3, 4, v1
  v_lshl_add_u32 v2, v3, 4, v2
  s_lshl_b32 s43, s37, 7
  s_add_u32 s43, s43, 157696
  v_add_u32 v2, s43, v2
  s_nop 4
  s_mov_b64 exec, s[4:5]
  ds_write_b128 v2, v[26:29]
  s_mov_b64 exec, -1

  v_mov_b32 v30, v64
  v_mov_b32 v0, v65
  s_lshl_b32 s43, s37, 2
  v_add_u32 v5, s43, v21
  v_mov_b32 v31, 1

  s_waitcnt vmcnt(16)
  s_waitcnt lgkmcnt(0)
  s_barrier
  s_cmp_eq_u32 s42, 0
  s_cbranch_scc1 L_k1_fin

  v_mov_b32 v26, 0
  v_mov_b32 v27, 0
  v_mov_b32 v28, 0
  v_mov_b32 v29, 0
  s_cmp_ge_u32 s41, 8
  s_cbranch_scc1 L_k1_vtype

  ds_read_b64_tr_b16 v[32:33], v11 offset:0
  ds_read_b64_tr_b16 v[34:35], v11 offset:1024
  ds_read_b64_tr_b16 v[36:37], v12 offset:0
  ds_read_b64_tr_b16 v[38:39], v12 offset:1024
  ds_read_b64_tr_b16 v[40:41], v13 offset:0
  ds_read_b64_tr_b16 v[42:43], v13 offset:1024
  ds_read_b64_tr_b16 v[44:45], v14 offset:0
  ds_read_b64_tr_b16 v[46:47], v14 offset:1024
  s_waitcnt lgkmcnt(6)
  v_mfma_f32_32x32x16_bf16 v[64:79], v[32:35], v[128:131], 0
  ds_read_b64_tr_b16 v[48:49], v11 offset:4096
  ds_read_b64_tr_b16 v[50:51], v11 offset:5120
  ds_read_b64_tr_b16 v[52:53], v12 offset:4096
  s_add_u32 m0, s55, 114688
  s_add_u32 s88, s54, 12288
  buffer_load_dwordx4 v6, s[20:23], s54 offen lds
  s_waitcnt lgkmcnt(7)
  v_mfma_f32_32x32x16_bf16 v[80:95], v[36:39], v[128:131], 0
  ds_read_b64_tr_b16 v[54:55], v12 offset:5120
  ds_read_b64_tr_b16 v[56:57], v13 offset:4096
  ds_read_b64_tr_b16 v[58:59], v13 offset:5120
  v_mfma_f32_16x16x32_bf16 v[26:29], v[32:35], v[22:25], v[26:29]
  s_waitcnt lgkmcnt(8)
  v_mfma_f32_32x32x16_bf16 v[96:111], v[40:43], v[128:131], 0
  ds_read_b64_tr_b16 v[60:61], v14 offset:4096
  ds_read_b64_tr_b16 v[62:63], v14 offset:5120
  s_add_u32 m0, s55, 115712
  s_add_u32 s87, s54, 98304
  buffer_load_dwordx4 v6, s[20:23], s88 offen lds
  s_sub_u32 s54, s87, 1572864
  s_cmp_lt_u32 s87, s84
  s_cselect_b32 s54, s87, s54
  s_waitcnt lgkmcnt(8)
  v_mfma_f32_32x32x16_bf16 v[112:127], v[44:47], v[128:131], 0
  s_waitcnt lgkmcnt(6)
  v_mfma_f32_32x32x16_bf16 v[64:79], v[48:51], v[132:135], v[64:79]
  ds_read_b64_tr_b16 v[32:33], v11 offset:8192
  ds_read_b64_tr_b16 v[34:35], v11 offset:9216
  ds_read_b64_tr_b16 v[36:37], v12 offset:8192
  s_add_u32 m0, s55, 122880
  s_add_u32 s88, s54, 12288
  buffer_load_dwordx4 v6, s[20:23], s54 offen lds
  s_waitcnt lgkmcnt(7)
  v_mfma_f32_32x32x16_bf16 v[80:95], v[52:55], v[132:135], v[80:95]
  ds_read_b64_tr_b16 v[38:39], v12 offset:9216
  ds_read_b64_tr_b16 v[40:41], v13 offset:8192
  ds_read_b64_tr_b16 v[42:43], v13 offset:9216
  v_mfma_f32_16x16x32_bf16 v[26:29], v[48:51], v[22:25], v[26:29]
  s_waitcnt lgkmcnt(8)
  v_mfma_f32_32x32x16_bf16 v[96:111], v[56:59], v[132:135], v[96:111]
  ds_read_b64_tr_b16 v[44:45], v14 offset:8192
  ds_read_b64_tr_b16 v[46:47], v14 offset:9216
  s_add_u32 m0, s55, 123904
  s_add_u32 s87, s54, 98304
  buffer_load_dwordx4 v6, s[20:23], s88 offen lds
  s_sub_u32 s54, s87, 1572864
  s_cmp_lt_u32 s87, s84
  s_cselect_b32 s54, s87, s54
  s_waitcnt lgkmcnt(8)
  v_mfma_f32_32x32x16_bf16 v[112:127], v[60:63], v[132:135], v[112:127]
  s_waitcnt lgkmcnt(6)
  v_mfma_f32_32x32x16_bf16 v[64:79], v[32:35], v[136:139], v[64:79]
  ds_read_b64_tr_b16 v[48:49], v11 offset:12288
  ds_read_b64_tr_b16 v[50:51], v11 offset:13312
  ds_read_b64_tr_b16 v[52:53], v12 offset:12288
  s_add_u32 m0, s55, 24576
  s_add_u32 s88, s54, 12288
  buffer_load_dwordx4 v6, s[20:23], s54 offen lds
  s_waitcnt lgkmcnt(7)
  v_mfma_f32_32x32x16_bf16 v[80:95], v[36:39], v[136:139], v[80:95]
  ds_read_b64_tr_b16 v[54:55], v12 offset:13312
  ds_read_b64_tr_b16 v[56:57], v13 offset:12288
  ds_read_b64_tr_b16 v[58:59], v13 offset:13312
  v_mfma_f32_16x16x32_bf16 v[26:29], v[32:35], v[22:25], v[26:29]
  s_waitcnt lgkmcnt(8)
  v_mfma_f32_32x32x16_bf16 v[96:111], v[40:43], v[136:139], v[96:111]
  ds_read_b64_tr_b16 v[60:61], v14 offset:12288
  ds_read_b64_tr_b16 v[62:63], v14 offset:13312
  s_add_u32 m0, s55, 25600
  s_add_u32 s87, s54, 98304
  buffer_load_dwordx4 v6, s[20:23], s88 offen lds
  s_sub_u32 s54, s87, 1572864
  s_cmp_lt_u32 s87, s84
  s_cselect_b32 s54, s87, s54
  s_waitcnt lgkmcnt(8)
  v_mfma_f32_32x32x16_bf16 v[112:127], v[44:47], v[136:139], v[112:127]
  s_waitcnt lgkmcnt(6)
  v_mfma_f32_32x32x16_bf16 v[64:79], v[48:51], v[140:143], v[64:79]
  ds_read_b64_tr_b16 v[32:33], v15 offset:0
  ds_read_b64_tr_b16 v[34:35], v15 offset:1024
  ds_read_b64_tr_b16 v[36:37], v16 offset:0
  s_add_u32 m0, s55, 32768
  s_add_u32 s88, s54, 12288
  buffer_load_dwordx4 v6, s[20:23], s54 offen lds
  s_waitcnt lgkmcnt(7)
  v_mfma_f32_32x32x16_bf16 v[80:95], v[52:55], v[140:143], v[80:95]
  ds_read_b64_tr_b16 v[38:39], v16 offset:1024
  ds_read_b64_tr_b16 v[40:41], v17 offset:0
  ds_read_b64_tr_b16 v[42:43], v17 offset:1024
  v_mfma_f32_16x16x32_bf16 v[26:29], v[48:51], v[22:25], v[26:29]
  s_waitcnt lgkmcnt(8)
  v_mfma_f32_32x32x16_bf16 v[96:111], v[56:59], v[140:143], v[96:111]
  ds_read_b64_tr_b16 v[44:45], v18 offset:0
  ds_read_b64_tr_b16 v[46:47], v18 offset:1024
  s_add_u32 m0, s55, 33792
  s_add_u32 s87, s54, 98304
  buffer_load_dwordx4 v6, s[20:23], s88 offen lds
  s_sub_u32 s54, s87, 1572864
  s_cmp_lt_u32 s87, s84
  s_cselect_b32 s54, s87, s54
  s_waitcnt lgkmcnt(8)
  v_mfma_f32_32x32x16_bf16 v[112:127], v[60:63], v[140:143], v[112:127]
  s_waitcnt lgkmcnt(6)
  v_mfma_f32_32x32x16_bf16 v[64:79], v[32:35], v[144:147], v[64:79]
  ds_read_b64_tr_b16 v[48:49], v15 offset:4096
  ds_read_b64_tr_b16 v[50:51], v15 offset:5120
  ds_read_b64_tr_b16 v[52:53], v16 offset:4096
  s_waitcnt lgkmcnt(7)
  v_mfma_f32_32x32x16_bf16 v[80:95], v[36:39], v[144:147], v[80:95]
  ds_read_b64_tr_b16 v[54:55], v16 offset:5120
  ds_read_b64_tr_b16 v[56:57], v17 offset:4096
  ds_read_b64_tr_b16 v[58:59], v17 offset:5120
  v_mfma_f32_16x16x32_bf16 v[26:29], v[32:35], v[22:25], v[26:29]
  s_waitcnt lgkmcnt(8)
  v_mfma_f32_32x32x16_bf16 v[96:111], v[40:43], v[144:147], v[96:111]
  ds_read_b64_tr_b16 v[60:61], v18 offset:4096
  ds_read_b64_tr_b16 v[62:63], v18 offset:5120
  s_waitcnt lgkmcnt(8)
  v_mfma_f32_32x32x16_bf16 v[112:127], v[44:47], v[144:147], v[112:127]
  s_waitcnt lgkmcnt(6)
  v_mfma_f32_32x32x16_bf16 v[64:79], v[48:51], v[148:151], v[64:79]
  ds_read_b64_tr_b16 v[32:33], v15 offset:8192
  ds_read_b64_tr_b16 v[34:35], v15 offset:9216
  ds_read_b64_tr_b16 v[36:37], v16 offset:8192
  s_waitcnt lgkmcnt(7)
  v_mfma_f32_32x32x16_bf16 v[80:95], v[52:55], v[148:151], v[80:95]
  ds_read_b64_tr_b16 v[38:39], v16 offset:9216
  ds_read_b64_tr_b16 v[40:41], v17 offset:8192
  ds_read_b64_tr_b16 v[42:43], v17 offset:9216
  v_mfma_f32_16x16x32_bf16 v[26:29], v[48:51], v[22:25], v[26:29]
  s_waitcnt lgkmcnt(8)
  v_mfma_f32_32x32x16_bf16 v[96:111], v[56:59], v[148:151], v[96:111]
  ds_read_b64_tr_b16 v[44:45], v18 offset:8192
  ds_read_b64_tr_b16 v[46:47], v18 offset:9216
  s_waitcnt lgkmcnt(8)
  v_mfma_f32_32x32x16_bf16 v[112:127], v[60:63], v[148:151], v[112:127]
  s_waitcnt lgkmcnt(6)
  v_mfma_f32_32x32x16_bf16 v[64:79], v[32:35], v[152:155], v[64:79]
  ds_read_b64_tr_b16 v[48:49], v15 offset:12288
  ds_read_b64_tr_b16 v[50:51], v15 offset:13312
  ds_read_b64_tr_b16 v[52:53], v16 offset:12288
  s_waitcnt lgkmcnt(7)
  v_mfma_f32_32x32x16_bf16 v[80:95], v[36:39], v[152:155], v[80:95]
  ds_read_b64_tr_b16 v[54:55], v16 offset:13312
  ds_read_b64_tr_b16 v[56:57], v17 offset:12288
  ds_read_b64_tr_b16 v[58:59], v17 offset:13312
  v_mfma_f32_16x16x32_bf16 v[26:29], v[32:35], v[22:25], v[26:29]
  s_waitcnt lgkmcnt(8)
  v_mfma_f32_32x32x16_bf16 v[96:111], v[40:43], v[152:155], v[96:111]
  ds_read_b64_tr_b16 v[60:61], v18 offset:12288
  ds_read_b64_tr_b16 v[62:63], v18 offset:13312
  s_waitcnt lgkmcnt(8)
  v_mfma_f32_32x32x16_bf16 v[112:127], v[44:47], v[152:155], v[112:127]
  s_waitcnt lgkmcnt(6)
  v_mfma_f32_32x32x16_bf16 v[64:79], v[48:51], v[156:159], v[64:79]
  s_waitcnt vmcnt(16)
  ds_write_b32 v5, v31 offset:16
L_k1_fp_27:
  ds_read_b128 v[128:131], v21 offset:16
  s_waitcnt lgkmcnt(0)
  v_and_b32 v2, v128, v129
  v_and_b32 v4, v130, v131
  v_and_b32 v2, v2, v4
  s_nop 0
  v_readfirstlane_b32 s43, v2
  s_nop 3
  s_cmp_eq_u32 s43, 0
  s_cbranch_scc1 L_k1_fp_27

  ds_read_b64_tr_b16 v[32:33], v11 offset:16384
  ds_read_b64_tr_b16 v[34:35], v11 offset:17408
  ds_read_b64_tr_b16 v[36:37], v12 offset:16384
  v_mfma_f32_32x32x16_bf16 v[80:95], v[52:55], v[156:159], v[80:95]
  ds_read_b64_tr_b16 v[38:39], v12 offset:17408
  ds_read_b64_tr_b16 v[40:41], v13 offset:16384
  ds_read_b64_tr_b16 v[42:43], v13 offset:17408
  v_mfma_f32_16x16x32_bf16 v[26:29], v[48:51], v[22:25], v[26:29]
  v_mfma_f32_32x32x16_bf16 v[96:111], v[56:59], v[156:159], v[96:111]
  ds_read_b64_tr_b16 v[44:45], v14 offset:16384
  ds_read_b64_tr_b16 v[46:47], v14 offset:17408
  v_mfma_f32_32x32x16_bf16 v[112:127], v[60:63], v[156:159], v[112:127]
  s_waitcnt lgkmcnt(6)
  v_mfma_f32_32x32x16_bf16 v[64:79], v[32:35], v[160:163], v[64:79]
  ds_read_b64_tr_b16 v[48:49], v11 offset:20480
  ds_read_b64_tr_b16 v[50:51], v11 offset:21504
  ds_read_b64_tr_b16 v[52:53], v12 offset:20480
  s_waitcnt lgkmcnt(7)
  v_mfma_f32_32x32x16_bf16 v[80:95], v[36:39], v[160:163], v[80:95]
  ds_read_b64_tr_b16 v[54:55], v12 offset:21504
  ds_read_b64_tr_b16 v[56:57], v13 offset:20480
  ds_read_b64_tr_b16 v[58:59], v13 offset:21504
  v_mfma_f32_16x16x32_bf16 v[26:29], v[32:35], v[22:25], v[26:29]
  s_waitcnt lgkmcnt(8)
  v_mfma_f32_32x32x16_bf16 v[96:111], v[40:43], v[160:163], v[96:111]
  ds_read_b64_tr_b16 v[60:61], v14 offset:20480
  ds_read_b64_tr_b16 v[62:63], v14 offset:21504
  s_waitcnt lgkmcnt(8)
  v_mfma_f32_32x32x16_bf16 v[112:127], v[44:47], v[160:163], v[112:127]
  s_waitcnt lgkmcnt(6)
  v_mfma_f32_32x32x16_bf16 v[64:79], v[48:51], v[164:167], v[64:79]
  ds_read_b64_tr_b16 v[32:33], v11 offset:24576
  ds_read_b64_tr_b16 v[34:35], v11 offset:25600
  ds_read_b64_tr_b16 v[36:37], v12 offset:24576
  s_waitcnt lgkmcnt(7)
  v_mfma_f32_32x32x16_bf16 v[80:95], v[52:55], v[164:167], v[80:95]
  ds_read_b64_tr_b16 v[38:39], v12 offset:25600
  ds_read_b64_tr_b16 v[40:41], v13 offset:24576
  ds_read_b64_tr_b16 v[42:43], v13 offset:25600
  v_mfma_f32_16x16x32_bf16 v[26:29], v[48:51], v[22:25], v[26:29]
  s_waitcnt lgkmcnt(8)
  v_mfma_f32_32x32x16_bf16 v[96:111], v[56:59], v[164:167], v[96:111]
  ds_read_b64_tr_b16 v[44:45], v14 offset:24576
  ds_read_b64_tr_b16 v[46:47], v14 offset:25600
  s_waitcnt lgkmcnt(8)
  v_mfma_f32_32x32x16_bf16 v[112:127], v[60:63], v[164:167], v[112:127]
  s_waitcnt lgkmcnt(6)
  v_mfma_f32_32x32x16_bf16 v[64:79], v[32:35], v[168:171], v[64:79]
  ds_read_b64_tr_b16 v[48:49], v11 offset:28672
  ds_read_b64_tr_b16 v[50:51], v11 offset:29696
  ds_read_b64_tr_b16 v[52:53], v12 offset:28672
  s_waitcnt lgkmcnt(7)
  v_mfma_f32_32x32x16_bf16 v[80:95], v[36:39], v[168:171], v[80:95]
  ds_read_b64_tr_b16 v[54:55], v12 offset:29696
  ds_read_b64_tr_b16 v[56:57], v13 offset:28672
  ds_read_b64_tr_b16 v[58:59], v13 offset:29696
  v_mfma_f32_16x16x32_bf16 v[26:29], v[32:35], v[22:25], v[26:29]
  s_waitcnt lgkmcnt(8)
  v_mfma_f32_32x32x16_bf16 v[96:111], v[40:43], v[168:171], v[96:111]
  ds_read_b64_tr_b16 v[60:61], v14 offset:28672
  ds_read_b64_tr_b16 v[62:63], v14 offset:29696
  s_waitcnt lgkmcnt(8)
  v_mfma_f32_32x32x16_bf16 v[112:127], v[44:47], v[168:171], v[112:127]
  s_waitcnt lgkmcnt(6)
  v_mfma_f32_32x32x16_bf16 v[64:79], v[48:51], v[172:175], v[64:79]
  ds_read_b64_tr_b16 v[32:33], v15 offset:16384
  ds_read_b64_tr_b16 v[34:35], v15 offset:17408
  ds_read_b64_tr_b16 v[36:37], v16 offset:16384
  s_waitcnt lgkmcnt(7)
  v_mfma_f32_32x32x16_bf16 v[80:95], v[52:55], v[172:175], v[80:95]
  ds_read_b64_tr_b16 v[38:39], v16 offset:17408
  ds_read_b64_tr_b16 v[40:41], v17 offset:16384
  ds_read_b64_tr_b16 v[42:43], v17 offset:17408
  v_mfma_f32_16x16x32_bf16 v[26:29], v[48:51], v[22:25], v[26:29]
  s_waitcnt lgkmcnt(8)
  v_mfma_f32_32x32x16_bf16 v[96:111], v[56:59], v[172:175], v[96:111]
  ds_read_b64_tr_b16 v[44:45], v18 offset:16384
  ds_read_b64_tr_b16 v[46:47], v18 offset:17408
  s_waitcnt lgkmcnt(8)
  v_mfma_f32_32x32x16_bf16 v[112:127], v[60:63], v[172:175], v[112:127]
  s_waitcnt lgkmcnt(6)
  v_mfma_f32_32x32x16_bf16 v[64:79], v[32:35], v[176:179], v[64:79]
  ds_read_b64_tr_b16 v[48:49], v15 offset:20480
  ds_read_b64_tr_b16 v[50:51], v15 offset:21504
  ds_read_b64_tr_b16 v[52:53], v16 offset:20480
  s_waitcnt lgkmcnt(7)
  v_mfma_f32_32x32x16_bf16 v[80:95], v[36:39], v[176:179], v[80:95]
  ds_read_b64_tr_b16 v[54:55], v16 offset:21504
  ds_read_b64_tr_b16 v[56:57], v17 offset:20480
  ds_read_b64_tr_b16 v[58:59], v17 offset:21504
  v_mfma_f32_16x16x32_bf16 v[26:29], v[32:35], v[22:25], v[26:29]
  s_waitcnt lgkmcnt(8)
  v_mfma_f32_32x32x16_bf16 v[96:111], v[40:43], v[176:179], v[96:111]
  ds_read_b64_tr_b16 v[60:61], v18 offset:20480
  ds_read_b64_tr_b16 v[62:63], v18 offset:21504
  s_waitcnt lgkmcnt(8)
  v_mfma_f32_32x32x16_bf16 v[112:127], v[44:47], v[176:179], v[112:127]
  s_waitcnt lgkmcnt(6)
  v_mfma_f32_32x32x16_bf16 v[64:79], v[48:51], v[180:183], v[64:79]
  ds_read_b64_tr_b16 v[32:33], v7 offset:0
  ds_read_b64_tr_b16 v[34:35], v7 offset:1024
  ds_read_b64_tr_b16 v[36:37], v8 offset:0
  s_waitcnt lgkmcnt(7)
  v_mfma_f32_32x32x16_bf16 v[80:95], v[52:55], v[180:183], v[80:95]
  ds_read_b64_tr_b16 v[38:39], v8 offset:1024
  ds_read_b64_tr_b16 v[40:41], v9 offset:0
  ds_read_b64_tr_b16 v[42:43], v9 offset:1024
  v_mfma_f32_16x16x32_bf16 v[26:29], v[48:51], v[22:25], v[26:29]
  s_waitcnt lgkmcnt(8)
  v_mfma_f32_32x32x16_bf16 v[96:111], v[56:59], v[180:183], v[96:111]
  ds_read_b64_tr_b16 v[44:45], v10 offset:0
  ds_read_b64_tr_b16 v[46:47], v10 offset:1024
  s_waitcnt lgkmcnt(8)
  v_mfma_f32_32x32x16_bf16 v[112:127], v[60:63], v[180:183], v[112:127]
  s_waitcnt lgkmcnt(6)
  v_mfma_f32_32x32x16_bf16 v[64:79], v[32:35], v[184:187], v[64:79]
  ds_read_b64_tr_b16 v[48:49], v7 offset:4096
  ds_read_b64_tr_b16 v[50:51], v7 offset:5120
  ds_read_b64_tr_b16 v[52:53], v8 offset:4096
  s_waitcnt lgkmcnt(7)
  v_mfma_f32_32x32x16_bf16 v[80:95], v[36:39], v[184:187], v[80:95]
  ds_read_b64_tr_b16 v[54:55], v8 offset:5120
  ds_read_b64_tr_b16 v[56:57], v9 offset:4096
  ds_read_b64_tr_b16 v[58:59], v9 offset:5120
  v_mfma_f32_16x16x32_bf16 v[26:29], v[32:35], v[22:25], v[26:29]
  s_waitcnt lgkmcnt(8)
  v_mfma_f32_32x32x16_bf16 v[96:111], v[40:43], v[184:187], v[96:111]
  ds_read_b64_tr_b16 v[60:61], v10 offset:4096
  ds_read_b64_tr_b16 v[62:63], v10 offset:5120
  s_waitcnt lgkmcnt(8)
  v_mfma_f32_32x32x16_bf16 v[112:127], v[44:47], v[184:187], v[112:127]
  s_waitcnt lgkmcnt(6)
  v_mfma_f32_32x32x16_bf16 v[64:79], v[48:51], v[188:191], v[64:79]
  s_waitcnt vmcnt(8)
  ds_write_b32 v5, v31 offset:32
L_k1_fp_28:
  ds_read_b128 v[128:131], v21 offset:32
  s_waitcnt lgkmcnt(0)
  v_and_b32 v2, v128, v129
  v_and_b32 v4, v130, v131
  v_and_b32 v2, v2, v4
  s_nop 0
  v_readfirstlane_b32 s43, v2
  s_nop 3
  s_cmp_eq_u32 s43, 0
  s_cbranch_scc1 L_k1_fp_28

  ds_read_b64_tr_b16 v[32:33], v11 offset:32768
  ds_read_b64_tr_b16 v[34:35], v11 offset:33792
  ds_read_b64_tr_b16 v[36:37], v12 offset:32768
  v_mfma_f32_32x32x16_bf16 v[80:95], v[52:55], v[188:191], v[80:95]
  ds_read_b64_tr_b16 v[38:39], v12 offset:33792
  ds_read_b64_tr_b16 v[40:41], v13 offset:32768
  ds_read_b64_tr_b16 v[42:43], v13 offset:33792
  v_mfma_f32_16x16x32_bf16 v[26:29], v[48:51], v[22:25], v[26:29]
  v_mfma_f32_32x32x16_bf16 v[96:111], v[56:59], v[188:191], v[96:111]
  ds_read_b64_tr_b16 v[44:45], v14 offset:32768
  ds_read_b64_tr_b16 v[46:47], v14 offset:33792
  v_mfma_f32_32x32x16_bf16 v[112:127], v[60:63], v[188:191], v[112:127]
  s_waitcnt lgkmcnt(6)
  v_mfma_f32_32x32x16_bf16 v[64:79], v[32:35], v[192:195], v[64:79]
  ds_read_b64_tr_b16 v[48:49], v11 offset:36864
  ds_read_b64_tr_b16 v[50:51], v11 offset:37888
  ds_read_b64_tr_b16 v[52:53], v12 offset:36864
  s_waitcnt lgkmcnt(7)
  v_mfma_f32_32x32x16_bf16 v[80:95], v[36:39], v[192:195], v[80:95]
  ds_read_b64_tr_b16 v[54:55], v12 offset:37888
  ds_read_b64_tr_b16 v[56:57], v13 offset:36864
  ds_read_b64_tr_b16 v[58:59], v13 offset:37888
  v_mfma_f32_16x16x32_bf16 v[26:29], v[32:35], v[22:25], v[26:29]
  s_waitcnt lgkmcnt(8)
  v_mfma_f32_32x32x16_bf16 v[96:111], v[40:43], v[192:195], v[96:111]
  ds_read_b64_tr_b16 v[60:61], v14 offset:36864
  ds_read_b64_tr_b16 v[62:63], v14 offset:37888
  s_waitcnt lgkmcnt(8)
  v_mfma_f32_32x32x16_bf16 v[112:127], v[44:47], v[192:195], v[112:127]
  s_waitcnt lgkmcnt(6)
  v_mfma_f32_32x32x16_bf16 v[64:79], v[48:51], v[196:199], v[64:79]
  ds_read_b64_tr_b16 v[32:33], v11 offset:40960
  ds_read_b64_tr_b16 v[34:35], v11 offset:41984
  ds_read_b64_tr_b16 v[36:37], v12 offset:40960
  s_waitcnt lgkmcnt(7)
  v_mfma_f32_32x32x16_bf16 v[80:95], v[52:55], v[196:199], v[80:95]
  ds_read_b64_tr_b16 v[38:39], v12 offset:41984
  ds_read_b64_tr_b16 v[40:41], v13 offset:40960
  ds_read_b64_tr_b16 v[42:43], v13 offset:41984
  v_mfma_f32_16x16x32_bf16 v[26:29], v[48:51], v[22:25], v[26:29]
  s_waitcnt lgkmcnt(8)
  v_mfma_f32_32x32x16_bf16 v[96:111], v[56:59], v[196:199], v[96:111]
  ds_read_b64_tr_b16 v[44:45], v14 offset:40960
  ds_read_b64_tr_b16 v[46:47], v14 offset:41984
  s_waitcnt lgkmcnt(8)
  v_mfma_f32_32x32x16_bf16 v[112:127], v[60:63], v[196:199], v[112:127]
  s_waitcnt lgkmcnt(6)
  v_mfma_f32_32x32x16_bf16 v[64:79], v[32:35], v[200:203], v[64:79]
  ds_read_b64_tr_b16 v[48:49], v11 offset:45056
  ds_read_b64_tr_b16 v[50:51], v11 offset:46080
  ds_read_b64_tr_b16 v[52:53], v12 offset:45056
  s_waitcnt lgkmcnt(7)
  v_mfma_f32_32x32x16_bf16 v[80:95], v[36:39], v[200:203], v[80:95]
  ds_read_b64_tr_b16 v[54:55], v12 offset:46080
  ds_read_b64_tr_b16 v[56:57], v13 offset:45056
  ds_read_b64_tr_b16 v[58:59], v13 offset:46080
  v_mfma_f32_16x16x32_bf16 v[26:29], v[32:35], v[22:25], v[26:29]
  s_waitcnt lgkmcnt(8)
  v_mfma_f32_32x32x16_bf16 v[96:111], v[40:43], v[200:203], v[96:111]
  ds_read_b64_tr_b16 v[60:61], v14 offset:45056
  ds_read_b64_tr_b16 v[62:63], v14 offset:46080
  s_waitcnt lgkmcnt(8)
  v_mfma_f32_32x32x16_bf16 v[112:127], v[44:47], v[200:203], v[112:127]
  s_waitcnt lgkmcnt(6)
  v_mfma_f32_32x32x16_bf16 v[64:79], v[48:51], v[204:207], v[64:79]
  ds_read_b64_tr_b16 v[32:33], v7 offset:8192
  ds_read_b64_tr_b16 v[34:35], v7 offset:9216
  ds_read_b64_tr_b16 v[36:37], v8 offset:8192
  s_waitcnt lgkmcnt(7)
  v_mfma_f32_32x32x16_bf16 v[80:95], v[52:55], v[204:207], v[80:95]
  ds_read_b64_tr_b16 v[38:39], v8 offset:9216
  ds_read_b64_tr_b16 v[40:41], v9 offset:8192
  ds_read_b64_tr_b16 v[42:43], v9 offset:9216
  v_mfma_f32_16x16x32_bf16 v[26:29], v[48:51], v[22:25], v[26:29]
  s_waitcnt lgkmcnt(8)
  v_mfma_f32_32x32x16_bf16 v[96:111], v[56:59], v[204:207], v[96:111]
  ds_read_b64_tr_b16 v[44:45], v10 offset:8192
  ds_read_b64_tr_b16 v[46:47], v10 offset:9216
  s_waitcnt lgkmcnt(8)
  v_mfma_f32_32x32x16_bf16 v[112:127], v[60:63], v[204:207], v[112:127]
  s_waitcnt lgkmcnt(6)
  v_mfma_f32_32x32x16_bf16 v[64:79], v[32:35], v[208:211], v[64:79]
  ds_read_b64_tr_b16 v[48:49], v7 offset:12288
  ds_read_b64_tr_b16 v[50:51], v7 offset:13312
  ds_read_b64_tr_b16 v[52:53], v8 offset:12288
  s_waitcnt lgkmcnt(7)
  v_mfma_f32_32x32x16_bf16 v[80:95], v[36:39], v[208:211], v[80:95]
  ds_read_b64_tr_b16 v[54:55], v8 offset:13312
  ds_read_b64_tr_b16 v[56:57], v9 offset:12288
  ds_read_b64_tr_b16 v[58:59], v9 offset:13312
  v_mfma_f32_16x16x32_bf16 v[26:29], v[32:35], v[22:25], v[26:29]
  s_waitcnt lgkmcnt(8)
  v_mfma_f32_32x32x16_bf16 v[96:111], v[40:43], v[208:211], v[96:111]
  ds_read_b64_tr_b16 v[60:61], v10 offset:12288
  ds_read_b64_tr_b16 v[62:63], v10 offset:13312
  s_waitcnt lgkmcnt(8)
  v_mfma_f32_32x32x16_bf16 v[112:127], v[44:47], v[208:211], v[112:127]
  s_waitcnt lgkmcnt(6)
  v_mfma_f32_32x32x16_bf16 v[64:79], v[48:51], v[212:215], v[64:79]
  ds_read_b64_tr_b16 v[32:33], v7 offset:16384
  ds_read_b64_tr_b16 v[34:35], v7 offset:17408
  ds_read_b64_tr_b16 v[36:37], v8 offset:16384
  s_waitcnt lgkmcnt(7)
  v_mfma_f32_32x32x16_bf16 v[80:95], v[52:55], v[212:215], v[80:95]
  ds_read_b64_tr_b16 v[38:39], v8 offset:17408
  ds_read_b64_tr_b16 v[40:41], v9 offset:16384
  ds_read_b64_tr_b16 v[42:43], v9 offset:17408
  v_mfma_f32_16x16x32_bf16 v[26:29], v[48:51], v[22:25], v[26:29]
  s_waitcnt lgkmcnt(8)
  v_mfma_f32_32x32x16_bf16 v[96:111], v[56:59], v[212:215], v[96:111]
  ds_read_b64_tr_b16 v[44:45], v10 offset:16384
  ds_read_b64_tr_b16 v[46:47], v10 offset:17408
  s_waitcnt lgkmcnt(8)
  v_mfma_f32_32x32x16_bf16 v[112:127], v[60:63], v[212:215], v[112:127]
  s_waitcnt lgkmcnt(6)
  v_mfma_f32_32x32x16_bf16 v[64:79], v[32:35], v[216:219], v[64:79]
  ds_read_b64_tr_b16 v[48:49], v7 offset:20480
  ds_read_b64_tr_b16 v[50:51], v7 offset:21504
  ds_read_b64_tr_b16 v[52:53], v8 offset:20480
  s_waitcnt lgkmcnt(7)
  v_mfma_f32_32x32x16_bf16 v[80:95], v[36:39], v[216:219], v[80:95]
  ds_read_b64_tr_b16 v[54:55], v8 offset:21504
  ds_read_b64_tr_b16 v[56:57], v9 offset:20480
  ds_read_b64_tr_b16 v[58:59], v9 offset:21504
  v_mfma_f32_16x16x32_bf16 v[26:29], v[32:35], v[22:25], v[26:29]
  s_waitcnt lgkmcnt(8)
  v_mfma_f32_32x32x16_bf16 v[96:111], v[40:43], v[216:219], v[96:111]
  ds_read_b64_tr_b16 v[60:61], v10 offset:20480
  ds_read_b64_tr_b16 v[62:63], v10 offset:21504
  s_waitcnt lgkmcnt(8)
  v_mfma_f32_32x32x16_bf16 v[112:127], v[44:47], v[216:219], v[112:127]
  s_waitcnt lgkmcnt(6)
  v_mfma_f32_32x32x16_bf16 v[64:79], v[48:51], v[220:223], v[64:79]
  s_waitcnt vmcnt(0)
  ds_write_b32 v5, v31 offset:48
L_k1_fp_29:
  ds_read_b128 v[128:131], v21 offset:48
  s_waitcnt lgkmcnt(0)
  v_and_b32 v2, v128, v129
  v_and_b32 v4, v130, v131
  v_and_b32 v2, v2, v4
  s_nop 0
  v_readfirstlane_b32 s43, v2
  s_nop 3
  s_cmp_eq_u32 s43, 0
  s_cbranch_scc1 L_k1_fp_29

  s_lshl_b32 s43, s37, 9
  s_add_u32 s43, s43, 155904
  v_and_b32 v4, 31, v1
  v_lshl_add_u32 v4, v4, 3, s43
  ds_read_b64 v[162:163], v4 offset:4352
  s_waitcnt lgkmcnt(0)
  v_add_f32 v160, v30, v162
  v_add_f32 v161, v0, v163

  v_mul_f32 v160, 0x3b000000, v160
  v_mul_f32 v161, 0x3b000000, v161
  v_fma_f32 v161, -v160, v160, v161
  v_max_f32 v161, 0, v161
  v_cvt_pk_bf16_f32 v162, v160, v161
  v_lshlrev_b32 v30, 16, v162
  v_and_b32 v161, s58, v162
  v_add_f32 v161, 0x3727c5ac, v161
  v_cvt_pk_bf16_f32 v161, v161, v161
  v_and_b32 v161, s58, v161
  v_sqrt_f32 v161, v161
  s_nop 0
  v_cvt_pk_bf16_f32 v161, v161, v161
  v_and_b32 v161, s58, v161
  v_rcp_f32 v0, v161
  s_nop 0
  v_fma_f32 v160, -v161, v0, 1.0
  v_fma_f32 v0, v160, v0, v0
  v_mul_f32 v30, v30, v0
  v_xor_b32 v30, 0x80000000, v30

  ds_read_b64_tr_b16 v[32:33], v11 offset:49152
  ds_read_b64_tr_b16 v[34:35], v11 offset:50176
  ds_read_b64_tr_b16 v[36:37], v12 offset:49152
  v_mfma_f32_32x32x16_bf16 v[80:95], v[52:55], v[220:223], v[80:95]
  ds_read_b64_tr_b16 v[38:39], v12 offset:50176
  ds_read_b64_tr_b16 v[40:41], v13 offset:49152
  ds_read_b64_tr_b16 v[42:43], v13 offset:50176
  v_mfma_f32_16x16x32_bf16 v[26:29], v[48:51], v[22:25], v[26:29]
  v_mfma_f32_32x32x16_bf16 v[96:111], v[56:59], v[220:223], v[96:111]
  ds_read_b64_tr_b16 v[44:45], v14 offset:49152
  ds_read_b64_tr_b16 v[46:47], v14 offset:50176
  v_mfma_f32_32x32x16_bf16 v[112:127], v[60:63], v[220:223], v[112:127]
  s_waitcnt lgkmcnt(6)
  v_mfma_f32_32x32x16_bf16 v[64:79], v[32:35], v[224:227], v[64:79]
  ds_read_b64_tr_b16 v[48:49], v11 offset:53248
  ds_read_b64_tr_b16 v[50:51], v11 offset:54272
  ds_read_b64_tr_b16 v[52:53], v12 offset:53248
  s_waitcnt lgkmcnt(7)
  v_mfma_f32_32x32x16_bf16 v[80:95], v[36:39], v[224:227], v[80:95]
  ds_read_b64_tr_b16 v[54:55], v12 offset:54272
  ds_read_b64_tr_b16 v[56:57], v13 offset:53248
  ds_read_b64_tr_b16 v[58:59], v13 offset:54272
  v_mfma_f32_16x16x32_bf16 v[26:29], v[32:35], v[22:25], v[26:29]
  s_waitcnt lgkmcnt(8)
  v_mfma_f32_32x32x16_bf16 v[96:111], v[40:43], v[224:227], v[96:111]
  ds_read_b64_tr_b16 v[60:61], v14 offset:53248
  ds_read_b64_tr_b16 v[62:63], v14 offset:54272
  s_waitcnt lgkmcnt(8)
  v_mfma_f32_32x32x16_bf16 v[112:127], v[44:47], v[224:227], v[112:127]
  s_waitcnt lgkmcnt(6)
  v_mfma_f32_32x32x16_bf16 v[64:79], v[48:51], v[228:231], v[64:79]
  ds_read_b64_tr_b16 v[32:33], v11 offset:57344
  ds_read_b64_tr_b16 v[34:35], v11 offset:58368
  ds_read_b64_tr_b16 v[36:37], v12 offset:57344
  s_waitcnt lgkmcnt(7)
  v_mfma_f32_32x32x16_bf16 v[80:95], v[52:55], v[228:231], v[80:95]
  ds_read_b64_tr_b16 v[38:39], v12 offset:58368
  ds_read_b64_tr_b16 v[40:41], v13 offset:57344
  ds_read_b64_tr_b16 v[42:43], v13 offset:58368
  v_mfma_f32_16x16x32_bf16 v[26:29], v[48:51], v[22:25], v[26:29]
  s_waitcnt lgkmcnt(8)
  v_mfma_f32_32x32x16_bf16 v[96:111], v[56:59], v[228:231], v[96:111]
  ds_read_b64_tr_b16 v[44:45], v14 offset:57344
  ds_read_b64_tr_b16 v[46:47], v14 offset:58368
  s_waitcnt lgkmcnt(8)
  v_mfma_f32_32x32x16_bf16 v[112:127], v[60:63], v[228:231], v[112:127]
  s_waitcnt lgkmcnt(6)
  v_mfma_f32_32x32x16_bf16 v[64:79], v[32:35], v[232:235], v[64:79]
  ds_read_b64_tr_b16 v[48:49], v11 offset:61440
  ds_read_b64_tr_b16 v[50:51], v11 offset:62464
  ds_read_b64_tr_b16 v[52:53], v12 offset:61440
  s_waitcnt lgkmcnt(7)
  v_mfma_f32_32x32x16_bf16 v[80:95], v[36:39], v[232:235], v[80:95]
  ds_read_b64_tr_b16 v[54:55], v12 offset:62464
  ds_read_b64_tr_b16 v[56:57], v13 offset:61440
  ds_read_b64_tr_b16 v[58:59], v13 offset:62464
  v_mfma_f32_16x16x32_bf16 v[26:29], v[32:35], v[22:25], v[26:29]
  s_waitcnt lgkmcnt(8)
  v_mfma_f32_32x32x16_bf16 v[96:111], v[40:43], v[232:235], v[96:111]
  ds_read_b64_tr_b16 v[60:61], v14 offset:61440
  ds_read_b64_tr_b16 v[62:63], v14 offset:62464
  s_waitcnt lgkmcnt(8)
  v_mfma_f32_32x32x16_bf16 v[112:127], v[44:47], v[232:235], v[112:127]
  s_waitcnt lgkmcnt(6)
  v_mfma_f32_32x32x16_bf16 v[64:79], v[48:51], v[236:239], v[64:79]
  ds_read_b64_tr_b16 v[32:33], v7 offset:24576
  ds_read_b64_tr_b16 v[34:35], v7 offset:25600
  ds_read_b64_tr_b16 v[36:37], v8 offset:24576
  s_waitcnt lgkmcnt(7)
  v_mfma_f32_32x32x16_bf16 v[80:95], v[52:55], v[236:239], v[80:95]
  ds_read_b64_tr_b16 v[38:39], v8 offset:25600
  ds_read_b64_tr_b16 v[40:41], v9 offset:24576
  ds_read_b64_tr_b16 v[42:43], v9 offset:25600
  v_mfma_f32_16x16x32_bf16 v[26:29], v[48:51], v[22:25], v[26:29]
  s_waitcnt lgkmcnt(8)
  v_mfma_f32_32x32x16_bf16 v[96:111], v[56:59], v[236:239], v[96:111]
  ds_read_b64_tr_b16 v[44:45], v10 offset:24576
  ds_read_b64_tr_b16 v[46:47], v10 offset:25600
  s_waitcnt lgkmcnt(8)
  v_mfma_f32_32x32x16_bf16 v[112:127], v[60:63], v[236:239], v[112:127]
  s_waitcnt lgkmcnt(6)
  v_mfma_f32_32x32x16_bf16 v[64:79], v[32:35], v[240:243], v[64:79]
  ds_read_b64_tr_b16 v[48:49], v7 offset:28672
  ds_read_b64_tr_b16 v[50:51], v7 offset:29696
  ds_read_b64_tr_b16 v[52:53], v8 offset:28672
  s_waitcnt lgkmcnt(7)
  v_mfma_f32_32x32x16_bf16 v[80:95], v[36:39], v[240:243], v[80:95]
  ds_read_b64_tr_b16 v[54:55], v8 offset:29696
  ds_read_b64_tr_b16 v[56:57], v9 offset:28672
  ds_read_b64_tr_b16 v[58:59], v9 offset:29696
  v_mfma_f32_16x16x32_bf16 v[26:29], v[32:35], v[22:25], v[26:29]
  s_waitcnt lgkmcnt(8)
  v_mfma_f32_32x32x16_bf16 v[96:111], v[40:43], v[240:243], v[96:111]
  ds_read_b64_tr_b16 v[60:61], v10 offset:28672
  ds_read_b64_tr_b16 v[62:63], v10 offset:29696
  s_waitcnt lgkmcnt(8)
  v_mfma_f32_32x32x16_bf16 v[112:127], v[44:47], v[240:243], v[112:127]
  s_waitcnt lgkmcnt(6)
  v_mfma_f32_32x32x16_bf16 v[64:79], v[48:51], v[244:247], v[64:79]
  ds_read_b64_tr_b16 v[32:33], v7 offset:32768
  ds_read_b64_tr_b16 v[34:35], v7 offset:33792
  ds_read_b64_tr_b16 v[36:37], v8 offset:32768
  s_waitcnt lgkmcnt(7)
  v_mfma_f32_32x32x16_bf16 v[80:95], v[52:55], v[244:247], v[80:95]
  ds_read_b64_tr_b16 v[38:39], v8 offset:33792
  ds_read_b64_tr_b16 v[40:41], v9 offset:32768
  ds_read_b64_tr_b16 v[42:43], v9 offset:33792
  v_mfma_f32_16x16x32_bf16 v[26:29], v[48:51], v[22:25], v[26:29]
  s_waitcnt lgkmcnt(8)
  v_mfma_f32_32x32x16_bf16 v[96:111], v[56:59], v[244:247], v[96:111]
  ds_read_b64_tr_b16 v[44:45], v10 offset:32768
  ds_read_b64_tr_b16 v[46:47], v10 offset:33792
  s_waitcnt lgkmcnt(8)
  v_mfma_f32_32x32x16_bf16 v[112:127], v[60:63], v[244:247], v[112:127]
  s_waitcnt lgkmcnt(6)
  v_mfma_f32_32x32x16_bf16 v[64:79], v[32:35], v[248:251], v[64:79]
  ds_read_b64_tr_b16 v[48:49], v7 offset:36864
  ds_read_b64_tr_b16 v[50:51], v7 offset:37888
  ds_read_b64_tr_b16 v[52:53], v8 offset:36864
  s_waitcnt lgkmcnt(7)
  v_mfma_f32_32x32x16_bf16 v[80:95], v[36:39], v[248:251], v[80:95]
  ds_read_b64_tr_b16 v[54:55], v8 offset:37888
  ds_read_b64_tr_b16 v[56:57], v9 offset:36864
  ds_read_b64_tr_b16 v[58:59], v9 offset:37888
  v_mfma_f32_16x16x32_bf16 v[26:29], v[32:35], v[22:25], v[26:29]
  s_waitcnt lgkmcnt(8)
  v_mfma_f32_32x32x16_bf16 v[96:111], v[40:43], v[248:251], v[96:111]
  ds_read_b64_tr_b16 v[60:61], v10 offset:36864
  ds_read_b64_tr_b16 v[62:63], v10 offset:37888
  s_waitcnt lgkmcnt(8)
  v_mfma_f32_32x32x16_bf16 v[112:127], v[44:47], v[248:251], v[112:127]
  s_waitcnt lgkmcnt(6)
  v_mfma_f32_32x32x16_bf16 v[64:79], v[48:51], v[252:255], v[64:79]
  s_waitcnt lgkmcnt(4)
  v_mfma_f32_32x32x16_bf16 v[80:95], v[52:55], v[252:255], v[80:95]
  v_mfma_f32_16x16x32_bf16 v[26:29], v[48:51], v[22:25], v[26:29]
  s_waitcnt lgkmcnt(2)
  v_mfma_f32_32x32x16_bf16 v[96:111], v[56:59], v[252:255], v[96:111]
  s_waitcnt lgkmcnt(0)
  v_mfma_f32_32x32x16_bf16 v[112:127], v[60:63], v[252:255], v[112:127]
  v_and_b32 v2, 1, v1
  v_lshlrev_b32 v2, 6, v2
  v_lshrrev_b32 v3, 4, v1
  v_lshl_add_u32 v2, v3, 4, v2
  s_lshl_b32 s43, s37, 7
  s_add_u32 s43, s43, 158208
  v_add_u32 v2, s43, v2
  s_nop 4
  s_mov_b64 exec, s[4:5]
  ds_write_b128 v2, v[26:29]
  s_mov_b64 exec, -1

  ds_write_b32 v5, v31 offset:64
  ds_write_b32 v5, v31 offset:64
L_k1_fp_30:
  ds_read_b128 v[128:131], v21 offset:64
  s_waitcnt lgkmcnt(0)
  v_and_b32 v2, v128, v129
  v_and_b32 v4, v130, v131
  v_and_b32 v2, v2, v4
  s_nop 0
  v_readfirstlane_b32 s43, v2
  s_nop 3
  s_cmp_eq_u32 s43, 0
  s_cbranch_scc1 L_k1_fp_30

L_k1_tdry:
  v_lshrrev_b32 v3, 5, v1
  s_lshl_b32 s43, s37, 7
  v_lshl_add_u32 v3, v3, 4, s43

  v_xor_b32 v2, 0, v3
  v_add_u32 v160, 158208, v2
  v_add_u32 v161, 158240, v2
  v_add_u32 v162, 158272, v2
  v_add_u32 v163, 158304, v2
  s_cbranch_execz L_k1_gm_31
  ds_read_b128 v[192:195], v160
  ds_read_b128 v[196:199], v161
  ds_read_b128 v[200:203], v162
  ds_read_b128 v[204:207], v163
L_k1_gm_31:
  v_xor_b32 v2, 128, v3
  v_add_u32 v164, 158208, v2
  v_add_u32 v165, 158240, v2
  v_add_u32 v166, 158272, v2
  v_add_u32 v167, 158304, v2
  s_cbranch_execz L_k1_gm_32
  ds_read_b128 v[208:211], v164
  ds_read_b128 v[212:215], v165
  ds_read_b128 v[216:219], v166
  ds_read_b128 v[220:223], v167
L_k1_gm_32:
  v_xor_b32 v2, 256, v3
  v_add_u32 v168, 158208, v2
  v_add_u32 v169, 158240, v2
  v_add_u32 v170, 158272, v2
  v_add_u32 v171, 158304, v2
  s_cbranch_execz L_k1_gm_33
  ds_read_b128 v[224:227], v168
  ds_read_b128 v[228:231], v169
  ds_read_b128 v[232:235], v170
  ds_read_b128 v[236:239], v171
L_k1_gm_33:
  v_xor_b32 v2, 384, v3
  v_add_u32 v172, 158208, v2
  v_add_u32 v173, 158240, v2
  v_add_u32 v174, 158272, v2
  v_add_u32 v175, 158304, v2
  s_waitcnt lgkmcnt(11)
  s_cbranch_execz L_k1_gm_34
  ds_read_b128 v[240:243], v172
  ds_read_b128 v[244:247], v173
  ds_read_b128 v[248:251], v174
  ds_read_b128 v[252:255], v175
L_k1_gm_34:
  s_lshl_b32 s59, s41, 19
  s_lshl_b32 s43, s56, 10
  s_add_u32 s59, s59, s43
  s_cmp_lt_u32 s41, 4
  s_cselect_b32 s52, 0x3eb8aa3b, 1.0
  v_mul_f32 v160, s52, v30
  v_mul_f32 v162, s52, v0

  s_waitcnt lgkmcnt(14)
  v_pk_mul_f32 v[192:193], v[192:193], v[160:161] op_sel_hi:[1,0]
  v_pk_mul_f32 v[194:195], v[194:195], v[160:161] op_sel_hi:[1,0]
  v_pk_mul_f32 v[196:197], v[196:197], v[160:161] op_sel_hi:[1,0]
  v_pk_mul_f32 v[198:199], v[198:199], v[160:161] op_sel_hi:[1,0]
  v_pk_fma_f32 v[64:65], v[64:65], v[162:163], v[192:193] op_sel_hi:[1,0,1]
  v_pk_fma_f32 v[66:67], v[66:67], v[162:163], v[194:195] op_sel_hi:[1,0,1]
  v_pk_fma_f32 v[68:69], v[68:69], v[162:163], v[196:197] op_sel_hi:[1,0,1]
  v_pk_fma_f32 v[70:71], v[70:71], v[162:163], v[198:199] op_sel_hi:[1,0,1]
  v_cvt_pk_bf16_f32 v128, v64, v65
  v_cvt_pk_bf16_f32 v129, v66, v67
  v_cvt_pk_bf16_f32 v130, v68, v69
  v_cvt_pk_bf16_f32 v131, v70, v71
  s_xor_b32 s43, s37, 0
  s_lshl_b32 s43, s43, 17
  s_add_u32 s43, s43, s59
  s_cbranch_execz L_k1_gm_35
  buffer_store_dwordx4 v[128:131], v19, s[24:27], s43 offen sc1
L_k1_gm_35:
  s_waitcnt lgkmcnt(12)
  v_pk_mul_f32 v[200:201], v[200:201], v[160:161] op_sel_hi:[1,0]
  v_pk_mul_f32 v[202:203], v[202:203], v[160:161] op_sel_hi:[1,0]
  v_pk_mul_f32 v[204:205], v[204:205], v[160:161] op_sel_hi:[1,0]
  v_pk_mul_f32 v[206:207], v[206:207], v[160:161] op_sel_hi:[1,0]
  v_pk_fma_f32 v[72:73], v[72:73], v[162:163], v[200:201] op_sel_hi:[1,0,1]
  v_pk_fma_f32 v[74:75], v[74:75], v[162:163], v[202:203] op_sel_hi:[1,0,1]
  v_pk_fma_f32 v[76:77], v[76:77], v[162:163], v[204:205] op_sel_hi:[1,0,1]
  v_pk_fma_f32 v[78:79], v[78:79], v[162:163], v[206:207] op_sel_hi:[1,0,1]
  v_cvt_pk_bf16_f32 v132, v72, v73
  v_cvt_pk_bf16_f32 v133, v74, v75
  v_cvt_pk_bf16_f32 v134, v76, v77
  v_cvt_pk_bf16_f32 v135, v78, v79
  s_add_u32 s43, s43, 65536
  s_cbranch_execz L_k1_gm_36
  buffer_store_dwordx4 v[132:135], v19, s[24:27], s43 offen sc1
L_k1_gm_36:
  s_waitcnt lgkmcnt(10)
  v_pk_mul_f32 v[208:209], v[208:209], v[160:161] op_sel_hi:[1,0]
  v_pk_mul_f32 v[210:211], v[210:211], v[160:161] op_sel_hi:[1,0]
  v_pk_mul_f32 v[212:213], v[212:213], v[160:161] op_sel_hi:[1,0]
  v_pk_mul_f32 v[214:215], v[214:215], v[160:161] op_sel_hi:[1,0]
  v_pk_fma_f32 v[80:81], v[80:81], v[162:163], v[208:209] op_sel_hi:[1,0,1]
  v_pk_fma_f32 v[82:83], v[82:83], v[162:163], v[210:211] op_sel_hi:[1,0,1]
  v_pk_fma_f32 v[84:85], v[84:85], v[162:163], v[212:213] op_sel_hi:[1,0,1]
  v_pk_fma_f32 v[86:87], v[86:87], v[162:163], v[214:215] op_sel_hi:[1,0,1]
  v_cvt_pk_bf16_f32 v136, v80, v81
  v_cvt_pk_bf16_f32 v137, v82, v83
  v_cvt_pk_bf16_f32 v138, v84, v85
  v_cvt_pk_bf16_f32 v139, v86, v87
  s_xor_b32 s43, s37, 1
  s_lshl_b32 s43, s43, 17
  s_add_u32 s43, s43, s59
  s_cbranch_execz L_k1_gm_37
  buffer_store_dwordx4 v[136:139], v19, s[24:27], s43 offen sc1
L_k1_gm_37:
  s_waitcnt lgkmcnt(8)
  v_pk_mul_f32 v[216:217], v[216:217], v[160:161] op_sel_hi:[1,0]
  v_pk_mul_f32 v[218:219], v[218:219], v[160:161] op_sel_hi:[1,0]
  v_pk_mul_f32 v[220:221], v[220:221], v[160:161] op_sel_hi:[1,0]
  v_pk_mul_f32 v[222:223], v[222:223], v[160:161] op_sel_hi:[1,0]
  v_pk_fma_f32 v[88:89], v[88:89], v[162:163], v[216:217] op_sel_hi:[1,0,1]
  v_pk_fma_f32 v[90:91], v[90:91], v[162:163], v[218:219] op_sel_hi:[1,0,1]
  v_pk_fma_f32 v[92:93], v[92:93], v[162:163], v[220:221] op_sel_hi:[1,0,1]
  v_pk_fma_f32 v[94:95], v[94:95], v[162:163], v[222:223] op_sel_hi:[1,0,1]
  v_cvt_pk_bf16_f32 v140, v88, v89
  v_cvt_pk_bf16_f32 v141, v90, v91
  v_cvt_pk_bf16_f32 v142, v92, v93
  v_cvt_pk_bf16_f32 v143, v94, v95
  s_add_u32 s43, s43, 65536
  s_cbranch_execz L_k1_gm_38
  buffer_store_dwordx4 v[140:143], v19, s[24:27], s43 offen sc1
L_k1_gm_38:
  s_waitcnt lgkmcnt(6)
  v_pk_mul_f32 v[224:225], v[224:225], v[160:161] op_sel_hi:[1,0]
  v_pk_mul_f32 v[226:227], v[226:227], v[160:161] op_sel_hi:[1,0]
  v_pk_mul_f32 v[228:229], v[228:229], v[160:161] op_sel_hi:[1,0]
  v_pk_mul_f32 v[230:231], v[230:231], v[160:161] op_sel_hi:[1,0]
  v_pk_fma_f32 v[96:97], v[96:97], v[162:163], v[224:225] op_sel_hi:[1,0,1]
  v_pk_fma_f32 v[98:99], v[98:99], v[162:163], v[226:227] op_sel_hi:[1,0,1]
  v_pk_fma_f32 v[100:101], v[100:101], v[162:163], v[228:229] op_sel_hi:[1,0,1]
  v_pk_fma_f32 v[102:103], v[102:103], v[162:163], v[230:231] op_sel_hi:[1,0,1]
  v_cvt_pk_bf16_f32 v144, v96, v97
  v_cvt_pk_bf16_f32 v145, v98, v99
  v_cvt_pk_bf16_f32 v146, v100, v101
  v_cvt_pk_bf16_f32 v147, v102, v103
  s_xor_b32 s43, s37, 2
  s_lshl_b32 s43, s43, 17
  s_add_u32 s43, s43, s59
  s_cbranch_execz L_k1_gm_39
  buffer_store_dwordx4 v[144:147], v19, s[24:27], s43 offen sc1
L_k1_gm_39:
  s_waitcnt lgkmcnt(4)
  v_pk_mul_f32 v[232:233], v[232:233], v[160:161] op_sel_hi:[1,0]
  v_pk_mul_f32 v[234:235], v[234:235], v[160:161] op_sel_hi:[1,0]
  v_pk_mul_f32 v[236:237], v[236:237], v[160:161] op_sel_hi:[1,0]
  v_pk_mul_f32 v[238:239], v[238:239], v[160:161] op_sel_hi:[1,0]
  v_pk_fma_f32 v[104:105], v[104:105], v[162:163], v[232:233] op_sel_hi:[1,0,1]
  v_pk_fma_f32 v[106:107], v[106:107], v[162:163], v[234:235] op_sel_hi:[1,0,1]
  v_pk_fma_f32 v[108:109], v[108:109], v[162:163], v[236:237] op_sel_hi:[1,0,1]
  v_pk_fma_f32 v[110:111], v[110:111], v[162:163], v[238:239] op_sel_hi:[1,0,1]
  v_cvt_pk_bf16_f32 v148, v104, v105
  v_cvt_pk_bf16_f32 v149, v106, v107
  v_cvt_pk_bf16_f32 v150, v108, v109
  v_cvt_pk_bf16_f32 v151, v110, v111
  s_add_u32 s43, s43, 65536
  s_cbranch_execz L_k1_gm_40
  buffer_store_dwordx4 v[148:151], v19, s[24:27], s43 offen sc1
L_k1_gm_40:
  s_waitcnt lgkmcnt(2)
  v_pk_mul_f32 v[240:241], v[240:241], v[160:161] op_sel_hi:[1,0]
  v_pk_mul_f32 v[242:243], v[242:243], v[160:161] op_sel_hi:[1,0]
  v_pk_mul_f32 v[244:245], v[244:245], v[160:161] op_sel_hi:[1,0]
  v_pk_mul_f32 v[246:247], v[246:247], v[160:161] op_sel_hi:[1,0]
  v_pk_fma_f32 v[112:113], v[112:113], v[162:163], v[240:241] op_sel_hi:[1,0,1]
  v_pk_fma_f32 v[114:115], v[114:115], v[162:163], v[242:243] op_sel_hi:[1,0,1]
  v_pk_fma_f32 v[116:117], v[116:117], v[162:163], v[244:245] op_sel_hi:[1,0,1]
  v_pk_fma_f32 v[118:119], v[118:119], v[162:163], v[246:247] op_sel_hi:[1,0,1]
  v_cvt_pk_bf16_f32 v152, v112, v113
  v_cvt_pk_bf16_f32 v153, v114, v115
  v_cvt_pk_bf16_f32 v154, v116, v117
  v_cvt_pk_bf16_f32 v155, v118, v119
  s_xor_b32 s43, s37, 3
  s_lshl_b32 s43, s43, 17
  s_add_u32 s43, s43, s59
  s_cbranch_execz L_k1_gm_41
  buffer_store_dwordx4 v[152:155], v19, s[24:27], s43 offen sc1
L_k1_gm_41:
  s_waitcnt lgkmcnt(0)
  v_pk_mul_f32 v[248:249], v[248:249], v[160:161] op_sel_hi:[1,0]
  v_pk_mul_f32 v[250:251], v[250:251], v[160:161] op_sel_hi:[1,0]
  v_pk_mul_f32 v[252:253], v[252:253], v[160:161] op_sel_hi:[1,0]
  v_pk_mul_f32 v[254:255], v[254:255], v[160:161] op_sel_hi:[1,0]
  v_pk_fma_f32 v[120:121], v[120:121], v[162:163], v[248:249] op_sel_hi:[1,0,1]
  v_pk_fma_f32 v[122:123], v[122:123], v[162:163], v[250:251] op_sel_hi:[1,0,1]
  v_pk_fma_f32 v[124:125], v[124:125], v[162:163], v[252:253] op_sel_hi:[1,0,1]
  v_pk_fma_f32 v[126:127], v[126:127], v[162:163], v[254:255] op_sel_hi:[1,0,1]
  v_cvt_pk_bf16_f32 v156, v120, v121
  v_cvt_pk_bf16_f32 v157, v122, v123
  v_cvt_pk_bf16_f32 v158, v124, v125
  v_cvt_pk_bf16_f32 v159, v126, v127
  s_add_u32 s43, s43, 65536
  s_cbranch_execz L_k1_gm_42
  buffer_store_dwordx4 v[156:159], v19, s[24:27], s43 offen sc1
L_k1_gm_42:
  s_cbranch_execz L_k1_qret
  s_endpgm
L_k1_vtype:
  ds_read_b64_tr_b16 v[32:33], v11 offset:0
  ds_read_b64_tr_b16 v[34:35], v11 offset:1024
  ds_read_b64_tr_b16 v[36:37], v12 offset:0
  ds_read_b64_tr_b16 v[38:39], v12 offset:1024
  ds_read_b64_tr_b16 v[40:41], v13 offset:0
  ds_read_b64_tr_b16 v[42:43], v13 offset:1024
  ds_read_b64_tr_b16 v[44:45], v14 offset:0
  ds_read_b64_tr_b16 v[46:47], v14 offset:1024
  s_waitcnt lgkmcnt(6)
  v_mfma_f32_32x32x16_bf16 v[64:79], v[128:131], v[32:35], 0
  ds_read_b64_tr_b16 v[48:49], v11 offset:4096
  ds_read_b64_tr_b16 v[50:51], v11 offset:5120
  ds_read_b64_tr_b16 v[52:53], v12 offset:4096
  s_add_u32 m0, s55, 114688
  s_add_u32 s88, s54, 12288
  buffer_load_dwordx4 v6, s[20:23], s54 offen lds
  s_waitcnt lgkmcnt(7)
  v_mfma_f32_32x32x16_bf16 v[80:95], v[128:131], v[36:39], 0
  ds_read_b64_tr_b16 v[54:55], v12 offset:5120
  ds_read_b64_tr_b16 v[56:57], v13 offset:4096
  ds_read_b64_tr_b16 v[58:59], v13 offset:5120
  v_mfma_f32_16x16x32_bf16 v[26:29], v[32:35], v[22:25], v[26:29]
  s_waitcnt lgkmcnt(8)
  v_mfma_f32_32x32x16_bf16 v[96:111], v[128:131], v[40:43], 0
  ds_read_b64_tr_b16 v[60:61], v14 offset:4096
  ds_read_b64_tr_b16 v[62:63], v14 offset:5120
  s_add_u32 m0, s55, 115712
  s_add_u32 s87, s54, 98304
  buffer_load_dwordx4 v6, s[20:23], s88 offen lds
  s_sub_u32 s54, s87, 1572864
  s_cmp_lt_u32 s87, s84
  s_cselect_b32 s54, s87, s54
  s_waitcnt lgkmcnt(8)
  v_mfma_f32_32x32x16_bf16 v[112:127], v[128:131], v[44:47], 0
  s_waitcnt lgkmcnt(6)
  v_mfma_f32_32x32x16_bf16 v[64:79], v[132:135], v[48:51], v[64:79]
  ds_read_b64_tr_b16 v[32:33], v11 offset:8192
  ds_read_b64_tr_b16 v[34:35], v11 offset:9216
  ds_read_b64_tr_b16 v[36:37], v12 offset:8192
  s_add_u32 m0, s55, 122880
  s_add_u32 s88, s54, 12288
  buffer_load_dwordx4 v6, s[20:23], s54 offen lds
  s_waitcnt lgkmcnt(7)
  v_mfma_f32_32x32x16_bf16 v[80:95], v[132:135], v[52:55], v[80:95]
  ds_read_b64_tr_b16 v[38:39], v12 offset:9216
  ds_read_b64_tr_b16 v[40:41], v13 offset:8192
  ds_read_b64_tr_b16 v[42:43], v13 offset:9216
  v_mfma_f32_16x16x32_bf16 v[26:29], v[48:51], v[22:25], v[26:29]
  s_waitcnt lgkmcnt(8)
  v_mfma_f32_32x32x16_bf16 v[96:111], v[132:135], v[56:59], v[96:111]
  ds_read_b64_tr_b16 v[44:45], v14 offset:8192
  ds_read_b64_tr_b16 v[46:47], v14 offset:9216
  s_add_u32 m0, s55, 123904
  s_add_u32 s87, s54, 98304
  buffer_load_dwordx4 v6, s[20:23], s88 offen lds
  s_sub_u32 s54, s87, 1572864
  s_cmp_lt_u32 s87, s84
  s_cselect_b32 s54, s87, s54
  s_waitcnt lgkmcnt(8)
  v_mfma_f32_32x32x16_bf16 v[112:127], v[132:135], v[60:63], v[112:127]
  s_waitcnt lgkmcnt(6)
  v_mfma_f32_32x32x16_bf16 v[64:79], v[136:139], v[32:35], v[64:79]
  ds_read_b64_tr_b16 v[48:49], v11 offset:12288
  ds_read_b64_tr_b16 v[50:51], v11 offset:13312
  ds_read_b64_tr_b16 v[52:53], v12 offset:12288
  s_add_u32 m0, s55, 24576
  s_add_u32 s88, s54, 12288
  buffer_load_dwordx4 v6, s[20:23], s54 offen lds
  s_waitcnt lgkmcnt(7)
  v_mfma_f32_32x32x16_bf16 v[80:95], v[136:139], v[36:39], v[80:95]
  ds_read_b64_tr_b16 v[54:55], v12 offset:13312
  ds_read_b64_tr_b16 v[56:57], v13 offset:12288
  ds_read_b64_tr_b16 v[58:59], v13 offset:13312
  v_mfma_f32_16x16x32_bf16 v[26:29], v[32:35], v[22:25], v[26:29]
  s_waitcnt lgkmcnt(8)
  v_mfma_f32_32x32x16_bf16 v[96:111], v[136:139], v[40:43], v[96:111]
  ds_read_b64_tr_b16 v[60:61], v14 offset:12288
  ds_read_b64_tr_b16 v[62:63], v14 offset:13312
  s_add_u32 m0, s55, 25600
  s_add_u32 s87, s54, 98304
  buffer_load_dwordx4 v6, s[20:23], s88 offen lds
  s_sub_u32 s54, s87, 1572864
  s_cmp_lt_u32 s87, s84
  s_cselect_b32 s54, s87, s54
  s_waitcnt lgkmcnt(8)
  v_mfma_f32_32x32x16_bf16 v[112:127], v[136:139], v[44:47], v[112:127]
  s_waitcnt lgkmcnt(6)
  v_mfma_f32_32x32x16_bf16 v[64:79], v[140:143], v[48:51], v[64:79]
  ds_read_b64_tr_b16 v[32:33], v15 offset:0
  ds_read_b64_tr_b16 v[34:35], v15 offset:1024
  ds_read_b64_tr_b16 v[36:37], v16 offset:0
  s_add_u32 m0, s55, 32768
  s_add_u32 s88, s54, 12288
  buffer_load_dwordx4 v6, s[20:23], s54 offen lds
  s_waitcnt lgkmcnt(7)
  v_mfma_f32_32x32x16_bf16 v[80:95], v[140:143], v[52:55], v[80:95]
  ds_read_b64_tr_b16 v[38:39], v16 offset:1024
  ds_read_b64_tr_b16 v[40:41], v17 offset:0
  ds_read_b64_tr_b16 v[42:43], v17 offset:1024
  v_mfma_f32_16x16x32_bf16 v[26:29], v[48:51], v[22:25], v[26:29]
  s_waitcnt lgkmcnt(8)
  v_mfma_f32_32x32x16_bf16 v[96:111], v[140:143], v[56:59], v[96:111]
  ds_read_b64_tr_b16 v[44:45], v18 offset:0
  ds_read_b64_tr_b16 v[46:47], v18 offset:1024
  s_add_u32 m0, s55, 33792
  s_add_u32 s87, s54, 98304
  buffer_load_dwordx4 v6, s[20:23], s88 offen lds
  s_sub_u32 s54, s87, 1572864
  s_cmp_lt_u32 s87, s84
  s_cselect_b32 s54, s87, s54
  s_waitcnt lgkmcnt(8)
  v_mfma_f32_32x32x16_bf16 v[112:127], v[140:143], v[60:63], v[112:127]
  s_waitcnt lgkmcnt(6)
  v_mfma_f32_32x32x16_bf16 v[64:79], v[144:147], v[32:35], v[64:79]
  ds_read_b64_tr_b16 v[48:49], v15 offset:4096
  ds_read_b64_tr_b16 v[50:51], v15 offset:5120
  ds_read_b64_tr_b16 v[52:53], v16 offset:4096
  s_waitcnt lgkmcnt(7)
  v_mfma_f32_32x32x16_bf16 v[80:95], v[144:147], v[36:39], v[80:95]
  ds_read_b64_tr_b16 v[54:55], v16 offset:5120
  ds_read_b64_tr_b16 v[56:57], v17 offset:4096
  ds_read_b64_tr_b16 v[58:59], v17 offset:5120
  v_mfma_f32_16x16x32_bf16 v[26:29], v[32:35], v[22:25], v[26:29]
  s_waitcnt lgkmcnt(8)
  v_mfma_f32_32x32x16_bf16 v[96:111], v[144:147], v[40:43], v[96:111]
  ds_read_b64_tr_b16 v[60:61], v18 offset:4096
  ds_read_b64_tr_b16 v[62:63], v18 offset:5120
  s_waitcnt lgkmcnt(8)
  v_mfma_f32_32x32x16_bf16 v[112:127], v[144:147], v[44:47], v[112:127]
  s_waitcnt lgkmcnt(6)
  v_mfma_f32_32x32x16_bf16 v[64:79], v[148:151], v[48:51], v[64:79]
  ds_read_b64_tr_b16 v[32:33], v15 offset:8192
  ds_read_b64_tr_b16 v[34:35], v15 offset:9216
  ds_read_b64_tr_b16 v[36:37], v16 offset:8192
  s_waitcnt lgkmcnt(7)
  v_mfma_f32_32x32x16_bf16 v[80:95], v[148:151], v[52:55], v[80:95]
  ds_read_b64_tr_b16 v[38:39], v16 offset:9216
  ds_read_b64_tr_b16 v[40:41], v17 offset:8192
  ds_read_b64_tr_b16 v[42:43], v17 offset:9216
  v_mfma_f32_16x16x32_bf16 v[26:29], v[48:51], v[22:25], v[26:29]
  s_waitcnt lgkmcnt(8)
  v_mfma_f32_32x32x16_bf16 v[96:111], v[148:151], v[56:59], v[96:111]
  ds_read_b64_tr_b16 v[44:45], v18 offset:8192
  ds_read_b64_tr_b16 v[46:47], v18 offset:9216
  s_waitcnt lgkmcnt(8)
  v_mfma_f32_32x32x16_bf16 v[112:127], v[148:151], v[60:63], v[112:127]
  s_waitcnt lgkmcnt(6)
  v_mfma_f32_32x32x16_bf16 v[64:79], v[152:155], v[32:35], v[64:79]
  ds_read_b64_tr_b16 v[48:49], v15 offset:12288
  ds_read_b64_tr_b16 v[50:51], v15 offset:13312
  ds_read_b64_tr_b16 v[52:53], v16 offset:12288
  s_waitcnt lgkmcnt(7)
  v_mfma_f32_32x32x16_bf16 v[80:95], v[152:155], v[36:39], v[80:95]
  ds_read_b64_tr_b16 v[54:55], v16 offset:13312
  ds_read_b64_tr_b16 v[56:57], v17 offset:12288
  ds_read_b64_tr_b16 v[58:59], v17 offset:13312
  v_mfma_f32_16x16x32_bf16 v[26:29], v[32:35], v[22:25], v[26:29]
  s_waitcnt lgkmcnt(8)
  v_mfma_f32_32x32x16_bf16 v[96:111], v[152:155], v[40:43], v[96:111]
  ds_read_b64_tr_b16 v[60:61], v18 offset:12288
  ds_read_b64_tr_b16 v[62:63], v18 offset:13312
  s_waitcnt lgkmcnt(8)
  v_mfma_f32_32x32x16_bf16 v[112:127], v[152:155], v[44:47], v[112:127]
  s_waitcnt lgkmcnt(6)
  v_mfma_f32_32x32x16_bf16 v[64:79], v[156:159], v[48:51], v[64:79]
  s_waitcnt vmcnt(16)
  ds_write_b32 v5, v31 offset:16
L_k1_fp_43:
  ds_read_b128 v[128:131], v21 offset:16
  s_waitcnt lgkmcnt(0)
  v_and_b32 v2, v128, v129
  v_and_b32 v4, v130, v131
  v_and_b32 v2, v2, v4
  s_nop 0
  v_readfirstlane_b32 s43, v2
  s_nop 3
  s_cmp_eq_u32 s43, 0
  s_cbranch_scc1 L_k1_fp_43

  ds_read_b64_tr_b16 v[32:33], v11 offset:16384
  ds_read_b64_tr_b16 v[34:35], v11 offset:17408
  ds_read_b64_tr_b16 v[36:37], v12 offset:16384
  v_mfma_f32_32x32x16_bf16 v[80:95], v[156:159], v[52:55], v[80:95]
  ds_read_b64_tr_b16 v[38:39], v12 offset:17408
  ds_read_b64_tr_b16 v[40:41], v13 offset:16384
  ds_read_b64_tr_b16 v[42:43], v13 offset:17408
  v_mfma_f32_16x16x32_bf16 v[26:29], v[48:51], v[22:25], v[26:29]
  v_mfma_f32_32x32x16_bf16 v[96:111], v[156:159], v[56:59], v[96:111]
  ds_read_b64_tr_b16 v[44:45], v14 offset:16384
  ds_read_b64_tr_b16 v[46:47], v14 offset:17408
  v_mfma_f32_32x32x16_bf16 v[112:127], v[156:159], v[60:63], v[112:127]
  s_waitcnt lgkmcnt(6)
  v_mfma_f32_32x32x16_bf16 v[64:79], v[160:163], v[32:35], v[64:79]
  ds_read_b64_tr_b16 v[48:49], v11 offset:20480
  ds_read_b64_tr_b16 v[50:51], v11 offset:21504
  ds_read_b64_tr_b16 v[52:53], v12 offset:20480
  s_waitcnt lgkmcnt(7)
  v_mfma_f32_32x32x16_bf16 v[80:95], v[160:163], v[36:39], v[80:95]
  ds_read_b64_tr_b16 v[54:55], v12 offset:21504
  ds_read_b64_tr_b16 v[56:57], v13 offset:20480
  ds_read_b64_tr_b16 v[58:59], v13 offset:21504
  v_mfma_f32_16x16x32_bf16 v[26:29], v[32:35], v[22:25], v[26:29]
  s_waitcnt lgkmcnt(8)
  v_mfma_f32_32x32x16_bf16 v[96:111], v[160:163], v[40:43], v[96:111]
  ds_read_b64_tr_b16 v[60:61], v14 offset:20480
  ds_read_b64_tr_b16 v[62:63], v14 offset:21504
  s_waitcnt lgkmcnt(8)
  v_mfma_f32_32x32x16_bf16 v[112:127], v[160:163], v[44:47], v[112:127]
  s_waitcnt lgkmcnt(6)
  v_mfma_f32_32x32x16_bf16 v[64:79], v[164:167], v[48:51], v[64:79]
  ds_read_b64_tr_b16 v[32:33], v11 offset:24576
  ds_read_b64_tr_b16 v[34:35], v11 offset:25600
  ds_read_b64_tr_b16 v[36:37], v12 offset:24576
  s_waitcnt lgkmcnt(7)
  v_mfma_f32_32x32x16_bf16 v[80:95], v[164:167], v[52:55], v[80:95]
  ds_read_b64_tr_b16 v[38:39], v12 offset:25600
  ds_read_b64_tr_b16 v[40:41], v13 offset:24576
  ds_read_b64_tr_b16 v[42:43], v13 offset:25600
  v_mfma_f32_16x16x32_bf16 v[26:29], v[48:51], v[22:25], v[26:29]
  s_waitcnt lgkmcnt(8)
  v_mfma_f32_32x32x16_bf16 v[96:111], v[164:167], v[56:59], v[96:111]
  ds_read_b64_tr_b16 v[44:45], v14 offset:24576
  ds_read_b64_tr_b16 v[46:47], v14 offset:25600
  s_waitcnt lgkmcnt(8)
  v_mfma_f32_32x32x16_bf16 v[112:127], v[164:167], v[60:63], v[112:127]
  s_waitcnt lgkmcnt(6)
  v_mfma_f32_32x32x16_bf16 v[64:79], v[168:171], v[32:35], v[64:79]
  ds_read_b64_tr_b16 v[48:49], v11 offset:28672
  ds_read_b64_tr_b16 v[50:51], v11 offset:29696
  ds_read_b64_tr_b16 v[52:53], v12 offset:28672
  s_waitcnt lgkmcnt(7)
  v_mfma_f32_32x32x16_bf16 v[80:95], v[168:171], v[36:39], v[80:95]
  ds_read_b64_tr_b16 v[54:55], v12 offset:29696
  ds_read_b64_tr_b16 v[56:57], v13 offset:28672
  ds_read_b64_tr_b16 v[58:59], v13 offset:29696
  v_mfma_f32_16x16x32_bf16 v[26:29], v[32:35], v[22:25], v[26:29]
  s_waitcnt lgkmcnt(8)
  v_mfma_f32_32x32x16_bf16 v[96:111], v[168:171], v[40:43], v[96:111]
  ds_read_b64_tr_b16 v[60:61], v14 offset:28672
  ds_read_b64_tr_b16 v[62:63], v14 offset:29696
  s_waitcnt lgkmcnt(8)
  v_mfma_f32_32x32x16_bf16 v[112:127], v[168:171], v[44:47], v[112:127]
  s_waitcnt lgkmcnt(6)
  v_mfma_f32_32x32x16_bf16 v[64:79], v[172:175], v[48:51], v[64:79]
  ds_read_b64_tr_b16 v[32:33], v15 offset:16384
  ds_read_b64_tr_b16 v[34:35], v15 offset:17408
  ds_read_b64_tr_b16 v[36:37], v16 offset:16384
  s_waitcnt lgkmcnt(7)
  v_mfma_f32_32x32x16_bf16 v[80:95], v[172:175], v[52:55], v[80:95]
  ds_read_b64_tr_b16 v[38:39], v16 offset:17408
  ds_read_b64_tr_b16 v[40:41], v17 offset:16384
  ds_read_b64_tr_b16 v[42:43], v17 offset:17408
  v_mfma_f32_16x16x32_bf16 v[26:29], v[48:51], v[22:25], v[26:29]
  s_waitcnt lgkmcnt(8)
  v_mfma_f32_32x32x16_bf16 v[96:111], v[172:175], v[56:59], v[96:111]
  ds_read_b64_tr_b16 v[44:45], v18 offset:16384
  ds_read_b64_tr_b16 v[46:47], v18 offset:17408
  s_waitcnt lgkmcnt(8)
  v_mfma_f32_32x32x16_bf16 v[112:127], v[172:175], v[60:63], v[112:127]
  s_waitcnt lgkmcnt(6)
  v_mfma_f32_32x32x16_bf16 v[64:79], v[176:179], v[32:35], v[64:79]
  ds_read_b64_tr_b16 v[48:49], v15 offset:20480
  ds_read_b64_tr_b16 v[50:51], v15 offset:21504
  ds_read_b64_tr_b16 v[52:53], v16 offset:20480
  s_waitcnt lgkmcnt(7)
  v_mfma_f32_32x32x16_bf16 v[80:95], v[176:179], v[36:39], v[80:95]
  ds_read_b64_tr_b16 v[54:55], v16 offset:21504
  ds_read_b64_tr_b16 v[56:57], v17 offset:20480
  ds_read_b64_tr_b16 v[58:59], v17 offset:21504
  v_mfma_f32_16x16x32_bf16 v[26:29], v[32:35], v[22:25], v[26:29]
  s_waitcnt lgkmcnt(8)
  v_mfma_f32_32x32x16_bf16 v[96:111], v[176:179], v[40:43], v[96:111]
  ds_read_b64_tr_b16 v[60:61], v18 offset:20480
  ds_read_b64_tr_b16 v[62:63], v18 offset:21504
  s_waitcnt lgkmcnt(8)
  v_mfma_f32_32x32x16_bf16 v[112:127], v[176:179], v[44:47], v[112:127]
  s_waitcnt lgkmcnt(6)
  v_mfma_f32_32x32x16_bf16 v[64:79], v[180:183], v[48:51], v[64:79]
  ds_read_b64_tr_b16 v[32:33], v7 offset:0
  ds_read_b64_tr_b16 v[34:35], v7 offset:1024
  ds_read_b64_tr_b16 v[36:37], v8 offset:0
  s_waitcnt lgkmcnt(7)
  v_mfma_f32_32x32x16_bf16 v[80:95], v[180:183], v[52:55], v[80:95]
  ds_read_b64_tr_b16 v[38:39], v8 offset:1024
  ds_read_b64_tr_b16 v[40:41], v9 offset:0
  ds_read_b64_tr_b16 v[42:43], v9 offset:1024
  v_mfma_f32_16x16x32_bf16 v[26:29], v[48:51], v[22:25], v[26:29]
  s_waitcnt lgkmcnt(8)
  v_mfma_f32_32x32x16_bf16 v[96:111], v[180:183], v[56:59], v[96:111]
  ds_read_b64_tr_b16 v[44:45], v10 offset:0
  ds_read_b64_tr_b16 v[46:47], v10 offset:1024
  s_waitcnt lgkmcnt(8)
  v_mfma_f32_32x32x16_bf16 v[112:127], v[180:183], v[60:63], v[112:127]
  s_waitcnt lgkmcnt(6)
  v_mfma_f32_32x32x16_bf16 v[64:79], v[184:187], v[32:35], v[64:79]
  ds_read_b64_tr_b16 v[48:49], v7 offset:4096
  ds_read_b64_tr_b16 v[50:51], v7 offset:5120
  ds_read_b64_tr_b16 v[52:53], v8 offset:4096
  s_waitcnt lgkmcnt(7)
  v_mfma_f32_32x32x16_bf16 v[80:95], v[184:187], v[36:39], v[80:95]
  ds_read_b64_tr_b16 v[54:55], v8 offset:5120
  ds_read_b64_tr_b16 v[56:57], v9 offset:4096
  ds_read_b64_tr_b16 v[58:59], v9 offset:5120
  v_mfma_f32_16x16x32_bf16 v[26:29], v[32:35], v[22:25], v[26:29]
  s_waitcnt lgkmcnt(8)
  v_mfma_f32_32x32x16_bf16 v[96:111], v[184:187], v[40:43], v[96:111]
  ds_read_b64_tr_b16 v[60:61], v10 offset:4096
  ds_read_b64_tr_b16 v[62:63], v10 offset:5120
  s_waitcnt lgkmcnt(8)
  v_mfma_f32_32x32x16_bf16 v[112:127], v[184:187], v[44:47], v[112:127]
  s_waitcnt lgkmcnt(6)
  v_mfma_f32_32x32x16_bf16 v[64:79], v[188:191], v[48:51], v[64:79]
  s_waitcnt vmcnt(8)
  ds_write_b32 v5, v31 offset:32
L_k1_fp_44:
  ds_read_b128 v[128:131], v21 offset:32
  s_waitcnt lgkmcnt(0)
  v_and_b32 v2, v128, v129
  v_and_b32 v4, v130, v131
  v_and_b32 v2, v2, v4
  s_nop 0
  v_readfirstlane_b32 s43, v2
  s_nop 3
  s_cmp_eq_u32 s43, 0
  s_cbranch_scc1 L_k1_fp_44

  ds_read_b64_tr_b16 v[32:33], v11 offset:32768
  ds_read_b64_tr_b16 v[34:35], v11 offset:33792
  ds_read_b64_tr_b16 v[36:37], v12 offset:32768
  v_mfma_f32_32x32x16_bf16 v[80:95], v[188:191], v[52:55], v[80:95]
  ds_read_b64_tr_b16 v[38:39], v12 offset:33792
  ds_read_b64_tr_b16 v[40:41], v13 offset:32768
  ds_read_b64_tr_b16 v[42:43], v13 offset:33792
  v_mfma_f32_16x16x32_bf16 v[26:29], v[48:51], v[22:25], v[26:29]
  v_mfma_f32_32x32x16_bf16 v[96:111], v[188:191], v[56:59], v[96:111]
  ds_read_b64_tr_b16 v[44:45], v14 offset:32768
  ds_read_b64_tr_b16 v[46:47], v14 offset:33792
  v_mfma_f32_32x32x16_bf16 v[112:127], v[188:191], v[60:63], v[112:127]
  s_waitcnt lgkmcnt(6)
  v_mfma_f32_32x32x16_bf16 v[64:79], v[192:195], v[32:35], v[64:79]
  ds_read_b64_tr_b16 v[48:49], v11 offset:36864
  ds_read_b64_tr_b16 v[50:51], v11 offset:37888
  ds_read_b64_tr_b16 v[52:53], v12 offset:36864
  s_waitcnt lgkmcnt(7)
  v_mfma_f32_32x32x16_bf16 v[80:95], v[192:195], v[36:39], v[80:95]
  ds_read_b64_tr_b16 v[54:55], v12 offset:37888
  ds_read_b64_tr_b16 v[56:57], v13 offset:36864
  ds_read_b64_tr_b16 v[58:59], v13 offset:37888
  v_mfma_f32_16x16x32_bf16 v[26:29], v[32:35], v[22:25], v[26:29]
  s_waitcnt lgkmcnt(8)
  v_mfma_f32_32x32x16_bf16 v[96:111], v[192:195], v[40:43], v[96:111]
  ds_read_b64_tr_b16 v[60:61], v14 offset:36864
  ds_read_b64_tr_b16 v[62:63], v14 offset:37888
  s_waitcnt lgkmcnt(8)
  v_mfma_f32_32x32x16_bf16 v[112:127], v[192:195], v[44:47], v[112:127]
  s_waitcnt lgkmcnt(6)
  v_mfma_f32_32x32x16_bf16 v[64:79], v[196:199], v[48:51], v[64:79]
  ds_read_b64_tr_b16 v[32:33], v11 offset:40960
  ds_read_b64_tr_b16 v[34:35], v11 offset:41984
  ds_read_b64_tr_b16 v[36:37], v12 offset:40960
  s_waitcnt lgkmcnt(7)
  v_mfma_f32_32x32x16_bf16 v[80:95], v[196:199], v[52:55], v[80:95]
  ds_read_b64_tr_b16 v[38:39], v12 offset:41984
  ds_read_b64_tr_b16 v[40:41], v13 offset:40960
  ds_read_b64_tr_b16 v[42:43], v13 offset:41984
  v_mfma_f32_16x16x32_bf16 v[26:29], v[48:51], v[22:25], v[26:29]
  s_waitcnt lgkmcnt(8)
  v_mfma_f32_32x32x16_bf16 v[96:111], v[196:199], v[56:59], v[96:111]
  ds_read_b64_tr_b16 v[44:45], v14 offset:40960
  ds_read_b64_tr_b16 v[46:47], v14 offset:41984
  s_waitcnt lgkmcnt(8)
  v_mfma_f32_32x32x16_bf16 v[112:127], v[196:199], v[60:63], v[112:127]
  s_waitcnt lgkmcnt(6)
  v_mfma_f32_32x32x16_bf16 v[64:79], v[200:203], v[32:35], v[64:79]
  ds_read_b64_tr_b16 v[48:49], v11 offset:45056
  ds_read_b64_tr_b16 v[50:51], v11 offset:46080
  ds_read_b64_tr_b16 v[52:53], v12 offset:45056
  s_waitcnt lgkmcnt(7)
  v_mfma_f32_32x32x16_bf16 v[80:95], v[200:203], v[36:39], v[80:95]
  ds_read_b64_tr_b16 v[54:55], v12 offset:46080
  ds_read_b64_tr_b16 v[56:57], v13 offset:45056
  ds_read_b64_tr_b16 v[58:59], v13 offset:46080
  v_mfma_f32_16x16x32_bf16 v[26:29], v[32:35], v[22:25], v[26:29]
  s_waitcnt lgkmcnt(8)
  v_mfma_f32_32x32x16_bf16 v[96:111], v[200:203], v[40:43], v[96:111]
  ds_read_b64_tr_b16 v[60:61], v14 offset:45056
  ds_read_b64_tr_b16 v[62:63], v14 offset:46080
  s_waitcnt lgkmcnt(8)
  v_mfma_f32_32x32x16_bf16 v[112:127], v[200:203], v[44:47], v[112:127]
  s_waitcnt lgkmcnt(6)
  v_mfma_f32_32x32x16_bf16 v[64:79], v[204:207], v[48:51], v[64:79]
  ds_read_b64_tr_b16 v[32:33], v7 offset:8192
  ds_read_b64_tr_b16 v[34:35], v7 offset:9216
  ds_read_b64_tr_b16 v[36:37], v8 offset:8192
  s_waitcnt lgkmcnt(7)
  v_mfma_f32_32x32x16_bf16 v[80:95], v[204:207], v[52:55], v[80:95]
  ds_read_b64_tr_b16 v[38:39], v8 offset:9216
  ds_read_b64_tr_b16 v[40:41], v9 offset:8192
  ds_read_b64_tr_b16 v[42:43], v9 offset:9216
  v_mfma_f32_16x16x32_bf16 v[26:29], v[48:51], v[22:25], v[26:29]
  s_waitcnt lgkmcnt(8)
  v_mfma_f32_32x32x16_bf16 v[96:111], v[204:207], v[56:59], v[96:111]
  ds_read_b64_tr_b16 v[44:45], v10 offset:8192
  ds_read_b64_tr_b16 v[46:47], v10 offset:9216
  s_waitcnt lgkmcnt(8)
  v_mfma_f32_32x32x16_bf16 v[112:127], v[204:207], v[60:63], v[112:127]
  s_waitcnt lgkmcnt(6)
  v_mfma_f32_32x32x16_bf16 v[64:79], v[208:211], v[32:35], v[64:79]
  ds_read_b64_tr_b16 v[48:49], v7 offset:12288
  ds_read_b64_tr_b16 v[50:51], v7 offset:13312
  ds_read_b64_tr_b16 v[52:53], v8 offset:12288
  s_waitcnt lgkmcnt(7)
  v_mfma_f32_32x32x16_bf16 v[80:95], v[208:211], v[36:39], v[80:95]
  ds_read_b64_tr_b16 v[54:55], v8 offset:13312
  ds_read_b64_tr_b16 v[56:57], v9 offset:12288
  ds_read_b64_tr_b16 v[58:59], v9 offset:13312
  v_mfma_f32_16x16x32_bf16 v[26:29], v[32:35], v[22:25], v[26:29]
  s_waitcnt lgkmcnt(8)
  v_mfma_f32_32x32x16_bf16 v[96:111], v[208:211], v[40:43], v[96:111]
  ds_read_b64_tr_b16 v[60:61], v10 offset:12288
  ds_read_b64_tr_b16 v[62:63], v10 offset:13312
  s_waitcnt lgkmcnt(8)
  v_mfma_f32_32x32x16_bf16 v[112:127], v[208:211], v[44:47], v[112:127]
  s_waitcnt lgkmcnt(6)
  v_mfma_f32_32x32x16_bf16 v[64:79], v[212:215], v[48:51], v[64:79]
  ds_read_b64_tr_b16 v[32:33], v7 offset:16384
  ds_read_b64_tr_b16 v[34:35], v7 offset:17408
  ds_read_b64_tr_b16 v[36:37], v8 offset:16384
  s_waitcnt lgkmcnt(7)
  v_mfma_f32_32x32x16_bf16 v[80:95], v[212:215], v[52:55], v[80:95]
  ds_read_b64_tr_b16 v[38:39], v8 offset:17408
  ds_read_b64_tr_b16 v[40:41], v9 offset:16384
  ds_read_b64_tr_b16 v[42:43], v9 offset:17408
  v_mfma_f32_16x16x32_bf16 v[26:29], v[48:51], v[22:25], v[26:29]
  s_waitcnt lgkmcnt(8)
  v_mfma_f32_32x32x16_bf16 v[96:111], v[212:215], v[56:59], v[96:111]
  ds_read_b64_tr_b16 v[44:45], v10 offset:16384
  ds_read_b64_tr_b16 v[46:47], v10 offset:17408
  s_waitcnt lgkmcnt(8)
  v_mfma_f32_32x32x16_bf16 v[112:127], v[212:215], v[60:63], v[112:127]
  s_waitcnt lgkmcnt(6)
  v_mfma_f32_32x32x16_bf16 v[64:79], v[216:219], v[32:35], v[64:79]
  ds_read_b64_tr_b16 v[48:49], v7 offset:20480
  ds_read_b64_tr_b16 v[50:51], v7 offset:21504
  ds_read_b64_tr_b16 v[52:53], v8 offset:20480
  s_waitcnt lgkmcnt(7)
  v_mfma_f32_32x32x16_bf16 v[80:95], v[216:219], v[36:39], v[80:95]
  ds_read_b64_tr_b16 v[54:55], v8 offset:21504
  ds_read_b64_tr_b16 v[56:57], v9 offset:20480
  ds_read_b64_tr_b16 v[58:59], v9 offset:21504
  v_mfma_f32_16x16x32_bf16 v[26:29], v[32:35], v[22:25], v[26:29]
  s_waitcnt lgkmcnt(8)
  v_mfma_f32_32x32x16_bf16 v[96:111], v[216:219], v[40:43], v[96:111]
  ds_read_b64_tr_b16 v[60:61], v10 offset:20480
  ds_read_b64_tr_b16 v[62:63], v10 offset:21504
  s_waitcnt lgkmcnt(8)
  v_mfma_f32_32x32x16_bf16 v[112:127], v[216:219], v[44:47], v[112:127]
  s_waitcnt lgkmcnt(6)
  v_mfma_f32_32x32x16_bf16 v[64:79], v[220:223], v[48:51], v[64:79]
  s_waitcnt vmcnt(0)
  ds_write_b32 v5, v31 offset:48
L_k1_fp_45:
  ds_read_b128 v[128:131], v21 offset:48
  s_waitcnt lgkmcnt(0)
  v_and_b32 v2, v128, v129
  v_and_b32 v4, v130, v131
  v_and_b32 v2, v2, v4
  s_nop 0
  v_readfirstlane_b32 s43, v2
  s_nop 3
  s_cmp_eq_u32 s43, 0
  s_cbranch_scc1 L_k1_fp_45

  s_lshl_b32 s43, s37, 9
  s_add_u32 s43, s43, 155904
  v_and_b32 v4, 31, v1
  v_lshl_add_u32 v4, v4, 3, s43
  ds_read_b64 v[162:163], v4 offset:4352
  s_waitcnt lgkmcnt(0)
  v_add_f32 v160, v30, v162
  v_add_f32 v161, v0, v163

  v_mul_f32 v160, 0x3b000000, v160
  v_mul_f32 v161, 0x3b000000, v161
  v_fma_f32 v161, -v160, v160, v161
  v_max_f32 v161, 0, v161
  v_cvt_pk_bf16_f32 v162, v160, v161
  v_lshlrev_b32 v30, 16, v162
  v_and_b32 v161, s58, v162
  v_add_f32 v161, 0x3727c5ac, v161
  v_cvt_pk_bf16_f32 v161, v161, v161
  v_and_b32 v161, s58, v161
  v_sqrt_f32 v161, v161
  s_nop 0
  v_cvt_pk_bf16_f32 v161, v161, v161
  v_and_b32 v161, s58, v161
  v_rcp_f32 v0, v161
  s_nop 0
  v_fma_f32 v160, -v161, v0, 1.0
  v_fma_f32 v0, v160, v0, v0
  v_mul_f32 v30, v30, v0
  v_xor_b32 v30, 0x80000000, v30

  ds_read_b64_tr_b16 v[32:33], v11 offset:49152
  ds_read_b64_tr_b16 v[34:35], v11 offset:50176
  ds_read_b64_tr_b16 v[36:37], v12 offset:49152
  v_mfma_f32_32x32x16_bf16 v[80:95], v[220:223], v[52:55], v[80:95]
  ds_read_b64_tr_b16 v[38:39], v12 offset:50176
  ds_read_b64_tr_b16 v[40:41], v13 offset:49152
  ds_read_b64_tr_b16 v[42:43], v13 offset:50176
  v_mfma_f32_16x16x32_bf16 v[26:29], v[48:51], v[22:25], v[26:29]
  v_mfma_f32_32x32x16_bf16 v[96:111], v[220:223], v[56:59], v[96:111]
  ds_read_b64_tr_b16 v[44:45], v14 offset:49152
  ds_read_b64_tr_b16 v[46:47], v14 offset:50176
  v_mfma_f32_32x32x16_bf16 v[112:127], v[220:223], v[60:63], v[112:127]
  s_waitcnt lgkmcnt(6)
  v_mfma_f32_32x32x16_bf16 v[64:79], v[224:227], v[32:35], v[64:79]
  ds_read_b64_tr_b16 v[48:49], v11 offset:53248
  ds_read_b64_tr_b16 v[50:51], v11 offset:54272
  ds_read_b64_tr_b16 v[52:53], v12 offset:53248
  s_waitcnt lgkmcnt(7)
  v_mfma_f32_32x32x16_bf16 v[80:95], v[224:227], v[36:39], v[80:95]
  ds_read_b64_tr_b16 v[54:55], v12 offset:54272
  ds_read_b64_tr_b16 v[56:57], v13 offset:53248
  ds_read_b64_tr_b16 v[58:59], v13 offset:54272
  v_mfma_f32_16x16x32_bf16 v[26:29], v[32:35], v[22:25], v[26:29]
  s_waitcnt lgkmcnt(8)
  v_mfma_f32_32x32x16_bf16 v[96:111], v[224:227], v[40:43], v[96:111]
  ds_read_b64_tr_b16 v[60:61], v14 offset:53248
  ds_read_b64_tr_b16 v[62:63], v14 offset:54272
  s_waitcnt lgkmcnt(8)
  v_mfma_f32_32x32x16_bf16 v[112:127], v[224:227], v[44:47], v[112:127]
  s_waitcnt lgkmcnt(6)
  v_mfma_f32_32x32x16_bf16 v[64:79], v[228:231], v[48:51], v[64:79]
  ds_read_b64_tr_b16 v[32:33], v11 offset:57344
  ds_read_b64_tr_b16 v[34:35], v11 offset:58368
  ds_read_b64_tr_b16 v[36:37], v12 offset:57344
  s_waitcnt lgkmcnt(7)
  v_mfma_f32_32x32x16_bf16 v[80:95], v[228:231], v[52:55], v[80:95]
  ds_read_b64_tr_b16 v[38:39], v12 offset:58368
  ds_read_b64_tr_b16 v[40:41], v13 offset:57344
  ds_read_b64_tr_b16 v[42:43], v13 offset:58368
  v_mfma_f32_16x16x32_bf16 v[26:29], v[48:51], v[22:25], v[26:29]
  s_waitcnt lgkmcnt(8)
  v_mfma_f32_32x32x16_bf16 v[96:111], v[228:231], v[56:59], v[96:111]
  ds_read_b64_tr_b16 v[44:45], v14 offset:57344
  ds_read_b64_tr_b16 v[46:47], v14 offset:58368
  s_waitcnt lgkmcnt(8)
  v_mfma_f32_32x32x16_bf16 v[112:127], v[228:231], v[60:63], v[112:127]
  s_waitcnt lgkmcnt(6)
  v_mfma_f32_32x32x16_bf16 v[64:79], v[232:235], v[32:35], v[64:79]
  ds_read_b64_tr_b16 v[48:49], v11 offset:61440
  ds_read_b64_tr_b16 v[50:51], v11 offset:62464
  ds_read_b64_tr_b16 v[52:53], v12 offset:61440
  s_waitcnt lgkmcnt(7)
  v_mfma_f32_32x32x16_bf16 v[80:95], v[232:235], v[36:39], v[80:95]
  ds_read_b64_tr_b16 v[54:55], v12 offset:62464
  ds_read_b64_tr_b16 v[56:57], v13 offset:61440
  ds_read_b64_tr_b16 v[58:59], v13 offset:62464
  v_mfma_f32_16x16x32_bf16 v[26:29], v[32:35], v[22:25], v[26:29]
  s_waitcnt lgkmcnt(8)
  v_mfma_f32_32x32x16_bf16 v[96:111], v[232:235], v[40:43], v[96:111]
  ds_read_b64_tr_b16 v[60:61], v14 offset:61440
  ds_read_b64_tr_b16 v[62:63], v14 offset:62464
  s_waitcnt lgkmcnt(8)
  v_mfma_f32_32x32x16_bf16 v[112:127], v[232:235], v[44:47], v[112:127]
  s_waitcnt lgkmcnt(6)
  v_mfma_f32_32x32x16_bf16 v[64:79], v[236:239], v[48:51], v[64:79]
  ds_read_b64_tr_b16 v[32:33], v7 offset:24576
  ds_read_b64_tr_b16 v[34:35], v7 offset:25600
  ds_read_b64_tr_b16 v[36:37], v8 offset:24576
  s_waitcnt lgkmcnt(7)
  v_mfma_f32_32x32x16_bf16 v[80:95], v[236:239], v[52:55], v[80:95]
  ds_read_b64_tr_b16 v[38:39], v8 offset:25600
  ds_read_b64_tr_b16 v[40:41], v9 offset:24576
  ds_read_b64_tr_b16 v[42:43], v9 offset:25600
  v_mfma_f32_16x16x32_bf16 v[26:29], v[48:51], v[22:25], v[26:29]
  s_waitcnt lgkmcnt(8)
  v_mfma_f32_32x32x16_bf16 v[96:111], v[236:239], v[56:59], v[96:111]
  ds_read_b64_tr_b16 v[44:45], v10 offset:24576
  ds_read_b64_tr_b16 v[46:47], v10 offset:25600
  s_waitcnt lgkmcnt(8)
  v_mfma_f32_32x32x16_bf16 v[112:127], v[236:239], v[60:63], v[112:127]
  s_waitcnt lgkmcnt(6)
  v_mfma_f32_32x32x16_bf16 v[64:79], v[240:243], v[32:35], v[64:79]
  ds_read_b64_tr_b16 v[48:49], v7 offset:28672
  ds_read_b64_tr_b16 v[50:51], v7 offset:29696
  ds_read_b64_tr_b16 v[52:53], v8 offset:28672
  s_waitcnt lgkmcnt(7)
  v_mfma_f32_32x32x16_bf16 v[80:95], v[240:243], v[36:39], v[80:95]
  ds_read_b64_tr_b16 v[54:55], v8 offset:29696
  ds_read_b64_tr_b16 v[56:57], v9 offset:28672
  ds_read_b64_tr_b16 v[58:59], v9 offset:29696
  v_mfma_f32_16x16x32_bf16 v[26:29], v[32:35], v[22:25], v[26:29]
  s_waitcnt lgkmcnt(8)
  v_mfma_f32_32x32x16_bf16 v[96:111], v[240:243], v[40:43], v[96:111]
  ds_read_b64_tr_b16 v[60:61], v10 offset:28672
  ds_read_b64_tr_b16 v[62:63], v10 offset:29696
  s_waitcnt lgkmcnt(8)
  v_mfma_f32_32x32x16_bf16 v[112:127], v[240:243], v[44:47], v[112:127]
  s_waitcnt lgkmcnt(6)
  v_mfma_f32_32x32x16_bf16 v[64:79], v[244:247], v[48:51], v[64:79]
  ds_read_b64_tr_b16 v[32:33], v7 offset:32768
  ds_read_b64_tr_b16 v[34:35], v7 offset:33792
  ds_read_b64_tr_b16 v[36:37], v8 offset:32768
  s_waitcnt lgkmcnt(7)
  v_mfma_f32_32x32x16_bf16 v[80:95], v[244:247], v[52:55], v[80:95]
  ds_read_b64_tr_b16 v[38:39], v8 offset:33792
  ds_read_b64_tr_b16 v[40:41], v9 offset:32768
  ds_read_b64_tr_b16 v[42:43], v9 offset:33792
  v_mfma_f32_16x16x32_bf16 v[26:29], v[48:51], v[22:25], v[26:29]
  s_waitcnt lgkmcnt(8)
  v_mfma_f32_32x32x16_bf16 v[96:111], v[244:247], v[56:59], v[96:111]
  ds_read_b64_tr_b16 v[44:45], v10 offset:32768
  ds_read_b64_tr_b16 v[46:47], v10 offset:33792
  s_waitcnt lgkmcnt(8)
  v_mfma_f32_32x32x16_bf16 v[112:127], v[244:247], v[60:63], v[112:127]
  s_waitcnt lgkmcnt(6)
  v_mfma_f32_32x32x16_bf16 v[64:79], v[248:251], v[32:35], v[64:79]
  ds_read_b64_tr_b16 v[48:49], v7 offset:36864
  ds_read_b64_tr_b16 v[50:51], v7 offset:37888
  ds_read_b64_tr_b16 v[52:53], v8 offset:36864
  s_waitcnt lgkmcnt(7)
  v_mfma_f32_32x32x16_bf16 v[80:95], v[248:251], v[36:39], v[80:95]
  ds_read_b64_tr_b16 v[54:55], v8 offset:37888
  ds_read_b64_tr_b16 v[56:57], v9 offset:36864
  ds_read_b64_tr_b16 v[58:59], v9 offset:37888
  v_mfma_f32_16x16x32_bf16 v[26:29], v[32:35], v[22:25], v[26:29]
  s_waitcnt lgkmcnt(8)
  v_mfma_f32_32x32x16_bf16 v[96:111], v[248:251], v[40:43], v[96:111]
  ds_read_b64_tr_b16 v[60:61], v10 offset:36864
  ds_read_b64_tr_b16 v[62:63], v10 offset:37888
  s_waitcnt lgkmcnt(8)
  v_mfma_f32_32x32x16_bf16 v[112:127], v[248:251], v[44:47], v[112:127]
  s_waitcnt lgkmcnt(6)
  v_mfma_f32_32x32x16_bf16 v[64:79], v[252:255], v[48:51], v[64:79]
  s_waitcnt lgkmcnt(4)
  v_mfma_f32_32x32x16_bf16 v[80:95], v[252:255], v[52:55], v[80:95]
  v_mfma_f32_16x16x32_bf16 v[26:29], v[48:51], v[22:25], v[26:29]
  s_waitcnt lgkmcnt(2)
  v_mfma_f32_32x32x16_bf16 v[96:111], v[252:255], v[56:59], v[96:111]
  s_waitcnt lgkmcnt(0)
  v_mfma_f32_32x32x16_bf16 v[112:127], v[252:255], v[60:63], v[112:127]
  v_and_b32 v2, 1, v1
  v_lshlrev_b32 v2, 6, v2
  v_lshrrev_b32 v3, 4, v1
  v_lshl_add_u32 v2, v3, 4, v2
  s_lshl_b32 s43, s37, 7
  s_add_u32 s43, s43, 158208
  v_add_u32 v2, s43, v2
  s_nop 4
  s_mov_b64 exec, s[4:5]
  ds_write_b128 v2, v[26:29]
  s_mov_b64 exec, -1

  ds_write_b32 v5, v31 offset:64
  s_lshl_b32 s43, s37, 8
  s_add_u32 s43, s43, 158720
  v_and_b32 v2, 31, v1
  v_lshl_add_u32 v2, v2, 2, s43
  ds_write_b32 v2, v0
  ds_write_b32 v2, v30 offset:128
  v_lshrrev_b32 v3, 5, v1
  v_lshl_add_u32 v3, v3, 4, s43

  ds_read_b128 v[32:35], v3 offset:0
  ds_read_b128 v[36:39], v3 offset:32
  ds_read_b128 v[40:43], v3 offset:64
  ds_read_b128 v[44:47], v3 offset:96
  ds_read_b128 v[48:51], v3 offset:128
  ds_read_b128 v[52:55], v3 offset:160
  ds_read_b128 v[56:59], v3 offset:192
  ds_read_b128 v[60:63], v3 offset:224
  ds_write_b32 v5, v31 offset:64
L_k1_fp_46:
  ds_read_b128 v[128:131], v21 offset:64
  s_waitcnt lgkmcnt(0)
  v_and_b32 v2, v128, v129
  v_and_b32 v4, v130, v131
  v_and_b32 v2, v2, v4
  s_nop 0
  v_readfirstlane_b32 s43, v2
  s_nop 3
  s_cmp_eq_u32 s43, 0
  s_cbranch_scc1 L_k1_fp_46

L_k1_vdry:
  v_and_b32 v3, 31, v1
  s_lshl_b32 s43, s37, 7
  v_lshl_add_u32 v3, v3, 2, s43

  v_xor_b32 v2, 0, v3
  v_add_u32 v168, 158208, v2
  s_cbranch_execz L_k1_gm_47
  ds_read_b32 v160, v168
L_k1_gm_47:
  v_xor_b32 v2, 128, v3
  v_add_u32 v169, 158208, v2
  s_cbranch_execz L_k1_gm_48
  ds_read_b32 v162, v169
L_k1_gm_48:
  v_xor_b32 v2, 256, v3
  v_add_u32 v170, 158208, v2
  s_cbranch_execz L_k1_gm_49
  ds_read_b32 v164, v170
L_k1_gm_49:
  v_xor_b32 v2, 384, v3
  v_add_u32 v171, 158208, v2
  s_cbranch_execz L_k1_gm_50
  ds_read_b32 v166, v171
L_k1_gm_50:
  s_sub_u32 s43, s41, 8
  s_lshl_b32 s59, s43, 19
  s_lshl_b32 s43, s56, 10
  s_add_u32 s59, s59, s43
  s_add_u32 s59, s59, 4194304
  s_waitcnt lgkmcnt(0)

  v_pk_mul_f32 v[64:65], v[64:65], v[32:33]
  v_pk_mul_f32 v[66:67], v[66:67], v[34:35]
  v_pk_mul_f32 v[68:69], v[68:69], v[36:37]
  v_pk_mul_f32 v[70:71], v[70:71], v[38:39]
  v_pk_fma_f32 v[64:65], v[48:49], v[160:161], v[64:65] op_sel_hi:[1,0,1]
  v_pk_fma_f32 v[66:67], v[50:51], v[160:161], v[66:67] op_sel_hi:[1,0,1]
  v_pk_fma_f32 v[68:69], v[52:53], v[160:161], v[68:69] op_sel_hi:[1,0,1]
  v_pk_fma_f32 v[70:71], v[54:55], v[160:161], v[70:71] op_sel_hi:[1,0,1]
  v_cvt_pk_bf16_f32 v128, v64, v65
  v_cvt_pk_bf16_f32 v129, v66, v67
  v_cvt_pk_bf16_f32 v130, v68, v69
  v_cvt_pk_bf16_f32 v131, v70, v71
  s_xor_b32 s43, s37, 0
  s_lshl_b32 s43, s43, 17
  s_add_u32 s43, s43, s59
  s_cbranch_execz L_k1_gm_51
  buffer_store_dwordx4 v[128:131], v20, s[24:27], s43 offen offset:0 sc1
L_k1_gm_51:
  v_pk_mul_f32 v[72:73], v[72:73], v[40:41]
  v_pk_mul_f32 v[74:75], v[74:75], v[42:43]
  v_pk_mul_f32 v[76:77], v[76:77], v[44:45]
  v_pk_mul_f32 v[78:79], v[78:79], v[46:47]
  v_pk_fma_f32 v[72:73], v[56:57], v[160:161], v[72:73] op_sel_hi:[1,0,1]
  v_pk_fma_f32 v[74:75], v[58:59], v[160:161], v[74:75] op_sel_hi:[1,0,1]
  v_pk_fma_f32 v[76:77], v[60:61], v[160:161], v[76:77] op_sel_hi:[1,0,1]
  v_pk_fma_f32 v[78:79], v[62:63], v[160:161], v[78:79] op_sel_hi:[1,0,1]
  v_cvt_pk_bf16_f32 v132, v72, v73
  v_cvt_pk_bf16_f32 v133, v74, v75
  v_cvt_pk_bf16_f32 v134, v76, v77
  v_cvt_pk_bf16_f32 v135, v78, v79
  s_cbranch_execz L_k1_gm_52
  buffer_store_dwordx4 v[132:135], v20, s[24:27], s43 offen offset:512 sc1
L_k1_gm_52:
  v_pk_mul_f32 v[80:81], v[80:81], v[32:33]
  v_pk_mul_f32 v[82:83], v[82:83], v[34:35]
  v_pk_mul_f32 v[84:85], v[84:85], v[36:37]
  v_pk_mul_f32 v[86:87], v[86:87], v[38:39]
  v_pk_fma_f32 v[80:81], v[48:49], v[162:163], v[80:81] op_sel_hi:[1,0,1]
  v_pk_fma_f32 v[82:83], v[50:51], v[162:163], v[82:83] op_sel_hi:[1,0,1]
  v_pk_fma_f32 v[84:85], v[52:53], v[162:163], v[84:85] op_sel_hi:[1,0,1]
  v_pk_fma_f32 v[86:87], v[54:55], v[162:163], v[86:87] op_sel_hi:[1,0,1]
  v_cvt_pk_bf16_f32 v136, v80, v81
  v_cvt_pk_bf16_f32 v137, v82, v83
  v_cvt_pk_bf16_f32 v138, v84, v85
  v_cvt_pk_bf16_f32 v139, v86, v87
  s_xor_b32 s43, s37, 1
  s_lshl_b32 s43, s43, 17
  s_add_u32 s43, s43, s59
  s_cbranch_execz L_k1_gm_53
  buffer_store_dwordx4 v[136:139], v20, s[24:27], s43 offen offset:0 sc1
L_k1_gm_53:
  v_pk_mul_f32 v[88:89], v[88:89], v[40:41]
  v_pk_mul_f32 v[90:91], v[90:91], v[42:43]
  v_pk_mul_f32 v[92:93], v[92:93], v[44:45]
  v_pk_mul_f32 v[94:95], v[94:95], v[46:47]
  v_pk_fma_f32 v[88:89], v[56:57], v[162:163], v[88:89] op_sel_hi:[1,0,1]
  v_pk_fma_f32 v[90:91], v[58:59], v[162:163], v[90:91] op_sel_hi:[1,0,1]
  v_pk_fma_f32 v[92:93], v[60:61], v[162:163], v[92:93] op_sel_hi:[1,0,1]
  v_pk_fma_f32 v[94:95], v[62:63], v[162:163], v[94:95] op_sel_hi:[1,0,1]
  v_cvt_pk_bf16_f32 v140, v88, v89
  v_cvt_pk_bf16_f32 v141, v90, v91
  v_cvt_pk_bf16_f32 v142, v92, v93
  v_cvt_pk_bf16_f32 v143, v94, v95
  s_cbranch_execz L_k1_gm_54
  buffer_store_dwordx4 v[140:143], v20, s[24:27], s43 offen offset:512 sc1
L_k1_gm_54:
  v_pk_mul_f32 v[96:97], v[96:97], v[32:33]
  v_pk_mul_f32 v[98:99], v[98:99], v[34:35]
  v_pk_mul_f32 v[100:101], v[100:101], v[36:37]
  v_pk_mul_f32 v[102:103], v[102:103], v[38:39]
  v_pk_fma_f32 v[96:97], v[48:49], v[164:165], v[96:97] op_sel_hi:[1,0,1]
  v_pk_fma_f32 v[98:99], v[50:51], v[164:165], v[98:99] op_sel_hi:[1,0,1]
  v_pk_fma_f32 v[100:101], v[52:53], v[164:165], v[100:101] op_sel_hi:[1,0,1]
  v_pk_fma_f32 v[102:103], v[54:55], v[164:165], v[102:103] op_sel_hi:[1,0,1]
  v_cvt_pk_bf16_f32 v144, v96, v97
  v_cvt_pk_bf16_f32 v145, v98, v99
  v_cvt_pk_bf16_f32 v146, v100, v101
  v_cvt_pk_bf16_f32 v147, v102, v103
  s_xor_b32 s43, s37, 2
  s_lshl_b32 s43, s43, 17
  s_add_u32 s43, s43, s59
  s_cbranch_execz L_k1_gm_55
  buffer_store_dwordx4 v[144:147], v20, s[24:27], s43 offen offset:0 sc1
L_k1_gm_55:
  v_pk_mul_f32 v[104:105], v[104:105], v[40:41]
  v_pk_mul_f32 v[106:107], v[106:107], v[42:43]
  v_pk_mul_f32 v[108:109], v[108:109], v[44:45]
  v_pk_mul_f32 v[110:111], v[110:111], v[46:47]
  v_pk_fma_f32 v[104:105], v[56:57], v[164:165], v[104:105] op_sel_hi:[1,0,1]
  v_pk_fma_f32 v[106:107], v[58:59], v[164:165], v[106:107] op_sel_hi:[1,0,1]
  v_pk_fma_f32 v[108:109], v[60:61], v[164:165], v[108:109] op_sel_hi:[1,0,1]
  v_pk_fma_f32 v[110:111], v[62:63], v[164:165], v[110:111] op_sel_hi:[1,0,1]
  v_cvt_pk_bf16_f32 v148, v104, v105
  v_cvt_pk_bf16_f32 v149, v106, v107
  v_cvt_pk_bf16_f32 v150, v108, v109
  v_cvt_pk_bf16_f32 v151, v110, v111
  s_cbranch_execz L_k1_gm_56
  buffer_store_dwordx4 v[148:151], v20, s[24:27], s43 offen offset:512 sc1
L_k1_gm_56:
  v_pk_mul_f32 v[112:113], v[112:113], v[32:33]
  v_pk_mul_f32 v[114:115], v[114:115], v[34:35]
  v_pk_mul_f32 v[116:117], v[116:117], v[36:37]
  v_pk_mul_f32 v[118:119], v[118:119], v[38:39]
  v_pk_fma_f32 v[112:113], v[48:49], v[166:167], v[112:113] op_sel_hi:[1,0,1]
  v_pk_fma_f32 v[114:115], v[50:51], v[166:167], v[114:115] op_sel_hi:[1,0,1]
  v_pk_fma_f32 v[116:117], v[52:53], v[166:167], v[116:117] op_sel_hi:[1,0,1]
  v_pk_fma_f32 v[118:119], v[54:55], v[166:167], v[118:119] op_sel_hi:[1,0,1]
  v_cvt_pk_bf16_f32 v152, v112, v113
  v_cvt_pk_bf16_f32 v153, v114, v115
  v_cvt_pk_bf16_f32 v154, v116, v117
  v_cvt_pk_bf16_f32 v155, v118, v119
  s_xor_b32 s43, s37, 3
  s_lshl_b32 s43, s43, 17
  s_add_u32 s43, s43, s59
  s_cbranch_execz L_k1_gm_57
  buffer_store_dwordx4 v[152:155], v20, s[24:27], s43 offen offset:0 sc1
L_k1_gm_57:
  v_pk_mul_f32 v[120:121], v[120:121], v[40:41]
  v_pk_mul_f32 v[122:123], v[122:123], v[42:43]
  v_pk_mul_f32 v[124:125], v[124:125], v[44:45]
  v_pk_mul_f32 v[126:127], v[126:127], v[46:47]
  v_pk_fma_f32 v[120:121], v[56:57], v[166:167], v[120:121] op_sel_hi:[1,0,1]
  v_pk_fma_f32 v[122:123], v[58:59], v[166:167], v[122:123] op_sel_hi:[1,0,1]
  v_pk_fma_f32 v[124:125], v[60:61], v[166:167], v[124:125] op_sel_hi:[1,0,1]
  v_pk_fma_f32 v[126:127], v[62:63], v[166:167], v[126:127] op_sel_hi:[1,0,1]
  v_cvt_pk_bf16_f32 v156, v120, v121
  v_cvt_pk_bf16_f32 v157, v122, v123
  v_cvt_pk_bf16_f32 v158, v124, v125
  v_cvt_pk_bf16_f32 v159, v126, v127
  s_cbranch_execz L_k1_gm_58
  buffer_store_dwordx4 v[156:159], v20, s[24:27], s43 offen offset:512 sc1
L_k1_gm_58:
  s_cbranch_execz L_k1_qret
  s_endpgm
L_k1_zw:
  v_lshrrev_b32 v2, 5, v1
  v_bfe_u32 v3, v1, 1, 3
  v_xor_b32 v3, v3, v2
  v_and_b32 v2, 31, v1
  s_lshl_b32 s43, s37, 12
  v_lshl_add_u32 v2, v2, 7, s43

  v_xor_b32 v4, 0, v3
  v_lshl_add_u32 v240, v4, 4, v2
  v_xor_b32 v4, 2, v3
  v_lshl_add_u32 v241, v4, 4, v2
  v_xor_b32 v4, 4, v3
  v_lshl_add_u32 v242, v4, 4, v2
  v_xor_b32 v4, 6, v3
  v_lshl_add_u32 v243, v4, 4, v2
  v_lshrrev_b32 v2, 5, v1
  v_bfe_u32 v3, v1, 2, 2
  v_lshl_add_u32 v2, v2, 3, v3
  v_lshlrev_b32 v2, 8, v2
  v_bfe_u32 v4, v1, 4, 1
  v_lshl_add_u32 v2, v4, 5, v2
  v_and_b32 v4, 3, v1
  v_lshl_add_u32 v2, v4, 3, v2

  v_xor_b32 v4, 0, v3
  v_lshl_add_u32 v7, v4, 6, v2
  v_add_u32 v11, 0x10000, v7
  v_add_u32 v15, 0x20000, v7
  v_xor_b32 v4, 1, v3
  v_lshl_add_u32 v8, v4, 6, v2
  v_add_u32 v12, 0x10000, v8
  v_add_u32 v16, 0x20000, v8
  v_xor_b32 v4, 2, v3
  v_lshl_add_u32 v9, v4, 6, v2
  v_add_u32 v13, 0x10000, v9
  v_add_u32 v17, 0x20000, v9
  v_xor_b32 v4, 3, v3
  v_lshl_add_u32 v10, v4, 6, v2
  v_add_u32 v14, 0x10000, v10
  v_add_u32 v18, 0x20000, v10
  v_lshlrev_b32 v2, 2, v1
  v_add_u32 v2, 159744, v2
  v_mov_b32 v224, 0
  v_mov_b32 v225, -1
  v_mov_b32 v226, 0
  v_mov_b32 v227, -1
  ds_write_b32 v2, v224
  v_and_b32 v2, 31, v1
  v_lshlrev_b32 v252, 3, v2
  s_waitcnt lgkmcnt(0)
  s_lshl_b32 s3, s56, 11
  s_add_u32 s3, s3, 25165824
  s_lshl_b32 s52, s40, 8
  s_add_u32 s47, s3, s52
  s_sub_u32 s47, s47, 1792
  s_mul_i32 s59, s56, 57344
  s_lshl_b32 s43, s40, 13
  s_add_u32 s59, s59, s43

  v_mov_b32 v244, 0
  v_mov_b32 v245, 0
  v_mov_b32 v246, 0
  v_mov_b32 v247, 0
  s_waitcnt lgkmcnt(0)
  s_mov_b32 s24, s50
  s_and_b32 s25, s51, 0xffff
  s_mov_b32 s26, 0x1b00000
  s_mov_b32 s27, 0x20000
  s_mov_b32 s32, s48
  s_and_b32 s33, s49, 0xffff
  s_mov_b32 s34, 0x100
  s_mov_b32 s35, 0x20000
  s_cmp_lt_u32 s40, 7
  s_cbranch_scc1 L_k1_noclr
  s_mov_b32 exec_hi, 0
  s_mov_b32 exec_lo, 0x55555555
  buffer_store_dwordx4 v[224:227], v252, s[24:27], s47 offen sc0 sc1
  s_mov_b64 exec, -1

L_k1_noclr:
  s_cmp_eq_u32 s37, 3
  s_cbranch_scc1 L_k1_nodry
  s_mov_b32 s88, s47
  s_mov_b64 exec, 0
  s_cmp_eq_u32 s37, 0
  s_cbranch_scc1 L_k1_vdry
  s_cmp_eq_u32 s37, 1
  s_cbranch_scc1 L_k1_tdry
  s_branch L_k1_g2
  L_k1_qret:
  s_mov_b64 exec, -1
  s_mul_i32 s59, s56, 57344
  s_lshl_b32 s43, s40, 13
  s_add_u32 s59, s59, s43
  L_k1_nodry:

  s_barrier
  ds_read_b128 v[128:131], v240 offset:0
  ds_read_b64_tr_b16 v[32:33], v11 offset:0
  ds_read_b64_tr_b16 v[34:35], v11 offset:1024
  ds_read_b64_tr_b16 v[36:37], v12 offset:0
  ds_read_b64_tr_b16 v[38:39], v12 offset:1024
  ds_read_b64_tr_b16 v[40:41], v13 offset:0
  ds_read_b64_tr_b16 v[42:43], v13 offset:1024
  ds_read_b64_tr_b16 v[44:45], v14 offset:0
  ds_read_b64_tr_b16 v[46:47], v14 offset:1024
  s_waitcnt lgkmcnt(6)
  v_mfma_f32_32x32x16_bf16 v[64:79], v[32:35], v[128:131], 0
  ds_read_b128 v[132:135], v241 offset:0
  ds_read_b64_tr_b16 v[48:49], v11 offset:4096
  ds_read_b64_tr_b16 v[50:51], v11 offset:5120
  v_lshlrev_b32 v248, 16, v128
  v_and_b32 v249, s58, v128
  v_add_f32 v244, v244, v248
  s_waitcnt lgkmcnt(7)
  v_mfma_f32_32x32x16_bf16 v[80:95], v[36:39], v[128:131], 0
  ds_read_b64_tr_b16 v[52:53], v12 offset:4096
  ds_read_b64_tr_b16 v[54:55], v12 offset:5120
  ds_read_b64_tr_b16 v[56:57], v13 offset:4096
  v_add_f32 v245, v245, v249
  v_fmac_f32 v246, v248, v248
  v_fmac_f32 v247, v249, v249
  s_waitcnt lgkmcnt(8)
  v_mfma_f32_32x32x16_bf16 v[96:111], v[40:43], v[128:131], 0
  ds_read_b64_tr_b16 v[58:59], v13 offset:5120
  ds_read_b64_tr_b16 v[60:61], v14 offset:4096
  ds_read_b64_tr_b16 v[62:63], v14 offset:5120
  v_lshlrev_b32 v250, 16, v129
  v_and_b32 v251, s58, v129
  v_add_f32 v244, v244, v250
  s_waitcnt lgkmcnt(9)
  v_mfma_f32_32x32x16_bf16 v[112:127], v[44:47], v[128:131], 0
  v_add_f32 v245, v245, v251
  v_fmac_f32 v246, v250, v250
  v_fmac_f32 v247, v251, v251
  s_waitcnt lgkmcnt(6)
  v_mfma_f32_32x32x16_bf16 v[64:79], v[48:51], v[132:135], v[64:79]
  ds_read_b128 v[136:139], v242 offset:0
  ds_read_b64_tr_b16 v[32:33], v11 offset:8192
  ds_read_b64_tr_b16 v[34:35], v11 offset:9216
  v_lshlrev_b32 v248, 16, v130
  v_and_b32 v249, s58, v130
  v_add_f32 v244, v244, v248
  s_waitcnt lgkmcnt(7)
  v_mfma_f32_32x32x16_bf16 v[80:95], v[52:55], v[132:135], v[80:95]
  ds_read_b64_tr_b16 v[36:37], v12 offset:8192
  ds_read_b64_tr_b16 v[38:39], v12 offset:9216
  ds_read_b64_tr_b16 v[40:41], v13 offset:8192
  v_add_f32 v245, v245, v249
  v_fmac_f32 v246, v248, v248
  v_fmac_f32 v247, v249, v249
  s_waitcnt lgkmcnt(8)
  v_mfma_f32_32x32x16_bf16 v[96:111], v[56:59], v[132:135], v[96:111]
  ds_read_b64_tr_b16 v[42:43], v13 offset:9216
  ds_read_b64_tr_b16 v[44:45], v14 offset:8192
  ds_read_b64_tr_b16 v[46:47], v14 offset:9216
  v_lshlrev_b32 v250, 16, v131
  v_and_b32 v251, s58, v131
  v_add_f32 v244, v244, v250
  s_waitcnt lgkmcnt(9)
  v_mfma_f32_32x32x16_bf16 v[112:127], v[60:63], v[132:135], v[112:127]
  v_add_f32 v245, v245, v251
  v_fmac_f32 v246, v250, v250
  v_fmac_f32 v247, v251, v251
  s_waitcnt lgkmcnt(6)
  v_mfma_f32_32x32x16_bf16 v[64:79], v[32:35], v[136:139], v[64:79]
  ds_read_b128 v[140:143], v243 offset:0
  ds_read_b64_tr_b16 v[48:49], v11 offset:12288
  ds_read_b64_tr_b16 v[50:51], v11 offset:13312
  v_lshlrev_b32 v248, 16, v136
  v_and_b32 v249, s58, v136
  v_add_f32 v244, v244, v248
  s_waitcnt lgkmcnt(7)
  v_mfma_f32_32x32x16_bf16 v[80:95], v[36:39], v[136:139], v[80:95]
  ds_read_b64_tr_b16 v[52:53], v12 offset:12288
  ds_read_b64_tr_b16 v[54:55], v12 offset:13312
  ds_read_b64_tr_b16 v[56:57], v13 offset:12288
  v_add_f32 v245, v245, v249
  v_fmac_f32 v246, v248, v248
  v_fmac_f32 v247, v249, v249
  s_waitcnt lgkmcnt(8)
  v_mfma_f32_32x32x16_bf16 v[96:111], v[40:43], v[136:139], v[96:111]
  ds_read_b64_tr_b16 v[58:59], v13 offset:13312
  ds_read_b64_tr_b16 v[60:61], v14 offset:12288
  ds_read_b64_tr_b16 v[62:63], v14 offset:13312
  v_lshlrev_b32 v250, 16, v137
  v_and_b32 v251, s58, v137
  v_add_f32 v244, v244, v250
  s_waitcnt lgkmcnt(9)
  v_mfma_f32_32x32x16_bf16 v[112:127], v[44:47], v[136:139], v[112:127]
  v_add_f32 v245, v245, v251
  v_fmac_f32 v246, v250, v250
  v_fmac_f32 v247, v251, v251
  s_waitcnt lgkmcnt(6)
  v_mfma_f32_32x32x16_bf16 v[64:79], v[48:51], v[140:143], v[64:79]
  s_waitcnt lgkmcnt(0)
  s_barrier
  ds_read_b128 v[128:131], v240 offset:16384
  ds_read_b64_tr_b16 v[32:33], v11 offset:16384
  ds_read_b64_tr_b16 v[34:35], v11 offset:17408
  v_lshlrev_b32 v248, 16, v138
  v_and_b32 v249, s58, v138
  v_add_f32 v244, v244, v248
  v_mfma_f32_32x32x16_bf16 v[80:95], v[52:55], v[140:143], v[80:95]
  ds_read_b64_tr_b16 v[36:37], v12 offset:16384
  ds_read_b64_tr_b16 v[38:39], v12 offset:17408
  ds_read_b64_tr_b16 v[40:41], v13 offset:16384
  v_add_f32 v245, v245, v249
  v_fmac_f32 v246, v248, v248
  v_fmac_f32 v247, v249, v249
  v_mfma_f32_32x32x16_bf16 v[96:111], v[56:59], v[140:143], v[96:111]
  ds_read_b64_tr_b16 v[42:43], v13 offset:17408
  ds_read_b64_tr_b16 v[44:45], v14 offset:16384
  ds_read_b64_tr_b16 v[46:47], v14 offset:17408
  v_lshlrev_b32 v250, 16, v139
  v_and_b32 v251, s58, v139
  v_add_f32 v244, v244, v250
  v_mfma_f32_32x32x16_bf16 v[112:127], v[60:63], v[140:143], v[112:127]
  v_add_f32 v245, v245, v251
  v_fmac_f32 v246, v250, v250
  v_fmac_f32 v247, v251, v251
  s_waitcnt lgkmcnt(6)
  v_mfma_f32_32x32x16_bf16 v[64:79], v[32:35], v[128:131], v[64:79]
  ds_read_b128 v[132:135], v241 offset:16384
  ds_read_b64_tr_b16 v[48:49], v11 offset:20480
  ds_read_b64_tr_b16 v[50:51], v11 offset:21504
  v_lshlrev_b32 v248, 16, v128
  v_and_b32 v249, s58, v128
  v_add_f32 v244, v244, v248
  s_waitcnt lgkmcnt(7)
  v_mfma_f32_32x32x16_bf16 v[80:95], v[36:39], v[128:131], v[80:95]
  ds_read_b64_tr_b16 v[52:53], v12 offset:20480
  ds_read_b64_tr_b16 v[54:55], v12 offset:21504
  ds_read_b64_tr_b16 v[56:57], v13 offset:20480
  v_add_f32 v245, v245, v249
  v_fmac_f32 v246, v248, v248
  v_fmac_f32 v247, v249, v249
  s_waitcnt lgkmcnt(8)
  v_mfma_f32_32x32x16_bf16 v[96:111], v[40:43], v[128:131], v[96:111]
  ds_read_b64_tr_b16 v[58:59], v13 offset:21504
  ds_read_b64_tr_b16 v[60:61], v14 offset:20480
  ds_read_b64_tr_b16 v[62:63], v14 offset:21504
  v_lshlrev_b32 v250, 16, v129
  v_and_b32 v251, s58, v129
  v_add_f32 v244, v244, v250
  s_waitcnt lgkmcnt(9)
  v_mfma_f32_32x32x16_bf16 v[112:127], v[44:47], v[128:131], v[112:127]
  v_add_f32 v245, v245, v251
  v_fmac_f32 v246, v250, v250
  v_fmac_f32 v247, v251, v251
  s_waitcnt lgkmcnt(6)
  v_mfma_f32_32x32x16_bf16 v[64:79], v[48:51], v[132:135], v[64:79]
  ds_read_b128 v[136:139], v242 offset:16384
  ds_read_b64_tr_b16 v[32:33], v11 offset:24576
  ds_read_b64_tr_b16 v[34:35], v11 offset:25600
  v_lshlrev_b32 v248, 16, v130
  v_and_b32 v249, s58, v130
  v_add_f32 v244, v244, v248
  s_waitcnt lgkmcnt(7)
  v_mfma_f32_32x32x16_bf16 v[80:95], v[52:55], v[132:135], v[80:95]
  ds_read_b64_tr_b16 v[36:37], v12 offset:24576
  ds_read_b64_tr_b16 v[38:39], v12 offset:25600
  ds_read_b64_tr_b16 v[40:41], v13 offset:24576
  v_add_f32 v245, v245, v249
  v_fmac_f32 v246, v248, v248
  v_fmac_f32 v247, v249, v249
  s_waitcnt lgkmcnt(8)
  v_mfma_f32_32x32x16_bf16 v[96:111], v[56:59], v[132:135], v[96:111]
  ds_read_b64_tr_b16 v[42:43], v13 offset:25600
  ds_read_b64_tr_b16 v[44:45], v14 offset:24576
  ds_read_b64_tr_b16 v[46:47], v14 offset:25600
  v_lshlrev_b32 v250, 16, v131
  v_and_b32 v251, s58, v131
  v_add_f32 v244, v244, v250
  s_waitcnt lgkmcnt(9)
  v_mfma_f32_32x32x16_bf16 v[112:127], v[60:63], v[132:135], v[112:127]
  v_add_f32 v245, v245, v251
  v_fmac_f32 v246, v250, v250
  v_fmac_f32 v247, v251, v251
  s_waitcnt lgkmcnt(6)
  v_mfma_f32_32x32x16_bf16 v[64:79], v[32:35], v[136:139], v[64:79]
  ds_read_b128 v[140:143], v243 offset:16384
  ds_read_b64_tr_b16 v[48:49], v11 offset:28672
  ds_read_b64_tr_b16 v[50:51], v11 offset:29696
  v_lshlrev_b32 v248, 16, v136
  v_and_b32 v249, s58, v136
  v_add_f32 v244, v244, v248
  s_waitcnt lgkmcnt(7)
  v_mfma_f32_32x32x16_bf16 v[80:95], v[36:39], v[136:139], v[80:95]
  ds_read_b64_tr_b16 v[52:53], v12 offset:28672
  ds_read_b64_tr_b16 v[54:55], v12 offset:29696
  ds_read_b64_tr_b16 v[56:57], v13 offset:28672
  v_add_f32 v245, v245, v249
  v_fmac_f32 v246, v248, v248
  v_fmac_f32 v247, v249, v249
  s_waitcnt lgkmcnt(8)
  v_mfma_f32_32x32x16_bf16 v[96:111], v[40:43], v[136:139], v[96:111]
  ds_read_b64_tr_b16 v[58:59], v13 offset:29696
  ds_read_b64_tr_b16 v[60:61], v14 offset:28672
  ds_read_b64_tr_b16 v[62:63], v14 offset:29696
  v_lshlrev_b32 v250, 16, v137
  v_and_b32 v251, s58, v137
  v_add_f32 v244, v244, v250
  s_waitcnt lgkmcnt(9)
  v_mfma_f32_32x32x16_bf16 v[112:127], v[44:47], v[136:139], v[112:127]
  v_add_f32 v245, v245, v251
  v_fmac_f32 v246, v250, v250
  v_fmac_f32 v247, v251, v251
  s_waitcnt lgkmcnt(6)
  v_mfma_f32_32x32x16_bf16 v[64:79], v[48:51], v[140:143], v[64:79]
  s_waitcnt vmcnt(0) lgkmcnt(0)
  s_barrier
  s_cmp_lt_u32 s40, 7
  s_cbranch_scc1 L_k1_noarr_59
  s_cmp_lg_u32 s36, 0
  s_cbranch_scc1 L_k1_noarr_59
  s_lshl_b32 s43, s39, 2
  v_mov_b32 v2, 1
  s_mov_b64 exec, 1
  buffer_atomic_add v2, off, s[32:35], s43 sc1
  s_mov_b64 exec, -1

L_k1_noarr_59:
  ds_read_b128 v[128:131], v240 offset:32768
  ds_read_b64_tr_b16 v[32:33], v11 offset:32768
  ds_read_b64_tr_b16 v[34:35], v11 offset:33792
  v_lshlrev_b32 v248, 16, v138
  v_and_b32 v249, s58, v138
  v_add_f32 v244, v244, v248
  v_mfma_f32_32x32x16_bf16 v[80:95], v[52:55], v[140:143], v[80:95]
  ds_read_b64_tr_b16 v[36:37], v12 offset:32768
  ds_read_b64_tr_b16 v[38:39], v12 offset:33792
  ds_read_b64_tr_b16 v[40:41], v13 offset:32768
  v_add_f32 v245, v245, v249
  v_fmac_f32 v246, v248, v248
  v_fmac_f32 v247, v249, v249
  v_mfma_f32_32x32x16_bf16 v[96:111], v[56:59], v[140:143], v[96:111]
  ds_read_b64_tr_b16 v[42:43], v13 offset:33792
  ds_read_b64_tr_b16 v[44:45], v14 offset:32768
  ds_read_b64_tr_b16 v[46:47], v14 offset:33792
  v_lshlrev_b32 v250, 16, v139
  v_and_b32 v251, s58, v139
  v_add_f32 v244, v244, v250
  v_mfma_f32_32x32x16_bf16 v[112:127], v[60:63], v[140:143], v[112:127]
  v_add_f32 v245, v245, v251
  v_fmac_f32 v246, v250, v250
  v_fmac_f32 v247, v251, v251
  s_waitcnt lgkmcnt(6)
  v_mfma_f32_32x32x16_bf16 v[64:79], v[32:35], v[128:131], v[64:79]
  ds_read_b128 v[132:135], v241 offset:32768
  ds_read_b64_tr_b16 v[48:49], v11 offset:36864
  ds_read_b64_tr_b16 v[50:51], v11 offset:37888
  v_lshlrev_b32 v248, 16, v128
  v_and_b32 v249, s58, v128
  v_add_f32 v244, v244, v248
  s_waitcnt lgkmcnt(7)
  v_mfma_f32_32x32x16_bf16 v[80:95], v[36:39], v[128:131], v[80:95]
  ds_read_b64_tr_b16 v[52:53], v12 offset:36864
  ds_read_b64_tr_b16 v[54:55], v12 offset:37888
  ds_read_b64_tr_b16 v[56:57], v13 offset:36864
  v_add_f32 v245, v245, v249
  v_fmac_f32 v246, v248, v248
  v_fmac_f32 v247, v249, v249
  s_waitcnt lgkmcnt(8)
  v_mfma_f32_32x32x16_bf16 v[96:111], v[40:43], v[128:131], v[96:111]
  ds_read_b64_tr_b16 v[58:59], v13 offset:37888
  ds_read_b64_tr_b16 v[60:61], v14 offset:36864
  ds_read_b64_tr_b16 v[62:63], v14 offset:37888
  v_lshlrev_b32 v250, 16, v129
  v_and_b32 v251, s58, v129
  v_add_f32 v244, v244, v250
  s_waitcnt lgkmcnt(9)
  v_mfma_f32_32x32x16_bf16 v[112:127], v[44:47], v[128:131], v[112:127]
  v_add_f32 v245, v245, v251
  v_fmac_f32 v246, v250, v250
  v_fmac_f32 v247, v251, v251
  s_waitcnt lgkmcnt(6)
  v_mfma_f32_32x32x16_bf16 v[64:79], v[48:51], v[132:135], v[64:79]
  ds_read_b128 v[136:139], v242 offset:32768
  ds_read_b64_tr_b16 v[32:33], v11 offset:40960
  ds_read_b64_tr_b16 v[34:35], v11 offset:41984
  v_lshlrev_b32 v248, 16, v130
  v_and_b32 v249, s58, v130
  v_add_f32 v244, v244, v248
  s_waitcnt lgkmcnt(7)
  v_mfma_f32_32x32x16_bf16 v[80:95], v[52:55], v[132:135], v[80:95]
  ds_read_b64_tr_b16 v[36:37], v12 offset:40960
  ds_read_b64_tr_b16 v[38:39], v12 offset:41984
  ds_read_b64_tr_b16 v[40:41], v13 offset:40960
  v_add_f32 v245, v245, v249
  v_fmac_f32 v246, v248, v248
  v_fmac_f32 v247, v249, v249
  s_waitcnt lgkmcnt(8)
  v_mfma_f32_32x32x16_bf16 v[96:111], v[56:59], v[132:135], v[96:111]
  ds_read_b64_tr_b16 v[42:43], v13 offset:41984
  ds_read_b64_tr_b16 v[44:45], v14 offset:40960
  ds_read_b64_tr_b16 v[46:47], v14 offset:41984
  v_lshlrev_b32 v250, 16, v131
  v_and_b32 v251, s58, v131
  v_add_f32 v244, v244, v250
  s_waitcnt lgkmcnt(9)
  v_mfma_f32_32x32x16_bf16 v[112:127], v[60:63], v[132:135], v[112:127]
  v_add_f32 v245, v245, v251
  v_fmac_f32 v246, v250, v250
  v_fmac_f32 v247, v251, v251
  s_waitcnt lgkmcnt(6)
  v_mfma_f32_32x32x16_bf16 v[64:79], v[32:35], v[136:139], v[64:79]
  ds_read_b128 v[140:143], v243 offset:32768
  ds_read_b64_tr_b16 v[48:49], v11 offset:45056
  ds_read_b64_tr_b16 v[50:51], v11 offset:46080
  v_lshlrev_b32 v248, 16, v136
  v_and_b32 v249, s58, v136
  v_add_f32 v244, v244, v248
  s_waitcnt lgkmcnt(7)
  v_mfma_f32_32x32x16_bf16 v[80:95], v[36:39], v[136:139], v[80:95]
  ds_read_b64_tr_b16 v[52:53], v12 offset:45056
  ds_read_b64_tr_b16 v[54:55], v12 offset:46080
  ds_read_b64_tr_b16 v[56:57], v13 offset:45056
  v_add_f32 v245, v245, v249
  v_fmac_f32 v246, v248, v248
  v_fmac_f32 v247, v249, v249
  s_waitcnt lgkmcnt(8)
  v_mfma_f32_32x32x16_bf16 v[96:111], v[40:43], v[136:139], v[96:111]
  ds_read_b64_tr_b16 v[58:59], v13 offset:46080
  ds_read_b64_tr_b16 v[60:61], v14 offset:45056
  ds_read_b64_tr_b16 v[62:63], v14 offset:46080
  v_lshlrev_b32 v250, 16, v137
  v_and_b32 v251, s58, v137
  v_add_f32 v244, v244, v250
  s_waitcnt lgkmcnt(9)
  v_mfma_f32_32x32x16_bf16 v[112:127], v[44:47], v[136:139], v[112:127]
  v_add_f32 v245, v245, v251
  v_fmac_f32 v246, v250, v250
  v_fmac_f32 v247, v251, v251
  s_waitcnt lgkmcnt(6)
  v_mfma_f32_32x32x16_bf16 v[64:79], v[48:51], v[140:143], v[64:79]
  s_waitcnt lgkmcnt(0)
  s_barrier
  ds_read_b128 v[128:131], v240 offset:49152
  ds_read_b64_tr_b16 v[32:33], v11 offset:49152
  ds_read_b64_tr_b16 v[34:35], v11 offset:50176
  v_lshlrev_b32 v248, 16, v138
  v_and_b32 v249, s58, v138
  v_add_f32 v244, v244, v248
  v_mfma_f32_32x32x16_bf16 v[80:95], v[52:55], v[140:143], v[80:95]
  ds_read_b64_tr_b16 v[36:37], v12 offset:49152
  ds_read_b64_tr_b16 v[38:39], v12 offset:50176
  ds_read_b64_tr_b16 v[40:41], v13 offset:49152
  v_add_f32 v245, v245, v249
  v_fmac_f32 v246, v248, v248
  v_fmac_f32 v247, v249, v249
  v_mfma_f32_32x32x16_bf16 v[96:111], v[56:59], v[140:143], v[96:111]
  ds_read_b64_tr_b16 v[42:43], v13 offset:50176
  ds_read_b64_tr_b16 v[44:45], v14 offset:49152
  ds_read_b64_tr_b16 v[46:47], v14 offset:50176
  v_lshlrev_b32 v250, 16, v139
  v_and_b32 v251, s58, v139
  v_add_f32 v244, v244, v250
  v_mfma_f32_32x32x16_bf16 v[112:127], v[60:63], v[140:143], v[112:127]
  v_add_f32 v245, v245, v251
  v_fmac_f32 v246, v250, v250
  v_fmac_f32 v247, v251, v251
  s_waitcnt lgkmcnt(6)
  v_mfma_f32_32x32x16_bf16 v[64:79], v[32:35], v[128:131], v[64:79]
  ds_read_b128 v[132:135], v241 offset:49152
  ds_read_b64_tr_b16 v[48:49], v11 offset:53248
  ds_read_b64_tr_b16 v[50:51], v11 offset:54272
  v_lshlrev_b32 v248, 16, v128
  v_and_b32 v249, s58, v128
  v_add_f32 v244, v244, v248
  s_waitcnt lgkmcnt(7)
  v_mfma_f32_32x32x16_bf16 v[80:95], v[36:39], v[128:131], v[80:95]
  ds_read_b64_tr_b16 v[52:53], v12 offset:53248
  ds_read_b64_tr_b16 v[54:55], v12 offset:54272
  ds_read_b64_tr_b16 v[56:57], v13 offset:53248
  v_add_f32 v245, v245, v249
  v_fmac_f32 v246, v248, v248
  v_fmac_f32 v247, v249, v249
  s_waitcnt lgkmcnt(8)
  v_mfma_f32_32x32x16_bf16 v[96:111], v[40:43], v[128:131], v[96:111]
  ds_read_b64_tr_b16 v[58:59], v13 offset:54272
  ds_read_b64_tr_b16 v[60:61], v14 offset:53248
  ds_read_b64_tr_b16 v[62:63], v14 offset:54272
  v_lshlrev_b32 v250, 16, v129
  v_and_b32 v251, s58, v129
  v_add_f32 v244, v244, v250
  s_waitcnt lgkmcnt(9)
  v_mfma_f32_32x32x16_bf16 v[112:127], v[44:47], v[128:131], v[112:127]
  v_add_f32 v245, v245, v251
  v_fmac_f32 v246, v250, v250
  v_fmac_f32 v247, v251, v251
  s_waitcnt lgkmcnt(6)
  v_mfma_f32_32x32x16_bf16 v[64:79], v[48:51], v[132:135], v[64:79]
  ds_read_b128 v[136:139], v242 offset:49152
  ds_read_b64_tr_b16 v[32:33], v11 offset:57344
  ds_read_b64_tr_b16 v[34:35], v11 offset:58368
  v_lshlrev_b32 v248, 16, v130
  v_and_b32 v249, s58, v130
  v_add_f32 v244, v244, v248
  s_waitcnt lgkmcnt(7)
  v_mfma_f32_32x32x16_bf16 v[80:95], v[52:55], v[132:135], v[80:95]
  ds_read_b64_tr_b16 v[36:37], v12 offset:57344
  ds_read_b64_tr_b16 v[38:39], v12 offset:58368
  ds_read_b64_tr_b16 v[40:41], v13 offset:57344
  v_add_f32 v245, v245, v249
  v_fmac_f32 v246, v248, v248
  v_fmac_f32 v247, v249, v249
  s_waitcnt lgkmcnt(8)
  v_mfma_f32_32x32x16_bf16 v[96:111], v[56:59], v[132:135], v[96:111]
  ds_read_b64_tr_b16 v[42:43], v13 offset:58368
  ds_read_b64_tr_b16 v[44:45], v14 offset:57344
  ds_read_b64_tr_b16 v[46:47], v14 offset:58368
  v_lshlrev_b32 v250, 16, v131
  v_and_b32 v251, s58, v131
  v_add_f32 v244, v244, v250
  s_waitcnt lgkmcnt(9)
  v_mfma_f32_32x32x16_bf16 v[112:127], v[60:63], v[132:135], v[112:127]
  v_add_f32 v245, v245, v251
  v_fmac_f32 v246, v250, v250
  v_fmac_f32 v247, v251, v251
  s_waitcnt lgkmcnt(6)
  v_mfma_f32_32x32x16_bf16 v[64:79], v[32:35], v[136:139], v[64:79]
  ds_read_b128 v[140:143], v243 offset:49152
  ds_read_b64_tr_b16 v[48:49], v11 offset:61440
  ds_read_b64_tr_b16 v[50:51], v11 offset:62464
  v_lshlrev_b32 v248, 16, v136
  v_and_b32 v249, s58, v136
  v_add_f32 v244, v244, v248
  s_waitcnt lgkmcnt(7)
  v_mfma_f32_32x32x16_bf16 v[80:95], v[36:39], v[136:139], v[80:95]
  ds_read_b64_tr_b16 v[52:53], v12 offset:61440
  ds_read_b64_tr_b16 v[54:55], v12 offset:62464
  ds_read_b64_tr_b16 v[56:57], v13 offset:61440
  v_add_f32 v245, v245, v249
  v_fmac_f32 v246, v248, v248
  v_fmac_f32 v247, v249, v249
  s_waitcnt lgkmcnt(8)
  v_mfma_f32_32x32x16_bf16 v[96:111], v[40:43], v[136:139], v[96:111]
  ds_read_b64_tr_b16 v[58:59], v13 offset:62464
  ds_read_b64_tr_b16 v[60:61], v14 offset:61440
  ds_read_b64_tr_b16 v[62:63], v14 offset:62464
  v_lshlrev_b32 v250, 16, v137
  v_and_b32 v251, s58, v137
  v_add_f32 v244, v244, v250
  s_waitcnt lgkmcnt(9)
  v_mfma_f32_32x32x16_bf16 v[112:127], v[44:47], v[136:139], v[112:127]
  v_add_f32 v245, v245, v251
  v_fmac_f32 v246, v250, v250
  v_fmac_f32 v247, v251, v251
  s_waitcnt lgkmcnt(6)
  v_mfma_f32_32x32x16_bf16 v[64:79], v[48:51], v[140:143], v[64:79]
  s_waitcnt lgkmcnt(0)
  s_barrier
  ds_read_b128 v[128:131], v240 offset:0
  ds_read_b64_tr_b16 v[32:33], v11 offset:0
  ds_read_b64_tr_b16 v[34:35], v11 offset:1024
  v_lshlrev_b32 v248, 16, v138
  v_and_b32 v249, s58, v138
  v_add_f32 v244, v244, v248
  v_mfma_f32_32x32x16_bf16 v[80:95], v[52:55], v[140:143], v[80:95]
  ds_read_b64_tr_b16 v[36:37], v12 offset:0
  ds_read_b64_tr_b16 v[38:39], v12 offset:1024
  ds_read_b64_tr_b16 v[40:41], v13 offset:0
  v_add_f32 v245, v245, v249
  v_fmac_f32 v246, v248, v248
  v_fmac_f32 v247, v249, v249
  v_mfma_f32_32x32x16_bf16 v[96:111], v[56:59], v[140:143], v[96:111]
  ds_read_b64_tr_b16 v[42:43], v13 offset:1024
  ds_read_b64_tr_b16 v[44:45], v14 offset:0
  ds_read_b64_tr_b16 v[46:47], v14 offset:1024
  v_lshlrev_b32 v250, 16, v139
  v_and_b32 v251, s58, v139
  v_add_f32 v244, v244, v250
  v_mfma_f32_32x32x16_bf16 v[112:127], v[60:63], v[140:143], v[112:127]
  v_add_f32 v245, v245, v251
  v_fmac_f32 v246, v250, v250
  v_fmac_f32 v247, v251, v251
  s_waitcnt lgkmcnt(6)
  v_mfma_f32_32x32x16_bf16 v[64:79], v[32:35], v[128:131], v[64:79]
  ds_read_b128 v[132:135], v241 offset:0
  ds_read_b64_tr_b16 v[48:49], v11 offset:4096
  ds_read_b64_tr_b16 v[50:51], v11 offset:5120
  v_lshlrev_b32 v248, 16, v128
  v_and_b32 v249, s58, v128
  v_add_f32 v244, v244, v248
  s_waitcnt lgkmcnt(7)
  v_mfma_f32_32x32x16_bf16 v[80:95], v[36:39], v[128:131], v[80:95]
  ds_read_b64_tr_b16 v[52:53], v12 offset:4096
  ds_read_b64_tr_b16 v[54:55], v12 offset:5120
  ds_read_b64_tr_b16 v[56:57], v13 offset:4096
  v_add_f32 v245, v245, v249
  v_fmac_f32 v246, v248, v248
  v_fmac_f32 v247, v249, v249
  s_waitcnt lgkmcnt(8)
  v_mfma_f32_32x32x16_bf16 v[96:111], v[40:43], v[128:131], v[96:111]
  ds_read_b64_tr_b16 v[58:59], v13 offset:5120
  ds_read_b64_tr_b16 v[60:61], v14 offset:4096
  ds_read_b64_tr_b16 v[62:63], v14 offset:5120
  v_lshlrev_b32 v250, 16, v129
  v_and_b32 v251, s58, v129
  v_add_f32 v244, v244, v250
  s_waitcnt lgkmcnt(9)
  v_mfma_f32_32x32x16_bf16 v[112:127], v[44:47], v[128:131], v[112:127]
  v_add_f32 v245, v245, v251
  v_fmac_f32 v246, v250, v250
  v_fmac_f32 v247, v251, v251
  s_waitcnt lgkmcnt(6)
  v_mfma_f32_32x32x16_bf16 v[64:79], v[48:51], v[132:135], v[64:79]
  ds_read_b128 v[136:139], v242 offset:0
  ds_read_b64_tr_b16 v[32:33], v11 offset:8192
  ds_read_b64_tr_b16 v[34:35], v11 offset:9216
  v_lshlrev_b32 v248, 16, v130
  v_and_b32 v249, s58, v130
  v_add_f32 v244, v244, v248
  s_waitcnt lgkmcnt(7)
  v_mfma_f32_32x32x16_bf16 v[80:95], v[52:55], v[132:135], v[80:95]
  ds_read_b64_tr_b16 v[36:37], v12 offset:8192
  ds_read_b64_tr_b16 v[38:39], v12 offset:9216
  ds_read_b64_tr_b16 v[40:41], v13 offset:8192
  v_add_f32 v245, v245, v249
  v_fmac_f32 v246, v248, v248
  v_fmac_f32 v247, v249, v249
  s_waitcnt lgkmcnt(8)
  v_mfma_f32_32x32x16_bf16 v[96:111], v[56:59], v[132:135], v[96:111]
  ds_read_b64_tr_b16 v[42:43], v13 offset:9216
  ds_read_b64_tr_b16 v[44:45], v14 offset:8192
  ds_read_b64_tr_b16 v[46:47], v14 offset:9216
  v_lshlrev_b32 v250, 16, v131
  v_and_b32 v251, s58, v131
  v_add_f32 v244, v244, v250
  s_waitcnt lgkmcnt(9)
  v_mfma_f32_32x32x16_bf16 v[112:127], v[60:63], v[132:135], v[112:127]
  v_add_f32 v245, v245, v251
  v_fmac_f32 v246, v250, v250
  v_fmac_f32 v247, v251, v251
  s_waitcnt lgkmcnt(6)
  v_mfma_f32_32x32x16_bf16 v[64:79], v[32:35], v[136:139], v[64:79]
  ds_read_b128 v[140:143], v243 offset:0
  ds_read_b64_tr_b16 v[48:49], v11 offset:12288
  ds_read_b64_tr_b16 v[50:51], v11 offset:13312
  v_lshlrev_b32 v248, 16, v136
  v_and_b32 v249, s58, v136
  v_add_f32 v244, v244, v248
  s_waitcnt lgkmcnt(7)
  v_mfma_f32_32x32x16_bf16 v[80:95], v[36:39], v[136:139], v[80:95]
  ds_read_b64_tr_b16 v[52:53], v12 offset:12288
  ds_read_b64_tr_b16 v[54:55], v12 offset:13312
  ds_read_b64_tr_b16 v[56:57], v13 offset:12288
  v_add_f32 v245, v245, v249
  v_fmac_f32 v246, v248, v248
  v_fmac_f32 v247, v249, v249
  s_waitcnt lgkmcnt(8)
  v_mfma_f32_32x32x16_bf16 v[96:111], v[40:43], v[136:139], v[96:111]
  ds_read_b64_tr_b16 v[58:59], v13 offset:13312
  ds_read_b64_tr_b16 v[60:61], v14 offset:12288
  ds_read_b64_tr_b16 v[62:63], v14 offset:13312
  v_lshlrev_b32 v250, 16, v137
  v_and_b32 v251, s58, v137
  v_add_f32 v244, v244, v250
  s_waitcnt lgkmcnt(9)
  v_mfma_f32_32x32x16_bf16 v[112:127], v[44:47], v[136:139], v[112:127]
  v_add_f32 v245, v245, v251
  v_fmac_f32 v246, v250, v250
  v_fmac_f32 v247, v251, v251
  s_waitcnt lgkmcnt(6)
  v_mfma_f32_32x32x16_bf16 v[64:79], v[48:51], v[140:143], v[64:79]
  s_waitcnt lgkmcnt(0)
  s_barrier
  ds_read_b128 v[128:131], v240 offset:16384
  ds_read_b64_tr_b16 v[32:33], v11 offset:16384
  ds_read_b64_tr_b16 v[34:35], v11 offset:17408
  v_lshlrev_b32 v248, 16, v138
  v_and_b32 v249, s58, v138
  v_add_f32 v244, v244, v248
  v_mfma_f32_32x32x16_bf16 v[80:95], v[52:55], v[140:143], v[80:95]
  ds_read_b64_tr_b16 v[36:37], v12 offset:16384
  ds_read_b64_tr_b16 v[38:39], v12 offset:17408
  ds_read_b64_tr_b16 v[40:41], v13 offset:16384
  v_add_f32 v245, v245, v249
  v_fmac_f32 v246, v248, v248
  v_fmac_f32 v247, v249, v249
  v_mfma_f32_32x32x16_bf16 v[96:111], v[56:59], v[140:143], v[96:111]
  ds_read_b64_tr_b16 v[42:43], v13 offset:17408
  ds_read_b64_tr_b16 v[44:45], v14 offset:16384
  ds_read_b64_tr_b16 v[46:47], v14 offset:17408
  v_lshlrev_b32 v250, 16, v139
  v_and_b32 v251, s58, v139
  v_add_f32 v244, v244, v250
  v_mfma_f32_32x32x16_bf16 v[112:127], v[60:63], v[140:143], v[112:127]
  v_add_f32 v245, v245, v251
  v_fmac_f32 v246, v250, v250
  v_fmac_f32 v247, v251, v251
  s_waitcnt lgkmcnt(6)
  v_mfma_f32_32x32x16_bf16 v[64:79], v[32:35], v[128:131], v[64:79]
  ds_read_b128 v[132:135], v241 offset:16384
  ds_read_b64_tr_b16 v[48:49], v11 offset:20480
  ds_read_b64_tr_b16 v[50:51], v11 offset:21504
  v_lshlrev_b32 v248, 16, v128
  v_and_b32 v249, s58, v128
  v_add_f32 v244, v244, v248
  s_waitcnt lgkmcnt(7)
  v_mfma_f32_32x32x16_bf16 v[80:95], v[36:39], v[128:131], v[80:95]
  ds_read_b64_tr_b16 v[52:53], v12 offset:20480
  ds_read_b64_tr_b16 v[54:55], v12 offset:21504
  ds_read_b64_tr_b16 v[56:57], v13 offset:20480
  v_add_f32 v245, v245, v249
  v_fmac_f32 v246, v248, v248
  v_fmac_f32 v247, v249, v249
  s_waitcnt lgkmcnt(8)
  v_mfma_f32_32x32x16_bf16 v[96:111], v[40:43], v[128:131], v[96:111]
  ds_read_b64_tr_b16 v[58:59], v13 offset:21504
  ds_read_b64_tr_b16 v[60:61], v14 offset:20480
  ds_read_b64_tr_b16 v[62:63], v14 offset:21504
  v_lshlrev_b32 v250, 16, v129
  v_and_b32 v251, s58, v129
  v_add_f32 v244, v244, v250
  s_waitcnt lgkmcnt(9)
  v_mfma_f32_32x32x16_bf16 v[112:127], v[44:47], v[128:131], v[112:127]
  v_add_f32 v245, v245, v251
  v_fmac_f32 v246, v250, v250
  v_fmac_f32 v247, v251, v251
  s_waitcnt lgkmcnt(6)
  v_mfma_f32_32x32x16_bf16 v[64:79], v[48:51], v[132:135], v[64:79]
  ds_read_b128 v[136:139], v242 offset:16384
  ds_read_b64_tr_b16 v[32:33], v11 offset:24576
  ds_read_b64_tr_b16 v[34:35], v11 offset:25600
  v_lshlrev_b32 v248, 16, v130
  v_and_b32 v249, s58, v130
  v_add_f32 v244, v244, v248
  s_waitcnt lgkmcnt(7)
  v_mfma_f32_32x32x16_bf16 v[80:95], v[52:55], v[132:135], v[80:95]
  ds_read_b64_tr_b16 v[36:37], v12 offset:24576
  ds_read_b64_tr_b16 v[38:39], v12 offset:25600
  ds_read_b64_tr_b16 v[40:41], v13 offset:24576
  v_add_f32 v245, v245, v249
  v_fmac_f32 v246, v248, v248
  v_fmac_f32 v247, v249, v249
  s_waitcnt lgkmcnt(8)
  v_mfma_f32_32x32x16_bf16 v[96:111], v[56:59], v[132:135], v[96:111]
  ds_read_b64_tr_b16 v[42:43], v13 offset:25600
  ds_read_b64_tr_b16 v[44:45], v14 offset:24576
  ds_read_b64_tr_b16 v[46:47], v14 offset:25600
  v_lshlrev_b32 v250, 16, v131
  v_and_b32 v251, s58, v131
  v_add_f32 v244, v244, v250
  s_waitcnt lgkmcnt(9)
  v_mfma_f32_32x32x16_bf16 v[112:127], v[60:63], v[132:135], v[112:127]
  v_add_f32 v245, v245, v251
  v_fmac_f32 v246, v250, v250
  v_fmac_f32 v247, v251, v251
  s_waitcnt lgkmcnt(6)
  v_mfma_f32_32x32x16_bf16 v[64:79], v[32:35], v[136:139], v[64:79]
  ds_read_b128 v[140:143], v243 offset:16384
  ds_read_b64_tr_b16 v[48:49], v11 offset:28672
  ds_read_b64_tr_b16 v[50:51], v11 offset:29696
  v_lshlrev_b32 v248, 16, v136
  v_and_b32 v249, s58, v136
  v_add_f32 v244, v244, v248
  s_waitcnt lgkmcnt(7)
  v_mfma_f32_32x32x16_bf16 v[80:95], v[36:39], v[136:139], v[80:95]
  ds_read_b64_tr_b16 v[52:53], v12 offset:28672
  ds_read_b64_tr_b16 v[54:55], v12 offset:29696
  ds_read_b64_tr_b16 v[56:57], v13 offset:28672
  v_add_f32 v245, v245, v249
  v_fmac_f32 v246, v248, v248
  v_fmac_f32 v247, v249, v249
  s_waitcnt lgkmcnt(8)
  v_mfma_f32_32x32x16_bf16 v[96:111], v[40:43], v[136:139], v[96:111]
  ds_read_b64_tr_b16 v[58:59], v13 offset:29696
  ds_read_b64_tr_b16 v[60:61], v14 offset:28672
  ds_read_b64_tr_b16 v[62:63], v14 offset:29696
  v_lshlrev_b32 v250, 16, v137
  v_and_b32 v251, s58, v137
  v_add_f32 v244, v244, v250
  s_waitcnt lgkmcnt(9)
  v_mfma_f32_32x32x16_bf16 v[112:127], v[44:47], v[136:139], v[112:127]
  v_add_f32 v245, v245, v251
  v_fmac_f32 v246, v250, v250
  v_fmac_f32 v247, v251, v251
  s_waitcnt lgkmcnt(6)
  v_mfma_f32_32x32x16_bf16 v[64:79], v[48:51], v[140:143], v[64:79]
  s_waitcnt lgkmcnt(0)
  s_barrier
  ds_read_b128 v[128:131], v240 offset:32768
  ds_read_b64_tr_b16 v[32:33], v11 offset:32768
  ds_read_b64_tr_b16 v[34:35], v11 offset:33792
  v_lshlrev_b32 v248, 16, v138
  v_and_b32 v249, s58, v138
  v_add_f32 v244, v244, v248
  v_mfma_f32_32x32x16_bf16 v[80:95], v[52:55], v[140:143], v[80:95]
  ds_read_b64_tr_b16 v[36:37], v12 offset:32768
  ds_read_b64_tr_b16 v[38:39], v12 offset:33792
  ds_read_b64_tr_b16 v[40:41], v13 offset:32768
  v_add_f32 v245, v245, v249
  v_fmac_f32 v246, v248, v248
  v_fmac_f32 v247, v249, v249
  v_mfma_f32_32x32x16_bf16 v[96:111], v[56:59], v[140:143], v[96:111]
  ds_read_b64_tr_b16 v[42:43], v13 offset:33792
  ds_read_b64_tr_b16 v[44:45], v14 offset:32768
  ds_read_b64_tr_b16 v[46:47], v14 offset:33792
  v_lshlrev_b32 v250, 16, v139
  v_and_b32 v251, s58, v139
  v_add_f32 v244, v244, v250
  v_mfma_f32_32x32x16_bf16 v[112:127], v[60:63], v[140:143], v[112:127]
  v_add_f32 v245, v245, v251
  v_fmac_f32 v246, v250, v250
  v_fmac_f32 v247, v251, v251
  s_waitcnt lgkmcnt(6)
  v_mfma_f32_32x32x16_bf16 v[64:79], v[32:35], v[128:131], v[64:79]
  ds_read_b128 v[132:135], v241 offset:32768
  ds_read_b64_tr_b16 v[48:49], v11 offset:36864
  ds_read_b64_tr_b16 v[50:51], v11 offset:37888
  v_lshlrev_b32 v248, 16, v128
  v_and_b32 v249, s58, v128
  v_add_f32 v244, v244, v248
  s_waitcnt lgkmcnt(7)
  v_mfma_f32_32x32x16_bf16 v[80:95], v[36:39], v[128:131], v[80:95]
  ds_read_b64_tr_b16 v[52:53], v12 offset:36864
  ds_read_b64_tr_b16 v[54:55], v12 offset:37888
  ds_read_b64_tr_b16 v[56:57], v13 offset:36864
  v_add_f32 v245, v245, v249
  v_fmac_f32 v246, v248, v248
  v_fmac_f32 v247, v249, v249
  s_waitcnt lgkmcnt(8)
  v_mfma_f32_32x32x16_bf16 v[96:111], v[40:43], v[128:131], v[96:111]
  ds_read_b64_tr_b16 v[58:59], v13 offset:37888
  ds_read_b64_tr_b16 v[60:61], v14 offset:36864
  ds_read_b64_tr_b16 v[62:63], v14 offset:37888
  v_lshlrev_b32 v250, 16, v129
  v_and_b32 v251, s58, v129
  v_add_f32 v244, v244, v250
  s_waitcnt lgkmcnt(9)
  v_mfma_f32_32x32x16_bf16 v[112:127], v[44:47], v[128:131], v[112:127]
  v_add_f32 v245, v245, v251
  v_fmac_f32 v246, v250, v250
  v_fmac_f32 v247, v251, v251
  s_waitcnt lgkmcnt(6)
  v_mfma_f32_32x32x16_bf16 v[64:79], v[48:51], v[132:135], v[64:79]
  ds_read_b128 v[136:139], v242 offset:32768
  ds_read_b64_tr_b16 v[32:33], v11 offset:40960
  ds_read_b64_tr_b16 v[34:35], v11 offset:41984
  v_lshlrev_b32 v248, 16, v130
  v_and_b32 v249, s58, v130
  v_add_f32 v244, v244, v248
  s_waitcnt lgkmcnt(7)
  v_mfma_f32_32x32x16_bf16 v[80:95], v[52:55], v[132:135], v[80:95]
  ds_read_b64_tr_b16 v[36:37], v12 offset:40960
  ds_read_b64_tr_b16 v[38:39], v12 offset:41984
  ds_read_b64_tr_b16 v[40:41], v13 offset:40960
  v_add_f32 v245, v245, v249
  v_fmac_f32 v246, v248, v248
  v_fmac_f32 v247, v249, v249
  s_waitcnt lgkmcnt(8)
  v_mfma_f32_32x32x16_bf16 v[96:111], v[56:59], v[132:135], v[96:111]
  ds_read_b64_tr_b16 v[42:43], v13 offset:41984
  ds_read_b64_tr_b16 v[44:45], v14 offset:40960
  ds_read_b64_tr_b16 v[46:47], v14 offset:41984
  v_lshlrev_b32 v250, 16, v131
  v_and_b32 v251, s58, v131
  v_add_f32 v244, v244, v250
  s_waitcnt lgkmcnt(9)
  v_mfma_f32_32x32x16_bf16 v[112:127], v[60:63], v[132:135], v[112:127]
  v_add_f32 v245, v245, v251
  v_fmac_f32 v246, v250, v250
  v_fmac_f32 v247, v251, v251
  s_waitcnt lgkmcnt(6)
  v_mfma_f32_32x32x16_bf16 v[64:79], v[32:35], v[136:139], v[64:79]
  ds_read_b128 v[140:143], v243 offset:32768
  ds_read_b64_tr_b16 v[48:49], v11 offset:45056
  ds_read_b64_tr_b16 v[50:51], v11 offset:46080
  v_lshlrev_b32 v248, 16, v136
  v_and_b32 v249, s58, v136
  v_add_f32 v244, v244, v248
  s_waitcnt lgkmcnt(7)
  v_mfma_f32_32x32x16_bf16 v[80:95], v[36:39], v[136:139], v[80:95]
  ds_read_b64_tr_b16 v[52:53], v12 offset:45056
  ds_read_b64_tr_b16 v[54:55], v12 offset:46080
  ds_read_b64_tr_b16 v[56:57], v13 offset:45056
  v_add_f32 v245, v245, v249
  v_fmac_f32 v246, v248, v248
  v_fmac_f32 v247, v249, v249
  s_waitcnt lgkmcnt(8)
  v_mfma_f32_32x32x16_bf16 v[96:111], v[40:43], v[136:139], v[96:111]
  ds_read_b64_tr_b16 v[58:59], v13 offset:46080
  ds_read_b64_tr_b16 v[60:61], v14 offset:45056
  ds_read_b64_tr_b16 v[62:63], v14 offset:46080
  v_lshlrev_b32 v250, 16, v137
  v_and_b32 v251, s58, v137
  v_add_f32 v244, v244, v250
  s_waitcnt lgkmcnt(9)
  v_mfma_f32_32x32x16_bf16 v[112:127], v[44:47], v[136:139], v[112:127]
  v_add_f32 v245, v245, v251
  v_fmac_f32 v246, v250, v250
  v_fmac_f32 v247, v251, v251
  s_waitcnt lgkmcnt(6)
  v_mfma_f32_32x32x16_bf16 v[64:79], v[48:51], v[140:143], v[64:79]
  s_waitcnt lgkmcnt(0)
  s_barrier
  ds_read_b128 v[128:131], v240 offset:49152
  ds_read_b64_tr_b16 v[32:33], v11 offset:49152
  ds_read_b64_tr_b16 v[34:35], v11 offset:50176
  v_lshlrev_b32 v248, 16, v138
  v_and_b32 v249, s58, v138
  v_add_f32 v244, v244, v248
  v_mfma_f32_32x32x16_bf16 v[80:95], v[52:55], v[140:143], v[80:95]
  ds_read_b64_tr_b16 v[36:37], v12 offset:49152
  ds_read_b64_tr_b16 v[38:39], v12 offset:50176
  ds_read_b64_tr_b16 v[40:41], v13 offset:49152
  v_add_f32 v245, v245, v249
  v_fmac_f32 v246, v248, v248
  v_fmac_f32 v247, v249, v249
  v_mfma_f32_32x32x16_bf16 v[96:111], v[56:59], v[140:143], v[96:111]
  ds_read_b64_tr_b16 v[42:43], v13 offset:50176
  ds_read_b64_tr_b16 v[44:45], v14 offset:49152
  ds_read_b64_tr_b16 v[46:47], v14 offset:50176
  v_lshlrev_b32 v250, 16, v139
  v_and_b32 v251, s58, v139
  v_add_f32 v244, v244, v250
  v_mfma_f32_32x32x16_bf16 v[112:127], v[60:63], v[140:143], v[112:127]
  v_add_f32 v245, v245, v251
  v_fmac_f32 v246, v250, v250
  v_fmac_f32 v247, v251, v251
  s_waitcnt lgkmcnt(6)
  v_mfma_f32_32x32x16_bf16 v[64:79], v[32:35], v[128:131], v[64:79]
  ds_read_b128 v[132:135], v241 offset:49152
  ds_read_b64_tr_b16 v[48:49], v11 offset:53248
  ds_read_b64_tr_b16 v[50:51], v11 offset:54272
  v_lshlrev_b32 v248, 16, v128
  v_and_b32 v249, s58, v128
  v_add_f32 v244, v244, v248
  s_waitcnt lgkmcnt(7)
  v_mfma_f32_32x32x16_bf16 v[80:95], v[36:39], v[128:131], v[80:95]
  ds_read_b64_tr_b16 v[52:53], v12 offset:53248
  ds_read_b64_tr_b16 v[54:55], v12 offset:54272
  ds_read_b64_tr_b16 v[56:57], v13 offset:53248
  v_add_f32 v245, v245, v249
  v_fmac_f32 v246, v248, v248
  v_fmac_f32 v247, v249, v249
  s_waitcnt lgkmcnt(8)
  v_mfma_f32_32x32x16_bf16 v[96:111], v[40:43], v[128:131], v[96:111]
  ds_read_b64_tr_b16 v[58:59], v13 offset:54272
  ds_read_b64_tr_b16 v[60:61], v14 offset:53248
  ds_read_b64_tr_b16 v[62:63], v14 offset:54272
  v_lshlrev_b32 v250, 16, v129
  v_and_b32 v251, s58, v129
  v_add_f32 v244, v244, v250
  s_waitcnt lgkmcnt(9)
  v_mfma_f32_32x32x16_bf16 v[112:127], v[44:47], v[128:131], v[112:127]
  v_add_f32 v245, v245, v251
  v_fmac_f32 v246, v250, v250
  v_fmac_f32 v247, v251, v251
  s_waitcnt lgkmcnt(6)
  v_mfma_f32_32x32x16_bf16 v[64:79], v[48:51], v[132:135], v[64:79]
  ds_read_b128 v[136:139], v242 offset:49152
  ds_read_b64_tr_b16 v[32:33], v11 offset:57344
  ds_read_b64_tr_b16 v[34:35], v11 offset:58368
  v_lshlrev_b32 v248, 16, v130
  v_and_b32 v249, s58, v130
  v_add_f32 v244, v244, v248
  s_waitcnt lgkmcnt(7)
  v_mfma_f32_32x32x16_bf16 v[80:95], v[52:55], v[132:135], v[80:95]
  ds_read_b64_tr_b16 v[36:37], v12 offset:57344
  ds_read_b64_tr_b16 v[38:39], v12 offset:58368
  ds_read_b64_tr_b16 v[40:41], v13 offset:57344
  v_add_f32 v245, v245, v249
  v_fmac_f32 v246, v248, v248
  v_fmac_f32 v247, v249, v249
  s_waitcnt lgkmcnt(8)
  v_mfma_f32_32x32x16_bf16 v[96:111], v[56:59], v[132:135], v[96:111]
  ds_read_b64_tr_b16 v[42:43], v13 offset:58368
  ds_read_b64_tr_b16 v[44:45], v14 offset:57344
  ds_read_b64_tr_b16 v[46:47], v14 offset:58368
  v_lshlrev_b32 v250, 16, v131
  v_and_b32 v251, s58, v131
  v_add_f32 v244, v244, v250
  s_waitcnt lgkmcnt(9)
  v_mfma_f32_32x32x16_bf16 v[112:127], v[60:63], v[132:135], v[112:127]
  v_add_f32 v245, v245, v251
  v_fmac_f32 v246, v250, v250
  v_fmac_f32 v247, v251, v251
  s_waitcnt lgkmcnt(6)
  v_mfma_f32_32x32x16_bf16 v[64:79], v[32:35], v[136:139], v[64:79]
  ds_read_b128 v[140:143], v243 offset:49152
  ds_read_b64_tr_b16 v[48:49], v11 offset:61440
  ds_read_b64_tr_b16 v[50:51], v11 offset:62464
  v_lshlrev_b32 v248, 16, v136
  v_and_b32 v249, s58, v136
  v_add_f32 v244, v244, v248
  s_waitcnt lgkmcnt(7)
  v_mfma_f32_32x32x16_bf16 v[80:95], v[36:39], v[136:139], v[80:95]
  ds_read_b64_tr_b16 v[52:53], v12 offset:61440
  ds_read_b64_tr_b16 v[54:55], v12 offset:62464
  ds_read_b64_tr_b16 v[56:57], v13 offset:61440
  v_add_f32 v245, v245, v249
  v_fmac_f32 v246, v248, v248
  v_fmac_f32 v247, v249, v249
  s_waitcnt lgkmcnt(8)
  v_mfma_f32_32x32x16_bf16 v[96:111], v[40:43], v[136:139], v[96:111]
  ds_read_b64_tr_b16 v[58:59], v13 offset:62464
  ds_read_b64_tr_b16 v[60:61], v14 offset:61440
  ds_read_b64_tr_b16 v[62:63], v14 offset:62464
  v_lshlrev_b32 v250, 16, v137
  v_and_b32 v251, s58, v137
  v_add_f32 v244, v244, v250
  s_waitcnt lgkmcnt(9)
  v_mfma_f32_32x32x16_bf16 v[112:127], v[44:47], v[136:139], v[112:127]
  v_add_f32 v245, v245, v251
  v_fmac_f32 v246, v250, v250
  v_fmac_f32 v247, v251, v251
  s_waitcnt lgkmcnt(6)
  v_mfma_f32_32x32x16_bf16 v[64:79], v[48:51], v[140:143], v[64:79]
  v_lshlrev_b32 v248, 16, v138
  v_and_b32 v249, s58, v138
  v_add_f32 v244, v244, v248
  s_waitcnt lgkmcnt(4)
  v_mfma_f32_32x32x16_bf16 v[80:95], v[52:55], v[140:143], v[80:95]
  v_add_f32 v245, v245, v249
  v_fmac_f32 v246, v248, v248
  v_fmac_f32 v247, v249, v249
  s_waitcnt lgkmcnt(2)
  v_mfma_f32_32x32x16_bf16 v[96:111], v[56:59], v[140:143], v[96:111]
  v_lshlrev_b32 v250, 16, v139
  v_and_b32 v251, s58, v139
  v_add_f32 v244, v244, v250
  s_waitcnt lgkmcnt(0)
  v_mfma_f32_32x32x16_bf16 v[112:127], v[60:63], v[140:143], v[112:127]
  v_add_f32 v245, v245, v251
  v_fmac_f32 v246, v250, v250
  v_fmac_f32 v247, v251, v251
  v_add_f32 v244, v244, v245
  v_add_f32 v246, v246, v247
  v_mov_b32 v245, v244
  v_mov_b32 v247, v246
  s_lshl_b32 s43, s37, 9
  v_permlane32_swap_b32 v244, v245
  v_permlane32_swap_b32 v246, v247
  s_add_u32 s43, s43, 155648
  v_and_b32 v4, 31, v1
  v_add_f32 v244, v244, v245
  v_add_f32 v245, v246, v247
  v_lshl_add_u32 v4, v4, 3, s43
  ds_write_b64 v4, v[244:245] offset:4608

  s_waitcnt lgkmcnt(0)
  s_barrier
  ds_read_b64 v[246:247], v4 offset:256
  v_lshrrev_b32 v3, 5, v1
  v_lshlrev_b32 v3, 4, v3
  v_add_u32 v3, 157696, v3
  s_lshl_b32 s43, s39, 2
  buffer_load_dword v253, off, s[32:35], s43 sc1

  ds_read_b128 v[144:147], v3 offset:0
  ds_read_b128 v[148:151], v3 offset:32
  ds_read_b128 v[152:155], v3 offset:64
  ds_read_b128 v[156:159], v3 offset:96
  ds_read_b128 v[160:163], v3 offset:128
  ds_read_b128 v[164:167], v3 offset:160
  ds_read_b128 v[168:171], v3 offset:192
  ds_read_b128 v[172:175], v3 offset:224
  ds_read_b128 v[176:179], v3 offset:256
  ds_read_b128 v[180:183], v3 offset:288
  ds_read_b128 v[184:187], v3 offset:320
  ds_read_b128 v[188:191], v3 offset:352
  ds_read_b128 v[192:195], v3 offset:384
  ds_read_b128 v[196:199], v3 offset:416
  s_waitcnt lgkmcnt(12)
  ds_read_b128 v[200:203], v3 offset:448
  ds_read_b128 v[204:207], v3 offset:480
  v_add_f32 v244, v244, v246
  v_add_f32 v245, v245, v247

  v_mul_f32 v244, 0x3b000000, v244
  v_mul_f32 v245, 0x3b000000, v245
  v_fma_f32 v245, -v244, v244, v245
  v_max_f32 v245, 0, v245
  v_cvt_pk_bf16_f32 v246, v244, v245
  v_lshlrev_b32 v236, 16, v246
  v_and_b32 v245, s58, v246
  v_add_f32 v245, 0x3727c5ac, v245
  v_cvt_pk_bf16_f32 v245, v245, v245
  v_and_b32 v245, s58, v245
  v_sqrt_f32 v245, v245
  s_nop 0
  v_cvt_pk_bf16_f32 v245, v245, v245
  v_and_b32 v245, s58, v245
  v_rcp_f32 v238, v245
  s_nop 0
  v_fma_f32 v244, -v245, v238, 1.0
  v_fma_f32 v238, v244, v238, v238
  v_mul_f32 v236, v236, v238
  v_xor_b32 v236, 0x80000000, v236

  v_mov_b32 v232, v245
  v_mul_f32 v234, v236, v245
  v_mul_f32 v228, 0xc0135761, v238
  v_mul_f32 v230, 0xbdd2d3e8, v238
  v_mul_f32 v230, v230, v238
  v_mul_f32 v230, v230, v238

  v_mov_b32 v244, 0
  v_mov_b32 v245, 0
  v_mov_b32 v246, 0
  v_mov_b32 v247, 0
  s_add_u32 s52, s59, 6291456
  s_waitcnt lgkmcnt(14)
  v_fmac_f32 v64, v144, v234
  v_fmac_f32 v65, v145, v234
  v_fmac_f32 v66, v146, v234
  v_fmac_f32 v67, v147, v234
  v_fmac_f32 v68, v148, v234
  v_fmac_f32 v69, v149, v234
  v_fmac_f32 v70, v150, v234
  v_fmac_f32 v71, v151, v234
  v_mul_f32 v144, v64, v64
  v_mul_f32 v145, v65, v65
  v_mul_f32 v146, v66, v66
  v_mul_f32 v147, v67, v67
  v_mul_f32 v148, v68, v68
  v_mul_f32 v149, v69, v69
  v_mul_f32 v150, v70, v70
  v_mul_f32 v151, v71, v71
  v_fma_f32 v144, v144, v230, v228
  v_fma_f32 v145, v145, v230, v228
  v_fma_f32 v146, v146, v230, v228
  v_fma_f32 v147, v147, v230, v228
  v_fma_f32 v148, v148, v230, v228
  v_fma_f32 v149, v149, v230, v228
  v_fma_f32 v150, v150, v230, v228
  v_fma_f32 v151, v151, v230, v228
  v_mul_f32 v144, v144, v64
  v_mul_f32 v145, v145, v65
  v_mul_f32 v146, v146, v66
  v_mul_f32 v147, v147, v67
  v_mul_f32 v148, v148, v68
  v_mul_f32 v149, v149, v69
  v_mul_f32 v150, v150, v70
  v_mul_f32 v151, v151, v71
  v_exp_f32 v144, v144
  v_exp_f32 v145, v145
  v_exp_f32 v146, v146
  v_exp_f32 v147, v147
  v_exp_f32 v148, v148
  v_exp_f32 v149, v149
  v_exp_f32 v150, v150
  v_exp_f32 v151, v151
  v_fma_f32 v144, v144, v232, v232
  v_fma_f32 v145, v145, v232, v232
  v_fma_f32 v146, v146, v232, v232
  v_fma_f32 v147, v147, v232, v232
  v_fma_f32 v148, v148, v232, v232
  v_fma_f32 v149, v149, v232, v232
  v_fma_f32 v150, v150, v232, v232
  v_fma_f32 v151, v151, v232, v232
  v_rcp_f32 v144, v144
  v_rcp_f32 v145, v145
  v_rcp_f32 v146, v146
  v_rcp_f32 v147, v147
  v_rcp_f32 v148, v148
  v_rcp_f32 v149, v149
  v_rcp_f32 v150, v150
  v_rcp_f32 v151, v151
  v_mul_f32 v64, v144, v64
  v_mul_f32 v65, v145, v65
  v_mul_f32 v66, v146, v66
  v_mul_f32 v67, v147, v67
  v_mul_f32 v68, v148, v68
  v_mul_f32 v69, v149, v69
  v_mul_f32 v70, v150, v70
  v_mul_f32 v71, v151, v71
  s_cmp_ge_u32 s40, 7
  s_cbranch_scc1 L_k1_g2_60

  v_cvt_pk_bf16_f32 v32, v64, v65
  v_cvt_pk_bf16_f32 v33, v66, v67
  v_cvt_pk_bf16_f32 v34, v68, v69
  v_cvt_pk_bf16_f32 v35, v70, v71
  buffer_store_dwordx4 v[32:35], v19, s[24:27], s52 offen offset:0 sc1
  s_branch L_k1_ge_61
L_k1_g2_60:
  v_add_f32 v244, v244, v64
  v_fmac_f32 v246, v64, v64
  v_add_f32 v245, v245, v65
  v_fmac_f32 v247, v65, v65
  v_add_f32 v244, v244, v66
  v_fmac_f32 v246, v66, v66
  v_add_f32 v245, v245, v67
  v_fmac_f32 v247, v67, v67
  v_add_f32 v244, v244, v68
  v_fmac_f32 v246, v68, v68
  v_add_f32 v245, v245, v69
  v_fmac_f32 v247, v69, v69
  v_add_f32 v244, v244, v70
  v_fmac_f32 v246, v70, v70
  v_add_f32 v245, v245, v71
  v_fmac_f32 v247, v71, v71
L_k1_ge_61:
  s_waitcnt lgkmcnt(12)
  v_fmac_f32 v72, v152, v234
  v_fmac_f32 v73, v153, v234
  v_fmac_f32 v74, v154, v234
  v_fmac_f32 v75, v155, v234
  v_fmac_f32 v76, v156, v234
  v_fmac_f32 v77, v157, v234
  v_fmac_f32 v78, v158, v234
  v_fmac_f32 v79, v159, v234
  v_mul_f32 v152, v72, v72
  v_mul_f32 v153, v73, v73
  v_mul_f32 v154, v74, v74
  v_mul_f32 v155, v75, v75
  v_mul_f32 v156, v76, v76
  v_mul_f32 v157, v77, v77
  v_mul_f32 v158, v78, v78
  v_mul_f32 v159, v79, v79
  v_fma_f32 v152, v152, v230, v228
  v_fma_f32 v153, v153, v230, v228
  v_fma_f32 v154, v154, v230, v228
  v_fma_f32 v155, v155, v230, v228
  v_fma_f32 v156, v156, v230, v228
  v_fma_f32 v157, v157, v230, v228
  v_fma_f32 v158, v158, v230, v228
  v_fma_f32 v159, v159, v230, v228
  v_mul_f32 v152, v152, v72
  v_mul_f32 v153, v153, v73
  v_mul_f32 v154, v154, v74
  v_mul_f32 v155, v155, v75
  v_mul_f32 v156, v156, v76
  v_mul_f32 v157, v157, v77
  v_mul_f32 v158, v158, v78
  v_mul_f32 v159, v159, v79
  v_exp_f32 v152, v152
  v_exp_f32 v153, v153
  v_exp_f32 v154, v154
  v_exp_f32 v155, v155
  v_exp_f32 v156, v156
  v_exp_f32 v157, v157
  v_exp_f32 v158, v158
  v_exp_f32 v159, v159
  v_fma_f32 v152, v152, v232, v232
  v_fma_f32 v153, v153, v232, v232
  v_fma_f32 v154, v154, v232, v232
  v_fma_f32 v155, v155, v232, v232
  v_fma_f32 v156, v156, v232, v232
  v_fma_f32 v157, v157, v232, v232
  v_fma_f32 v158, v158, v232, v232
  v_fma_f32 v159, v159, v232, v232
  v_rcp_f32 v152, v152
  v_rcp_f32 v153, v153
  v_rcp_f32 v154, v154
  v_rcp_f32 v155, v155
  v_rcp_f32 v156, v156
  v_rcp_f32 v157, v157
  v_rcp_f32 v158, v158
  v_rcp_f32 v159, v159
  v_mul_f32 v72, v152, v72
  v_mul_f32 v73, v153, v73
  v_mul_f32 v74, v154, v74
  v_mul_f32 v75, v155, v75
  v_mul_f32 v76, v156, v76
  v_mul_f32 v77, v157, v77
  v_mul_f32 v78, v158, v78
  v_mul_f32 v79, v159, v79
  s_cmp_ge_u32 s40, 7
  s_cbranch_scc1 L_k1_g2_62

  v_cvt_pk_bf16_f32 v36, v72, v73
  v_cvt_pk_bf16_f32 v37, v74, v75
  v_cvt_pk_bf16_f32 v38, v76, v77
  v_cvt_pk_bf16_f32 v39, v78, v79
  buffer_store_dwordx4 v[36:39], v19, s[24:27], s52 offen offset:1024 sc1
  s_branch L_k1_ge_63
L_k1_g2_62:
  v_add_f32 v244, v244, v72
  v_fmac_f32 v246, v72, v72
  v_add_f32 v245, v245, v73
  v_fmac_f32 v247, v73, v73
  v_add_f32 v244, v244, v74
  v_fmac_f32 v246, v74, v74
  v_add_f32 v245, v245, v75
  v_fmac_f32 v247, v75, v75
  v_add_f32 v244, v244, v76
  v_fmac_f32 v246, v76, v76
  v_add_f32 v245, v245, v77
  v_fmac_f32 v247, v77, v77
  v_add_f32 v244, v244, v78
  v_fmac_f32 v246, v78, v78
  v_add_f32 v245, v245, v79
  v_fmac_f32 v247, v79, v79
L_k1_ge_63:
  s_waitcnt lgkmcnt(10)
  v_fmac_f32 v80, v160, v234
  v_fmac_f32 v81, v161, v234
  v_fmac_f32 v82, v162, v234
  v_fmac_f32 v83, v163, v234
  v_fmac_f32 v84, v164, v234
  v_fmac_f32 v85, v165, v234
  v_fmac_f32 v86, v166, v234
  v_fmac_f32 v87, v167, v234
  v_mul_f32 v160, v80, v80
  v_mul_f32 v161, v81, v81
  v_mul_f32 v162, v82, v82
  v_mul_f32 v163, v83, v83
  v_mul_f32 v164, v84, v84
  v_mul_f32 v165, v85, v85
  v_mul_f32 v166, v86, v86
  v_mul_f32 v167, v87, v87
  v_fma_f32 v160, v160, v230, v228
  v_fma_f32 v161, v161, v230, v228
  v_fma_f32 v162, v162, v230, v228
  v_fma_f32 v163, v163, v230, v228
  v_fma_f32 v164, v164, v230, v228
  v_fma_f32 v165, v165, v230, v228
  v_fma_f32 v166, v166, v230, v228
  v_fma_f32 v167, v167, v230, v228
  v_mul_f32 v160, v160, v80
  v_mul_f32 v161, v161, v81
  v_mul_f32 v162, v162, v82
  v_mul_f32 v163, v163, v83
  v_mul_f32 v164, v164, v84
  v_mul_f32 v165, v165, v85
  v_mul_f32 v166, v166, v86
  v_mul_f32 v167, v167, v87
  v_exp_f32 v160, v160
  v_exp_f32 v161, v161
  v_exp_f32 v162, v162
  v_exp_f32 v163, v163
  v_exp_f32 v164, v164
  v_exp_f32 v165, v165
  v_exp_f32 v166, v166
  v_exp_f32 v167, v167
  v_fma_f32 v160, v160, v232, v232
  v_fma_f32 v161, v161, v232, v232
  v_fma_f32 v162, v162, v232, v232
  v_fma_f32 v163, v163, v232, v232
  v_fma_f32 v164, v164, v232, v232
  v_fma_f32 v165, v165, v232, v232
  v_fma_f32 v166, v166, v232, v232
  v_fma_f32 v167, v167, v232, v232
  v_rcp_f32 v160, v160
  v_rcp_f32 v161, v161
  v_rcp_f32 v162, v162
  v_rcp_f32 v163, v163
  v_rcp_f32 v164, v164
  v_rcp_f32 v165, v165
  v_rcp_f32 v166, v166
  v_rcp_f32 v167, v167
  v_mul_f32 v80, v160, v80
  v_mul_f32 v81, v161, v81
  v_mul_f32 v82, v162, v82
  v_mul_f32 v83, v163, v83
  v_mul_f32 v84, v164, v84
  v_mul_f32 v85, v165, v85
  v_mul_f32 v86, v166, v86
  v_mul_f32 v87, v167, v87
  s_cmp_ge_u32 s40, 7
  s_cbranch_scc1 L_k1_g2_64

  v_cvt_pk_bf16_f32 v40, v80, v81
  v_cvt_pk_bf16_f32 v41, v82, v83
  v_cvt_pk_bf16_f32 v42, v84, v85
  v_cvt_pk_bf16_f32 v43, v86, v87
  buffer_store_dwordx4 v[40:43], v19, s[24:27], s52 offen offset:2048 sc1
  s_branch L_k1_ge_65
L_k1_g2_64:
  v_add_f32 v244, v244, v80
  v_fmac_f32 v246, v80, v80
  v_add_f32 v245, v245, v81
  v_fmac_f32 v247, v81, v81
  v_add_f32 v244, v244, v82
  v_fmac_f32 v246, v82, v82
  v_add_f32 v245, v245, v83
  v_fmac_f32 v247, v83, v83
  v_add_f32 v244, v244, v84
  v_fmac_f32 v246, v84, v84
  v_add_f32 v245, v245, v85
  v_fmac_f32 v247, v85, v85
  v_add_f32 v244, v244, v86
  v_fmac_f32 v246, v86, v86
  v_add_f32 v245, v245, v87
  v_fmac_f32 v247, v87, v87
L_k1_ge_65:
  s_waitcnt lgkmcnt(8)
  v_fmac_f32 v88, v168, v234
  v_fmac_f32 v89, v169, v234
  v_fmac_f32 v90, v170, v234
  v_fmac_f32 v91, v171, v234
  v_fmac_f32 v92, v172, v234
  v_fmac_f32 v93, v173, v234
  v_fmac_f32 v94, v174, v234
  v_fmac_f32 v95, v175, v234
  v_mul_f32 v168, v88, v88
  v_mul_f32 v169, v89, v89
  v_mul_f32 v170, v90, v90
  v_mul_f32 v171, v91, v91
  v_mul_f32 v172, v92, v92
  v_mul_f32 v173, v93, v93
  v_mul_f32 v174, v94, v94
  v_mul_f32 v175, v95, v95
  v_fma_f32 v168, v168, v230, v228
  v_fma_f32 v169, v169, v230, v228
  v_fma_f32 v170, v170, v230, v228
  v_fma_f32 v171, v171, v230, v228
  v_fma_f32 v172, v172, v230, v228
  v_fma_f32 v173, v173, v230, v228
  v_fma_f32 v174, v174, v230, v228
  v_fma_f32 v175, v175, v230, v228
  v_mul_f32 v168, v168, v88
  v_mul_f32 v169, v169, v89
  v_mul_f32 v170, v170, v90
  v_mul_f32 v171, v171, v91
  v_mul_f32 v172, v172, v92
  v_mul_f32 v173, v173, v93
  v_mul_f32 v174, v174, v94
  v_mul_f32 v175, v175, v95
  v_exp_f32 v168, v168
  v_exp_f32 v169, v169
  v_exp_f32 v170, v170
  v_exp_f32 v171, v171
  v_exp_f32 v172, v172
  v_exp_f32 v173, v173
  v_exp_f32 v174, v174
  v_exp_f32 v175, v175
  v_fma_f32 v168, v168, v232, v232
  v_fma_f32 v169, v169, v232, v232
  v_fma_f32 v170, v170, v232, v232
  v_fma_f32 v171, v171, v232, v232
  v_fma_f32 v172, v172, v232, v232
  v_fma_f32 v173, v173, v232, v232
  v_fma_f32 v174, v174, v232, v232
  v_fma_f32 v175, v175, v232, v232
  v_rcp_f32 v168, v168
  v_rcp_f32 v169, v169
  v_rcp_f32 v170, v170
  v_rcp_f32 v171, v171
  v_rcp_f32 v172, v172
  v_rcp_f32 v173, v173
  v_rcp_f32 v174, v174
  v_rcp_f32 v175, v175
  v_mul_f32 v88, v168, v88
  v_mul_f32 v89, v169, v89
  v_mul_f32 v90, v170, v90
  v_mul_f32 v91, v171, v91
  v_mul_f32 v92, v172, v92
  v_mul_f32 v93, v173, v93
  v_mul_f32 v94, v174, v94
  v_mul_f32 v95, v175, v95
  s_cmp_ge_u32 s40, 7
  s_cbranch_scc1 L_k1_g2_66

  v_cvt_pk_bf16_f32 v44, v88, v89
  v_cvt_pk_bf16_f32 v45, v90, v91
  v_cvt_pk_bf16_f32 v46, v92, v93
  v_cvt_pk_bf16_f32 v47, v94, v95
  buffer_store_dwordx4 v[44:47], v19, s[24:27], s52 offen offset:3072 sc1
  s_branch L_k1_ge_67
L_k1_g2_66:
  v_add_f32 v244, v244, v88
  v_fmac_f32 v246, v88, v88
  v_add_f32 v245, v245, v89
  v_fmac_f32 v247, v89, v89
  v_add_f32 v244, v244, v90
  v_fmac_f32 v246, v90, v90
  v_add_f32 v245, v245, v91
  v_fmac_f32 v247, v91, v91
  v_add_f32 v244, v244, v92
  v_fmac_f32 v246, v92, v92
  v_add_f32 v245, v245, v93
  v_fmac_f32 v247, v93, v93
  v_add_f32 v244, v244, v94
  v_fmac_f32 v246, v94, v94
  v_add_f32 v245, v245, v95
  v_fmac_f32 v247, v95, v95
L_k1_ge_67:
  s_waitcnt lgkmcnt(6)
  v_fmac_f32 v96, v176, v234
  v_fmac_f32 v97, v177, v234
  v_fmac_f32 v98, v178, v234
  v_fmac_f32 v99, v179, v234
  v_fmac_f32 v100, v180, v234
  v_fmac_f32 v101, v181, v234
  v_fmac_f32 v102, v182, v234
  v_fmac_f32 v103, v183, v234
  v_mul_f32 v176, v96, v96
  v_mul_f32 v177, v97, v97
  v_mul_f32 v178, v98, v98
  v_mul_f32 v179, v99, v99
  v_mul_f32 v180, v100, v100
  v_mul_f32 v181, v101, v101
  v_mul_f32 v182, v102, v102
  v_mul_f32 v183, v103, v103
  v_fma_f32 v176, v176, v230, v228
  v_fma_f32 v177, v177, v230, v228
  v_fma_f32 v178, v178, v230, v228
  v_fma_f32 v179, v179, v230, v228
  v_fma_f32 v180, v180, v230, v228
  v_fma_f32 v181, v181, v230, v228
  v_fma_f32 v182, v182, v230, v228
  v_fma_f32 v183, v183, v230, v228
  v_mul_f32 v176, v176, v96
  v_mul_f32 v177, v177, v97
  v_mul_f32 v178, v178, v98
  v_mul_f32 v179, v179, v99
  v_mul_f32 v180, v180, v100
  v_mul_f32 v181, v181, v101
  v_mul_f32 v182, v182, v102
  v_mul_f32 v183, v183, v103
  v_exp_f32 v176, v176
  v_exp_f32 v177, v177
  v_exp_f32 v178, v178
  v_exp_f32 v179, v179
  v_exp_f32 v180, v180
  v_exp_f32 v181, v181
  v_exp_f32 v182, v182
  v_exp_f32 v183, v183
  v_fma_f32 v176, v176, v232, v232
  v_fma_f32 v177, v177, v232, v232
  v_fma_f32 v178, v178, v232, v232
  v_fma_f32 v179, v179, v232, v232
  v_fma_f32 v180, v180, v232, v232
  v_fma_f32 v181, v181, v232, v232
  v_fma_f32 v182, v182, v232, v232
  v_fma_f32 v183, v183, v232, v232
  v_rcp_f32 v176, v176
  v_rcp_f32 v177, v177
  v_rcp_f32 v178, v178
  v_rcp_f32 v179, v179
  v_rcp_f32 v180, v180
  v_rcp_f32 v181, v181
  v_rcp_f32 v182, v182
  v_rcp_f32 v183, v183
  v_mul_f32 v96, v176, v96
  v_mul_f32 v97, v177, v97
  v_mul_f32 v98, v178, v98
  v_mul_f32 v99, v179, v99
  v_mul_f32 v100, v180, v100
  v_mul_f32 v101, v181, v101
  v_mul_f32 v102, v182, v102
  v_mul_f32 v103, v183, v103
  s_cmp_ge_u32 s40, 7
  s_cbranch_scc1 L_k1_g2_68

  v_cvt_pk_bf16_f32 v48, v96, v97
  v_cvt_pk_bf16_f32 v49, v98, v99
  v_cvt_pk_bf16_f32 v50, v100, v101
  v_cvt_pk_bf16_f32 v51, v102, v103
  s_add_u32 s52, s52, 4096
  buffer_store_dwordx4 v[48:51], v19, s[24:27], s52 offen offset:0 sc1
  s_branch L_k1_ge_69
L_k1_g2_68:
  v_add_f32 v244, v244, v96
  v_fmac_f32 v246, v96, v96
  v_add_f32 v245, v245, v97
  v_fmac_f32 v247, v97, v97
  v_add_f32 v244, v244, v98
  v_fmac_f32 v246, v98, v98
  v_add_f32 v245, v245, v99
  v_fmac_f32 v247, v99, v99
  v_add_f32 v244, v244, v100
  v_fmac_f32 v246, v100, v100
  v_add_f32 v245, v245, v101
  v_fmac_f32 v247, v101, v101
  v_add_f32 v244, v244, v102
  v_fmac_f32 v246, v102, v102
  v_add_f32 v245, v245, v103
  v_fmac_f32 v247, v103, v103
L_k1_ge_69:
  s_waitcnt lgkmcnt(4)
  v_fmac_f32 v104, v184, v234
  v_fmac_f32 v105, v185, v234
  v_fmac_f32 v106, v186, v234
  v_fmac_f32 v107, v187, v234
  v_fmac_f32 v108, v188, v234
  v_fmac_f32 v109, v189, v234
  v_fmac_f32 v110, v190, v234
  v_fmac_f32 v111, v191, v234
  v_mul_f32 v184, v104, v104
  v_mul_f32 v185, v105, v105
  v_mul_f32 v186, v106, v106
  v_mul_f32 v187, v107, v107
  v_mul_f32 v188, v108, v108
  v_mul_f32 v189, v109, v109
  v_mul_f32 v190, v110, v110
  v_mul_f32 v191, v111, v111
  v_fma_f32 v184, v184, v230, v228
  v_fma_f32 v185, v185, v230, v228
  v_fma_f32 v186, v186, v230, v228
  v_fma_f32 v187, v187, v230, v228
  v_fma_f32 v188, v188, v230, v228
  v_fma_f32 v189, v189, v230, v228
  v_fma_f32 v190, v190, v230, v228
  v_fma_f32 v191, v191, v230, v228
  v_mul_f32 v184, v184, v104
  v_mul_f32 v185, v185, v105
  v_mul_f32 v186, v186, v106
  v_mul_f32 v187, v187, v107
  v_mul_f32 v188, v188, v108
  v_mul_f32 v189, v189, v109
  v_mul_f32 v190, v190, v110
  v_mul_f32 v191, v191, v111
  v_exp_f32 v184, v184
  v_exp_f32 v185, v185
  v_exp_f32 v186, v186
  v_exp_f32 v187, v187
  v_exp_f32 v188, v188
  v_exp_f32 v189, v189
  v_exp_f32 v190, v190
  v_exp_f32 v191, v191
  v_fma_f32 v184, v184, v232, v232
  v_fma_f32 v185, v185, v232, v232
  v_fma_f32 v186, v186, v232, v232
  v_fma_f32 v187, v187, v232, v232
  v_fma_f32 v188, v188, v232, v232
  v_fma_f32 v189, v189, v232, v232
  v_fma_f32 v190, v190, v232, v232
  v_fma_f32 v191, v191, v232, v232
  v_rcp_f32 v184, v184
  v_rcp_f32 v185, v185
  v_rcp_f32 v186, v186
  v_rcp_f32 v187, v187
  v_rcp_f32 v188, v188
  v_rcp_f32 v189, v189
  v_rcp_f32 v190, v190
  v_rcp_f32 v191, v191
  v_mul_f32 v104, v184, v104
  v_mul_f32 v105, v185, v105
  v_mul_f32 v106, v186, v106
  v_mul_f32 v107, v187, v107
  v_mul_f32 v108, v188, v108
  v_mul_f32 v109, v189, v109
  v_mul_f32 v110, v190, v110
  v_mul_f32 v111, v191, v111
  s_cmp_ge_u32 s40, 7
  s_cbranch_scc1 L_k1_g2_70

  v_cvt_pk_bf16_f32 v52, v104, v105
  v_cvt_pk_bf16_f32 v53, v106, v107
  v_cvt_pk_bf16_f32 v54, v108, v109
  v_cvt_pk_bf16_f32 v55, v110, v111
  buffer_store_dwordx4 v[52:55], v19, s[24:27], s52 offen offset:1024 sc1
  s_branch L_k1_ge_71
L_k1_g2_70:
  v_add_f32 v244, v244, v104
  v_fmac_f32 v246, v104, v104
  v_add_f32 v245, v245, v105
  v_fmac_f32 v247, v105, v105
  v_add_f32 v244, v244, v106
  v_fmac_f32 v246, v106, v106
  v_add_f32 v245, v245, v107
  v_fmac_f32 v247, v107, v107
  v_add_f32 v244, v244, v108
  v_fmac_f32 v246, v108, v108
  v_add_f32 v245, v245, v109
  v_fmac_f32 v247, v109, v109
  v_add_f32 v244, v244, v110
  v_fmac_f32 v246, v110, v110
  v_add_f32 v245, v245, v111
  v_fmac_f32 v247, v111, v111
L_k1_ge_71:
  s_waitcnt lgkmcnt(2)
  v_fmac_f32 v112, v192, v234
  v_fmac_f32 v113, v193, v234
  v_fmac_f32 v114, v194, v234
  v_fmac_f32 v115, v195, v234
  v_fmac_f32 v116, v196, v234
  v_fmac_f32 v117, v197, v234
  v_fmac_f32 v118, v198, v234
  v_fmac_f32 v119, v199, v234
  v_mul_f32 v192, v112, v112
  v_mul_f32 v193, v113, v113
  v_mul_f32 v194, v114, v114
  v_mul_f32 v195, v115, v115
  v_mul_f32 v196, v116, v116
  v_mul_f32 v197, v117, v117
  v_mul_f32 v198, v118, v118
  v_mul_f32 v199, v119, v119
  v_fma_f32 v192, v192, v230, v228
  v_fma_f32 v193, v193, v230, v228
  v_fma_f32 v194, v194, v230, v228
  v_fma_f32 v195, v195, v230, v228
  v_fma_f32 v196, v196, v230, v228
  v_fma_f32 v197, v197, v230, v228
  v_fma_f32 v198, v198, v230, v228
  v_fma_f32 v199, v199, v230, v228
  v_mul_f32 v192, v192, v112
  v_mul_f32 v193, v193, v113
  v_mul_f32 v194, v194, v114
  v_mul_f32 v195, v195, v115
  v_mul_f32 v196, v196, v116
  v_mul_f32 v197, v197, v117
  v_mul_f32 v198, v198, v118
  v_mul_f32 v199, v199, v119
  v_exp_f32 v192, v192
  v_exp_f32 v193, v193
  v_exp_f32 v194, v194
  v_exp_f32 v195, v195
  v_exp_f32 v196, v196
  v_exp_f32 v197, v197
  v_exp_f32 v198, v198
  v_exp_f32 v199, v199
  v_fma_f32 v192, v192, v232, v232
  v_fma_f32 v193, v193, v232, v232
  v_fma_f32 v194, v194, v232, v232
  v_fma_f32 v195, v195, v232, v232
  v_fma_f32 v196, v196, v232, v232
  v_fma_f32 v197, v197, v232, v232
  v_fma_f32 v198, v198, v232, v232
  v_fma_f32 v199, v199, v232, v232
  v_rcp_f32 v192, v192
  v_rcp_f32 v193, v193
  v_rcp_f32 v194, v194
  v_rcp_f32 v195, v195
  v_rcp_f32 v196, v196
  v_rcp_f32 v197, v197
  v_rcp_f32 v198, v198
  v_rcp_f32 v199, v199
  v_mul_f32 v112, v192, v112
  v_mul_f32 v113, v193, v113
  v_mul_f32 v114, v194, v114
  v_mul_f32 v115, v195, v115
  v_mul_f32 v116, v196, v116
  v_mul_f32 v117, v197, v117
  v_mul_f32 v118, v198, v118
  v_mul_f32 v119, v199, v119
  s_cmp_ge_u32 s40, 7
  s_cbranch_scc1 L_k1_g2_72

  v_cvt_pk_bf16_f32 v56, v112, v113
  v_cvt_pk_bf16_f32 v57, v114, v115
  v_cvt_pk_bf16_f32 v58, v116, v117
  v_cvt_pk_bf16_f32 v59, v118, v119
  buffer_store_dwordx4 v[56:59], v19, s[24:27], s52 offen offset:2048 sc1
  s_branch L_k1_ge_73
L_k1_g2_72:
  v_add_f32 v244, v244, v112
  v_fmac_f32 v246, v112, v112
  v_add_f32 v245, v245, v113
  v_fmac_f32 v247, v113, v113
  v_add_f32 v244, v244, v114
  v_fmac_f32 v246, v114, v114
  v_add_f32 v245, v245, v115
  v_fmac_f32 v247, v115, v115
  v_add_f32 v244, v244, v116
  v_fmac_f32 v246, v116, v116
  v_add_f32 v245, v245, v117
  v_fmac_f32 v247, v117, v117
  v_add_f32 v244, v244, v118
  v_fmac_f32 v246, v118, v118
  v_add_f32 v245, v245, v119
  v_fmac_f32 v247, v119, v119
L_k1_ge_73:
  s_waitcnt lgkmcnt(0)
  v_fmac_f32 v120, v200, v234
  v_fmac_f32 v121, v201, v234
  v_fmac_f32 v122, v202, v234
  v_fmac_f32 v123, v203, v234
  v_fmac_f32 v124, v204, v234
  v_fmac_f32 v125, v205, v234
  v_fmac_f32 v126, v206, v234
  v_fmac_f32 v127, v207, v234
  v_mul_f32 v200, v120, v120
  v_mul_f32 v201, v121, v121
  v_mul_f32 v202, v122, v122
  v_mul_f32 v203, v123, v123
  v_mul_f32 v204, v124, v124
  v_mul_f32 v205, v125, v125
  v_mul_f32 v206, v126, v126
  v_mul_f32 v207, v127, v127
  v_fma_f32 v200, v200, v230, v228
  v_fma_f32 v201, v201, v230, v228
  v_fma_f32 v202, v202, v230, v228
  v_fma_f32 v203, v203, v230, v228
  v_fma_f32 v204, v204, v230, v228
  v_fma_f32 v205, v205, v230, v228
  v_fma_f32 v206, v206, v230, v228
  v_fma_f32 v207, v207, v230, v228
  v_mul_f32 v200, v200, v120
  v_mul_f32 v201, v201, v121
  v_mul_f32 v202, v202, v122
  v_mul_f32 v203, v203, v123
  v_mul_f32 v204, v204, v124
  v_mul_f32 v205, v205, v125
  v_mul_f32 v206, v206, v126
  v_mul_f32 v207, v207, v127
  v_exp_f32 v200, v200
  v_exp_f32 v201, v201
  v_exp_f32 v202, v202
  v_exp_f32 v203, v203
  v_exp_f32 v204, v204
  v_exp_f32 v205, v205
  v_exp_f32 v206, v206
  v_exp_f32 v207, v207
  v_fma_f32 v200, v200, v232, v232
  v_fma_f32 v201, v201, v232, v232
  v_fma_f32 v202, v202, v232, v232
  v_fma_f32 v203, v203, v232, v232
  v_fma_f32 v204, v204, v232, v232
  v_fma_f32 v205, v205, v232, v232
  v_fma_f32 v206, v206, v232, v232
  v_fma_f32 v207, v207, v232, v232
  v_rcp_f32 v200, v200
  v_rcp_f32 v201, v201
  v_rcp_f32 v202, v202
  v_rcp_f32 v203, v203
  v_rcp_f32 v204, v204
  v_rcp_f32 v205, v205
  v_rcp_f32 v206, v206
  v_rcp_f32 v207, v207
  v_mul_f32 v120, v200, v120
  v_mul_f32 v121, v201, v121
  v_mul_f32 v122, v202, v122
  v_mul_f32 v123, v203, v123
  v_mul_f32 v124, v204, v124
  v_mul_f32 v125, v205, v125
  v_mul_f32 v126, v206, v126
  v_mul_f32 v127, v207, v127
  s_cmp_ge_u32 s40, 7
  s_cbranch_scc1 L_k1_g2_74

  v_cvt_pk_bf16_f32 v60, v120, v121
  v_cvt_pk_bf16_f32 v61, v122, v123
  v_cvt_pk_bf16_f32 v62, v124, v125
  v_cvt_pk_bf16_f32 v63, v126, v127
  buffer_store_dwordx4 v[60:63], v19, s[24:27], s52 offen offset:3072 sc1
  s_branch L_k1_fin
L_k1_g2_74:
  v_add_f32 v244, v244, v120
  v_fmac_f32 v246, v120, v120
  v_add_f32 v245, v245, v121
  v_fmac_f32 v247, v121, v121
  v_add_f32 v244, v244, v122
  v_fmac_f32 v246, v122, v122
  v_add_f32 v245, v245, v123
  v_fmac_f32 v247, v123, v123
  v_add_f32 v244, v244, v124
  v_fmac_f32 v246, v124, v124
  v_add_f32 v245, v245, v125
  v_fmac_f32 v247, v125, v125
  v_add_f32 v244, v244, v126
  v_fmac_f32 v246, v126, v126
  v_add_f32 v245, v245, v127
  v_fmac_f32 v247, v127, v127
L_k1_ge_75:
  v_add_f32 v244, v244, v245
  v_add_f32 v246, v246, v247
  v_mov_b32 v245, v244
  v_mov_b32 v247, v246
  s_nop 1
  v_permlane32_swap_b32 v244, v245
  v_permlane32_swap_b32 v246, v247
  s_nop 1
  v_add_f32 v244, v244, v245
  v_add_f32 v245, v246, v247
  v_and_b32 v245, 0x7fffffff, v245
  s_waitcnt vmcnt(0)
  s_nop 1
  v_mov_b32_dpp v246, v244 quad_perm:[1,0,3,2] row_mask:0xf bank_mask:0xf
  v_mov_b32_dpp v247, v245 quad_perm:[1,0,3,2] row_mask:0xf bank_mask:0xf
  s_mov_b32 exec_hi, 0
  s_mov_b32 exec_lo, 0x55555555
  buffer_store_dwordx4 v[244:247], v252, s[24:27], s47 offen sc0 sc1
  s_mov_b64 exec, -1
  s_add_u32 s47, s59, 14622720

L_k1_cw:
  v_readfirstlane_b32 s52, v253
  s_nop 3
  s_cmp_ge_u32 s52, 7
  s_cbranch_scc1 L_k1_cok
  s_lshl_b32 s43, s39, 2
  buffer_load_dword v253, off, s[32:35], s43 sc1
  s_waitcnt vmcnt(0)
  s_branch L_k1_cw

L_k1_cok:
  s_mov_b32 s4, -1
  s_mov_b32 s5, 0xffff
  s_lshl_b32 s43, s37, 9
  s_add_u32 s43, s43, 155648
  v_and_b32 v4, 15, v1
  v_lshl_add_u32 v4, v4, 4, s43
  v_add_u32 v252, s43, v252
  s_add_u32 s88, s47, 4096

  s_branch L_k1_g1

L_k1_g3:
  s_mov_b64 exec, -1
  s_branch L_k1_g1
L_k1_g0:
  s_sleep 6
L_k1_g1:
  buffer_load_dwordx4 v[128:131], v19, s[24:27], s3 offen sc1
  buffer_load_dwordx4 v[132:135], v19, s[24:27], s3 offen offset:1024 sc1
  s_waitcnt vmcnt(0)
  v_cndmask_b32 v132, 0, v132, s[4:5]
  v_cndmask_b32 v133, 0, v133, s[4:5]
  v_cndmask_b32 v134, 0, v134, s[4:5]
  v_cndmask_b32 v135, 0, v135, s[4:5]
  v_or3_b32 v3, v129, v131, v133
  v_or_b32 v3, v3, v135
  v_cmp_gt_i32 vcc, 0, v3
  s_nop 4
  s_cbranch_vccnz L_k1_g0
  L_k1_g2:
  v_pk_add_f32 v[128:129], v[128:129], v[132:133]
  v_pk_add_f32 v[130:131], v[130:131], v[134:135]

  v_mov_b32 v132, v128
  v_mov_b32 v133, v129
  v_mov_b32 v134, v130
  v_mov_b32 v135, v131
  s_nop 1
  v_permlane32_swap_b32 v128, v132
  v_permlane32_swap_b32 v129, v133
  v_permlane32_swap_b32 v130, v134
  v_permlane32_swap_b32 v131, v135
  s_nop 1
  v_pk_add_f32 v[128:129], v[128:129], v[132:133]
  v_pk_add_f32 v[130:131], v[130:131], v[134:135]
  v_mov_b32 v132, v128
  v_mov_b32 v133, v129
  v_mov_b32 v134, v130
  v_mov_b32 v135, v131
  s_nop 1
  v_permlane16_swap_b32 v128, v132
  v_permlane16_swap_b32 v129, v133
  v_permlane16_swap_b32 v130, v134
  v_permlane16_swap_b32 v131, v135
  s_nop 1
  v_pk_add_f32 v[128:129], v[128:129], v[132:133]
  v_pk_add_f32 v[130:131], v[130:131], v[134:135]
  s_cbranch_execz L_k1_gm_76
  ds_write_b128 v4, v[128:131]
  ds_read_b64 v[128:129], v252
  s_waitcnt lgkmcnt(0)

L_k1_gm_76:
  v_mul_f32 v128, 0x3a924925, v128
  v_mul_f32 v129, 0x3a924925, v129
  v_fma_f32 v129, -v128, v128, v129
  v_max_f32 v129, 0, v129
  v_cvt_pk_bf16_f32 v130, v128, v129
  v_lshlrev_b32 v236, 16, v130
  v_and_b32 v129, s58, v130
  v_add_f32 v129, 0x3727c5ac, v129
  v_cvt_pk_bf16_f32 v129, v129, v129
  v_and_b32 v129, s58, v129
  v_sqrt_f32 v129, v129
  s_nop 0
  v_cvt_pk_bf16_f32 v129, v129, v129
  v_and_b32 v129, s58, v129
  v_rcp_f32 v238, v129
  s_nop 0
  v_fma_f32 v128, -v129, v238, 1.0
  v_fma_f32 v238, v128, v238, v238
  v_mul_f32 v236, v236, v238
  v_xor_b32 v236, 0x80000000, v236

  v_pk_fma_f32 v[64:65], v[64:65], v[238:239], v[236:237] op_sel_hi:[1,0,0]
  v_pk_fma_f32 v[66:67], v[66:67], v[238:239], v[236:237] op_sel_hi:[1,0,0]
  v_pk_fma_f32 v[68:69], v[68:69], v[238:239], v[236:237] op_sel_hi:[1,0,0]
  v_pk_fma_f32 v[70:71], v[70:71], v[238:239], v[236:237] op_sel_hi:[1,0,0]
  v_cvt_pk_bf16_f32 v32, v64, v65
  v_cvt_pk_bf16_f32 v33, v66, v67
  v_cvt_pk_bf16_f32 v34, v68, v69
  v_cvt_pk_bf16_f32 v35, v70, v71
  s_cbranch_execz L_k1_gm_77
  buffer_store_dwordx4 v[32:35], v19, s[24:27], s47 offen offset:0 sc1
L_k1_gm_77:
  v_pk_fma_f32 v[72:73], v[72:73], v[238:239], v[236:237] op_sel_hi:[1,0,0]
  v_pk_fma_f32 v[74:75], v[74:75], v[238:239], v[236:237] op_sel_hi:[1,0,0]
  v_pk_fma_f32 v[76:77], v[76:77], v[238:239], v[236:237] op_sel_hi:[1,0,0]
  v_pk_fma_f32 v[78:79], v[78:79], v[238:239], v[236:237] op_sel_hi:[1,0,0]
  v_cvt_pk_bf16_f32 v36, v72, v73
  v_cvt_pk_bf16_f32 v37, v74, v75
  v_cvt_pk_bf16_f32 v38, v76, v77
  v_cvt_pk_bf16_f32 v39, v78, v79
  s_cbranch_execz L_k1_gm_78
  buffer_store_dwordx4 v[36:39], v19, s[24:27], s47 offen offset:1024 sc1
L_k1_gm_78:
  v_pk_fma_f32 v[80:81], v[80:81], v[238:239], v[236:237] op_sel_hi:[1,0,0]
  v_pk_fma_f32 v[82:83], v[82:83], v[238:239], v[236:237] op_sel_hi:[1,0,0]
  v_pk_fma_f32 v[84:85], v[84:85], v[238:239], v[236:237] op_sel_hi:[1,0,0]
  v_pk_fma_f32 v[86:87], v[86:87], v[238:239], v[236:237] op_sel_hi:[1,0,0]
  v_cvt_pk_bf16_f32 v40, v80, v81
  v_cvt_pk_bf16_f32 v41, v82, v83
  v_cvt_pk_bf16_f32 v42, v84, v85
  v_cvt_pk_bf16_f32 v43, v86, v87
  s_cbranch_execz L_k1_gm_79
  buffer_store_dwordx4 v[40:43], v19, s[24:27], s47 offen offset:2048 sc1
L_k1_gm_79:
  v_pk_fma_f32 v[88:89], v[88:89], v[238:239], v[236:237] op_sel_hi:[1,0,0]
  v_pk_fma_f32 v[90:91], v[90:91], v[238:239], v[236:237] op_sel_hi:[1,0,0]
  v_pk_fma_f32 v[92:93], v[92:93], v[238:239], v[236:237] op_sel_hi:[1,0,0]
  v_pk_fma_f32 v[94:95], v[94:95], v[238:239], v[236:237] op_sel_hi:[1,0,0]
  v_cvt_pk_bf16_f32 v44, v88, v89
  v_cvt_pk_bf16_f32 v45, v90, v91
  v_cvt_pk_bf16_f32 v46, v92, v93
  v_cvt_pk_bf16_f32 v47, v94, v95
  s_cbranch_execz L_k1_gm_80
  buffer_store_dwordx4 v[44:47], v19, s[24:27], s47 offen offset:3072 sc1
L_k1_gm_80:
  v_pk_fma_f32 v[96:97], v[96:97], v[238:239], v[236:237] op_sel_hi:[1,0,0]
  v_pk_fma_f32 v[98:99], v[98:99], v[238:239], v[236:237] op_sel_hi:[1,0,0]
  v_pk_fma_f32 v[100:101], v[100:101], v[238:239], v[236:237] op_sel_hi:[1,0,0]
  v_pk_fma_f32 v[102:103], v[102:103], v[238:239], v[236:237] op_sel_hi:[1,0,0]
  v_cvt_pk_bf16_f32 v48, v96, v97
  v_cvt_pk_bf16_f32 v49, v98, v99
  v_cvt_pk_bf16_f32 v50, v100, v101
  v_cvt_pk_bf16_f32 v51, v102, v103
  s_cbranch_execz L_k1_gm_81
  buffer_store_dwordx4 v[48:51], v19, s[24:27], s88 offen offset:0 sc1
L_k1_gm_81:
  v_pk_fma_f32 v[104:105], v[104:105], v[238:239], v[236:237] op_sel_hi:[1,0,0]
  v_pk_fma_f32 v[106:107], v[106:107], v[238:239], v[236:237] op_sel_hi:[1,0,0]
  v_pk_fma_f32 v[108:109], v[108:109], v[238:239], v[236:237] op_sel_hi:[1,0,0]
  v_pk_fma_f32 v[110:111], v[110:111], v[238:239], v[236:237] op_sel_hi:[1,0,0]
  v_cvt_pk_bf16_f32 v52, v104, v105
  v_cvt_pk_bf16_f32 v53, v106, v107
  v_cvt_pk_bf16_f32 v54, v108, v109
  v_cvt_pk_bf16_f32 v55, v110, v111
  s_cbranch_execz L_k1_gm_82
  buffer_store_dwordx4 v[52:55], v19, s[24:27], s88 offen offset:1024 sc1
L_k1_gm_82:
  v_pk_fma_f32 v[112:113], v[112:113], v[238:239], v[236:237] op_sel_hi:[1,0,0]
  v_pk_fma_f32 v[114:115], v[114:115], v[238:239], v[236:237] op_sel_hi:[1,0,0]
  v_pk_fma_f32 v[116:117], v[116:117], v[238:239], v[236:237] op_sel_hi:[1,0,0]
  v_pk_fma_f32 v[118:119], v[118:119], v[238:239], v[236:237] op_sel_hi:[1,0,0]
  v_cvt_pk_bf16_f32 v56, v112, v113
  v_cvt_pk_bf16_f32 v57, v114, v115
  v_cvt_pk_bf16_f32 v58, v116, v117
  v_cvt_pk_bf16_f32 v59, v118, v119
  s_cbranch_execz L_k1_gm_83
  buffer_store_dwordx4 v[56:59], v19, s[24:27], s88 offen offset:2048 sc1
L_k1_gm_83:
  v_pk_fma_f32 v[120:121], v[120:121], v[238:239], v[236:237] op_sel_hi:[1,0,0]
  v_pk_fma_f32 v[122:123], v[122:123], v[238:239], v[236:237] op_sel_hi:[1,0,0]
  v_pk_fma_f32 v[124:125], v[124:125], v[238:239], v[236:237] op_sel_hi:[1,0,0]
  v_pk_fma_f32 v[126:127], v[126:127], v[238:239], v[236:237] op_sel_hi:[1,0,0]
  v_cvt_pk_bf16_f32 v60, v120, v121
  v_cvt_pk_bf16_f32 v61, v122, v123
  v_cvt_pk_bf16_f32 v62, v124, v125
  v_cvt_pk_bf16_f32 v63, v126, v127
  s_cbranch_execz L_k1_gm_84
  buffer_store_dwordx4 v[60:63], v19, s[24:27], s88 offen offset:3072 sc1
L_k1_gm_84:
  s_cbranch_execz L_k1_qret
L_k1_fin:
  s_endpgm
L_k1_helper:
  s_waitcnt lgkmcnt(0)
  s_mov_b32 s24, s50
  s_and_b32 s25, s51, 0xffff
  s_mov_b32 s26, 0x1b00000
  s_mov_b32 s27, 0x20000
  s_mov_b32 s28, s10
  s_and_b32 s29, s11, 0xffff
  s_mov_b32 s30, 0x800000
  s_mov_b32 s31, 0x20000
  s_and_b32 s43, s2, 7
  s_lshl_b32 s43, s43, 2
  s_add_u32 s43, s43, s61
  s_lshl_b32 s39, s36, 5
  s_add_u32 s39, s39, s43
  s_cmp_ge_u32 s39, 88
  s_cbranch_scc1 L_k1_htouch
  s_cmp_lt_u32 s39, 32
  s_cselect_b32 s12, s44, s46
  s_cselect_b32 s13, s45, s47
  s_mov_b32 s14, 917504
  s_cmov_b32 s14, 524288
  s_cselect_b32 s43, 0, 32
  s_and_b32 s13, s13, 0xffff
  s_mov_b32 s15, 0x20000
  s_sub_u32 s43, s39, s43
  s_lshl_b32 s43, s43, 14
  s_lshl_b32 s40, s36, 14

  s_add_u32 m0, s40, 0
  s_add_u32 s52, s43, 0
  buffer_load_dwordx4 v19, s[12:15], s52 offen offset:0 lds
  buffer_load_dwordx4 v19, s[12:15], s52 offen offset:1024 lds
  buffer_load_dwordx4 v19, s[12:15], s52 offen offset:2048 lds
  buffer_load_dwordx4 v19, s[12:15], s52 offen offset:3072 lds
  s_add_u32 m0, s40, 4096
  s_add_u32 s52, s43, 4096
  buffer_load_dwordx4 v19, s[12:15], s52 offen offset:0 lds
  buffer_load_dwordx4 v19, s[12:15], s52 offen offset:1024 lds
  buffer_load_dwordx4 v19, s[12:15], s52 offen offset:2048 lds
  buffer_load_dwordx4 v19, s[12:15], s52 offen offset:3072 lds
  s_add_u32 m0, s40, 8192
  s_add_u32 s52, s43, 8192
  buffer_load_dwordx4 v19, s[12:15], s52 offen offset:0 lds
  buffer_load_dwordx4 v19, s[12:15], s52 offen offset:1024 lds
  buffer_load_dwordx4 v19, s[12:15], s52 offen offset:2048 lds
  buffer_load_dwordx4 v19, s[12:15], s52 offen offset:3072 lds
  s_add_u32 m0, s40, 12288
  s_add_u32 s52, s43, 12288
  buffer_load_dwordx4 v19, s[12:15], s52 offen offset:0 lds
  buffer_load_dwordx4 v19, s[12:15], s52 offen offset:1024 lds
  buffer_load_dwordx4 v19, s[12:15], s52 offen offset:2048 lds
  buffer_load_dwordx4 v19, s[12:15], s52 offen offset:3072 lds
  v_lshrrev_b32 v2, 5, v1
  v_bfe_u32 v3, v1, 2, 2
  v_lshl_add_u32 v2, v2, 2, v3
  v_lshlrev_b32 v2, 10, v2
  v_bfe_u32 v3, v1, 4, 1
  v_lshl_add_u32 v2, v3, 5, v2
  v_and_b32 v3, 1, v1
  v_lshl_add_u32 v2, v3, 4, v2
  v_bfe_u32 v3, v1, 1, 1
  v_lshl_add_u32 v2, v3, 3, v2
  v_add_u32 v6, s40, v2
  s_lshl_b32 s43, s39, 10
  s_add_u32 s43, s43, 26214400
  s_waitcnt vmcnt(0)

  ds_read_b64_tr_b16 v[32:33], v6 offset:0
  ds_read_b64_tr_b16 v[34:35], v6 offset:8192
  ds_read_b64_tr_b16 v[36:37], v6 offset:64
  ds_read_b64_tr_b16 v[38:39], v6 offset:8256
  ds_read_b64_tr_b16 v[40:41], v6 offset:128
  ds_read_b64_tr_b16 v[42:43], v6 offset:8320
  ds_read_b64_tr_b16 v[44:45], v6 offset:192
  ds_read_b64_tr_b16 v[46:47], v6 offset:8384
  ds_read_b64_tr_b16 v[48:49], v6 offset:256
  ds_read_b64_tr_b16 v[50:51], v6 offset:8448
  ds_read_b64_tr_b16 v[52:53], v6 offset:320
  ds_read_b64_tr_b16 v[54:55], v6 offset:8512
  ds_read_b64_tr_b16 v[56:57], v6 offset:384
  ds_read_b64_tr_b16 v[58:59], v6 offset:8576
  ds_read_b64_tr_b16 v[60:61], v6 offset:448
  ds_read_b64_tr_b16 v[62:63], v6 offset:8640
  ds_read_b64_tr_b16 v[64:65], v6 offset:512
  ds_read_b64_tr_b16 v[66:67], v6 offset:8704
  ds_read_b64_tr_b16 v[68:69], v6 offset:576
  ds_read_b64_tr_b16 v[70:71], v6 offset:8768
  ds_read_b64_tr_b16 v[72:73], v6 offset:640
  ds_read_b64_tr_b16 v[74:75], v6 offset:8832
  ds_read_b64_tr_b16 v[76:77], v6 offset:704
  ds_read_b64_tr_b16 v[78:79], v6 offset:8896
  ds_read_b64_tr_b16 v[80:81], v6 offset:768
  ds_read_b64_tr_b16 v[82:83], v6 offset:8960
  ds_read_b64_tr_b16 v[84:85], v6 offset:832
  ds_read_b64_tr_b16 v[86:87], v6 offset:9024
  ds_read_b64_tr_b16 v[88:89], v6 offset:896
  ds_read_b64_tr_b16 v[90:91], v6 offset:9088
  ds_read_b64_tr_b16 v[92:93], v6 offset:960
  ds_read_b64_tr_b16 v[94:95], v6 offset:9152
  s_waitcnt lgkmcnt(0)
  buffer_store_dwordx4 v[32:35], v19, s[24:27], s43 offen sc1
  s_add_u32 s43, s43, 90112
  buffer_store_dwordx4 v[36:39], v19, s[24:27], s43 offen sc1
  s_add_u32 s43, s43, 90112
  buffer_store_dwordx4 v[40:43], v19, s[24:27], s43 offen sc1
  s_add_u32 s43, s43, 90112
  buffer_store_dwordx4 v[44:47], v19, s[24:27], s43 offen sc1
  s_add_u32 s43, s43, 90112
  buffer_store_dwordx4 v[48:51], v19, s[24:27], s43 offen sc1
  s_add_u32 s43, s43, 90112
  buffer_store_dwordx4 v[52:55], v19, s[24:27], s43 offen sc1
  s_add_u32 s43, s43, 90112
  buffer_store_dwordx4 v[56:59], v19, s[24:27], s43 offen sc1
  s_add_u32 s43, s43, 90112
  buffer_store_dwordx4 v[60:63], v19, s[24:27], s43 offen sc1
  s_add_u32 s43, s43, 90112
  buffer_store_dwordx4 v[64:67], v19, s[24:27], s43 offen sc1
  s_add_u32 s43, s43, 90112
  buffer_store_dwordx4 v[68:71], v19, s[24:27], s43 offen sc1
  s_add_u32 s43, s43, 90112
  buffer_store_dwordx4 v[72:75], v19, s[24:27], s43 offen sc1
  s_add_u32 s43, s43, 90112
  buffer_store_dwordx4 v[76:79], v19, s[24:27], s43 offen sc1
  s_add_u32 s43, s43, 90112
  buffer_store_dwordx4 v[80:83], v19, s[24:27], s43 offen sc1
  s_add_u32 s43, s43, 90112
  buffer_store_dwordx4 v[84:87], v19, s[24:27], s43 offen sc1
  s_add_u32 s43, s43, 90112
  buffer_store_dwordx4 v[88:91], v19, s[24:27], s43 offen sc1
  s_add_u32 s43, s43, 90112
  buffer_store_dwordx4 v[92:95], v19, s[24:27], s43 offen sc1
  s_add_u32 s43, s43, 90112
L_k1_htouch:
  s_cmp_lg_u32 s36, 7
  s_cbranch_scc1 L_k1_hnc
  s_sub_u32 s43, s2, 224
  s_lshl_b32 s43, s43, 10
  s_add_u32 s43, s43, 25427968
  v_mov_b32 v28, 0
  v_mov_b32 v29, 0
  v_mov_b32 v30, 0
  v_mov_b32 v31, 0
  buffer_store_dwordx4 v[28:31], v19, s[24:27], s43 offen sc1

L_k1_hnc:
  s_sub_u32 s43, s2, 224
  s_lshl_b32 s43, s43, 3
  s_add_u32 s43, s43, s36
  s_lshl_b32 s43, s43, 15
  v_lshlrev_b32 v2, 6, v1

  buffer_load_dword v20, v2, s[28:31], s43 offen
  s_add_u32 s43, s43, 4096
  buffer_load_dword v21, v2, s[28:31], s43 offen
  s_add_u32 s43, s43, 4096
  buffer_load_dword v22, v2, s[28:31], s43 offen
  s_add_u32 s43, s43, 4096
  buffer_load_dword v23, v2, s[28:31], s43 offen
  s_add_u32 s43, s43, 4096
  buffer_load_dword v24, v2, s[28:31], s43 offen
  s_add_u32 s43, s43, 4096
  buffer_load_dword v25, v2, s[28:31], s43 offen
  s_add_u32 s43, s43, 4096
  buffer_load_dword v26, v2, s[28:31], s43 offen
  s_add_u32 s43, s43, 4096
  buffer_load_dword v27, v2, s[28:31], s43 offen
  s_add_u32 s43, s43, 4096
  s_waitcnt vmcnt(0)
L_k1_end:
  s_endpgm
.section .rodata,"a"
.p2align 6
.amdhsa_kernel k1_kernel
  .amdhsa_next_free_vgpr 256
  .amdhsa_next_free_sgpr 102
  .amdhsa_accum_offset 256
  .amdhsa_group_segment_fixed_size 0
  .amdhsa_kernarg_size 88
  .amdhsa_user_sgpr_count 2
  .amdhsa_user_sgpr_kernarg_segment_ptr 1
  .amdhsa_system_sgpr_workgroup_id_x 1
.end_amdhsa_kernel
.text
.globl k2_kernel
.p2align 8
.type k2_kernel,@function
k2_kernel:
  s_cmp_ge_u32 s2, 512
  s_cbranch_scc1 L_k2_end
  s_load_dwordx2 s[4:5], s[0:1], 80
  s_load_dwordx4 s[48:51], s[0:1], 40
  s_load_dwordx2 s[52:53], s[0:1], 72
  s_load_dwordx2 s[44:45], s[0:1], 16
  s_load_dwordx2 s[46:47], s[0:1], 56

  v_lshrrev_b32 v2, 6, v0
  v_and_b32 v1, 63, v0
  s_nop 0
  v_readfirstlane_b32 s24, v2
  s_waitcnt lgkmcnt(0)

  s_mov_b32 s8, s4
  s_and_b32 s9, s5, 0xffff
  s_mov_b32 s10, 0x1b00000
  s_mov_b32 s11, 0x20000
  s_mov_b32 s12, s48
  s_and_b32 s13, s49, 0xffff
  s_mov_b32 s14, 0x800000
  s_mov_b32 s15, 0x20000
  s_mov_b32 s16, s50
  s_and_b32 s17, s51, 0xffff
  s_mov_b32 s18, 0x1000
  s_mov_b32 s19, 0x20000
  s_mov_b32 s20, s52
  s_and_b32 s21, s53, 0xffff
  s_mov_b32 s22, 0x100
  s_mov_b32 s23, 0x20000
  s_cmp_lt_u32 s2, 256
  s_cbranch_scc1 L_k2_attn

  s_cmp_lt_u32 s2, 480
  s_cbranch_scc1 L_k2_sp
  s_sub_u32 s3, s2, 480

  s_sub_u32 s3, s2, 256
  s_branch L_k2_tail
L_k2_sp:
  s_sub_u32 s3, s2, 256
  s_and_b32 s27, s3, 7
  s_lshr_b32 s28, s3, 3
  s_lshr_b32 s25, s27, 1
  s_lshl_b32 s25, s25, 2
  s_and_b32 s26, s28, 3
  s_add_u32 s25, s25, s26
  s_and_b32 s26, s27, 1
  s_mul_i32 s26, s26, 7
  s_lshr_b32 s28, s28, 2
  s_add_u32 s26, s26, s28
  s_and_b32 s29, s24, 1
  s_lshr_b32 s30, s24, 1
  s_mov_b32 s31, 0xffff0000
  v_lshlrev_b32 v5, 4, v1

  v_lshrrev_b32 v2, 3, v1
  v_and_b32 v3, 7, v1
  v_lshrrev_b32 v4, 4, v1
  v_xor_b32 v4, v3, v4
  v_lshlrev_b32 v6, 4, v4
  v_lshl_add_u32 v6, v2, 12, v6
  v_xor_b32 v7, 64, v6
  v_bfe_u32 v4, v1, 4, 1
  v_lshlrev_b32 v4, 2, v4
  v_xor_b32 v4, v3, v4
  v_lshlrev_b32 v4, 9, v4
  v_lshl_add_u32 v8, v2, 4, v4

  v_lshrrev_b32 v2, 5, v1
  v_lshlrev_b32 v2, 6, v2
  v_xor_b32 v8, v2, v5
  v_xor_b32 v9, 0x80, v8

  s_lshl_b32 s32, s25, 7
  s_lshl_b32 s27, s24, 5
  s_add_u32 s32, s32, s27
  s_lshl_b32 s32, s32, 12
  s_mul_i32 s33, s30, 57344
  s_lshl_b32 s27, s26, 12
  s_add_u32 s33, s33, s27
  s_lshl_b32 s27, s29, 11
  s_add_u32 s33, s33, s27
  s_add_u32 s33, s33, 14680064
  s_lshl_b32 s34, s24, 12
  s_lshl_b32 s35, s24, 11
  s_add_u32 s35, s35, 16384

  s_add_u32 m0, s34, 0
  s_nop 0
  buffer_load_dwordx4 v6, s[12:15], s32 offen lds
  s_add_u32 m0, s34, 1024
  s_add_u32 s27, s32, 32768
  buffer_load_dwordx4 v7, s[12:15], s27 offen lds
  s_add_u32 m0, s34, 2048
  s_add_u32 s27, s32, 65536
  buffer_load_dwordx4 v6, s[12:15], s27 offen lds
  s_add_u32 m0, s34, 3072
  s_add_u32 s27, s32, 98304
  buffer_load_dwordx4 v7, s[12:15], s27 offen lds
  s_add_u32 s32, s32, 128
  s_add_u32 m0, s35, 0
  s_add_u32 s27, s33, 1024
  buffer_load_dwordx4 v8, s[8:11], s33 offen  lds
  s_add_u32 m0, s35, 1024
  s_add_u32 s33, s33, 114688
  buffer_load_dwordx4 v9, s[8:11], s27 offen  lds

  s_add_u32 m0, s34, 24576
  s_nop 0
  buffer_load_dwordx4 v6, s[12:15], s32 offen lds
  s_add_u32 m0, s34, 25600
  s_add_u32 s27, s32, 32768
  buffer_load_dwordx4 v7, s[12:15], s27 offen lds
  s_add_u32 m0, s34, 26624
  s_add_u32 s27, s32, 65536
  buffer_load_dwordx4 v6, s[12:15], s27 offen lds
  s_add_u32 m0, s34, 27648
  s_add_u32 s27, s32, 98304
  buffer_load_dwordx4 v7, s[12:15], s27 offen lds
  s_add_u32 s32, s32, 128
  s_add_u32 m0, s35, 24576
  s_add_u32 s27, s33, 1024
  buffer_load_dwordx4 v8, s[8:11], s33 offen  lds
  s_add_u32 m0, s35, 25600
  s_add_u32 s33, s33, 114688
  buffer_load_dwordx4 v9, s[8:11], s27 offen  lds

  v_and_b32 v2, 31, v1
  v_lshrrev_b32 v3, 5, v1
  v_bfe_u32 v4, v1, 1, 3
  v_xor_b32 v4, v4, v3
  s_lshl_b32 s27, s29, 13
  v_lshl_add_u32 v2, v2, 7, s27

  v_xor_b32 v10, 0, v4
  v_lshl_add_u32 v10, v10, 4, v2
  v_xor_b32 v11, 2, v4
  v_lshl_add_u32 v11, v11, 4, v2
  v_xor_b32 v12, 4, v4
  v_lshl_add_u32 v12, v12, 4, v2
  v_xor_b32 v13, 6, v4
  v_lshl_add_u32 v13, v13, 4, v2
  v_bfe_u32 v2, v1, 2, 2
  v_lshl_add_u32 v3, v3, 3, v2
  v_lshlrev_b32 v3, 7, v3
  v_bfe_u32 v4, v1, 4, 1
  v_lshlrev_b32 v4, 1, v4
  v_and_b32 v14, 1, v1
  v_add_u32 v4, v4, v14
  s_lshl_b32 s27, s30, 2
  v_add_u32 v4, s27, v4
  v_bfe_u32 v14, v1, 3, 1
  v_lshlrev_b32 v14, 2, v14
  v_xor_b32 v4, v4, v14
  v_lshl_add_u32 v3, v4, 4, v3
  v_bfe_u32 v4, v1, 1, 1
  v_lshl_add_u32 v3, v4, 3, v3
  v_add_u32 v14, 16384, v3

  v_bfe_u32 v2, v1, 4, 1
  v_lshrrev_b32 v3, 5, v1
  v_xor_b32 v3, v3, v2
  v_lshlrev_b32 v3, 7, v3
  v_lshl_add_u32 v3, v2, 10, v3
  v_and_b32 v2, 1, v1
  v_lshl_add_u32 v3, v2, 9, v3
  v_lshl_add_u32 v3, v2, 6, v3
  v_bfe_u32 v2, v1, 2, 2
  v_lshl_add_u32 v3, v2, 4, v3
  v_bfe_u32 v2, v1, 1, 1
  v_lshl_add_u32 v3, v2, 3, v3
  s_lshl_b32 s27, s30, 11
  s_add_u32 s27, s27, 16384
  v_add_u32 v14, s27, v3
  v_xor_b32 v15, 64, v14

  v_mov_b32 v96, 0
  v_mov_b32 v97, 0
  v_mov_b32 v98, 0
  v_mov_b32 v99, 0
  v_mov_b32 v100, 0
  v_mov_b32 v101, 0
  v_mov_b32 v102, 0
  v_mov_b32 v103, 0
  v_mov_b32 v104, 0
  v_mov_b32 v105, 0
  v_mov_b32 v106, 0
  v_mov_b32 v107, 0
  v_mov_b32 v108, 0
  v_mov_b32 v109, 0
  v_mov_b32 v110, 0
  v_mov_b32 v111, 0
  v_mov_b32 v112, 0
  v_mov_b32 v113, 0
  v_mov_b32 v114, 0
  v_mov_b32 v115, 0
  v_mov_b32 v116, 0
  v_mov_b32 v117, 0
  v_mov_b32 v118, 0
  v_mov_b32 v119, 0
  v_mov_b32 v120, 0
  v_mov_b32 v121, 0
  v_mov_b32 v122, 0
  v_mov_b32 v123, 0
  v_mov_b32 v124, 0
  v_mov_b32 v125, 0
  v_mov_b32 v126, 0
  v_mov_b32 v127, 0
  s_waitcnt vmcnt(6)
  s_barrier
  ds_read_b128 v[64:67], v10 offset:0
  ds_read_b128 v[68:71], v10 offset:4096
  ds_read_b64_tr_b16 v[72:73], v14 offset:0
  ds_read_b64_tr_b16 v[74:75], v15 offset:0
  s_mov_b32 s36, 10
L_sp_loop:
  ds_read_b128 v[76:79], v11 offset:0
  ds_read_b128 v[80:83], v11 offset:4096
  ds_read_b64_tr_b16 v[84:85], v14 offset:256
  ds_read_b64_tr_b16 v[86:87], v15 offset:256
  s_waitcnt lgkmcnt(4)
  v_mfma_f32_32x32x16_bf16 v[96:111], v[72:75], v[64:67], v[96:111]
  s_add_u32 m0, s34, 49152
  s_add_u32 s27, s32, 0
  buffer_load_dwordx4 v6, s[12:15], s27 offen lds
  v_mfma_f32_32x32x16_bf16 v[112:127], v[72:75], v[68:71], v[112:127]
  s_add_u32 m0, s34, 50176
  s_add_u32 s27, s32, 32768
  buffer_load_dwordx4 v7, s[12:15], s27 offen lds
  ds_read_b128 v[64:67], v12 offset:0
  ds_read_b128 v[68:71], v12 offset:4096
  ds_read_b64_tr_b16 v[72:73], v14 offset:4096
  ds_read_b64_tr_b16 v[74:75], v15 offset:4096
  s_waitcnt lgkmcnt(4)
  v_mfma_f32_32x32x16_bf16 v[96:111], v[84:87], v[76:79], v[96:111]
  s_add_u32 m0, s34, 51200
  s_add_u32 s27, s32, 65536
  buffer_load_dwordx4 v6, s[12:15], s27 offen lds
  v_mfma_f32_32x32x16_bf16 v[112:127], v[84:87], v[80:83], v[112:127]
  s_add_u32 m0, s34, 52224
  s_add_u32 s27, s32, 98304
  buffer_load_dwordx4 v7, s[12:15], s27 offen lds
  s_add_u32 s32, s32, 128
  ds_read_b128 v[76:79], v13 offset:0
  ds_read_b128 v[80:83], v13 offset:4096
  ds_read_b64_tr_b16 v[84:85], v14 offset:4352
  ds_read_b64_tr_b16 v[86:87], v15 offset:4352
  s_waitcnt lgkmcnt(4)
  v_mfma_f32_32x32x16_bf16 v[96:111], v[72:75], v[64:67], v[96:111]
  s_add_u32 m0, s35, 49152
  s_add_u32 s27, s33, 0
  buffer_load_dwordx4 v8, s[8:11], s27 offen lds
  v_mfma_f32_32x32x16_bf16 v[112:127], v[72:75], v[68:71], v[112:127]
  s_add_u32 m0, s35, 50176
  s_add_u32 s27, s33, 1024
  buffer_load_dwordx4 v9, s[8:11], s27 offen lds
  s_add_u32 s33, s33, 114688
  s_waitcnt vmcnt(6) lgkmcnt(0)
  s_barrier
  ds_read_b128 v[64:67], v10 offset:24576
  ds_read_b128 v[68:71], v10 offset:28672
  ds_read_b64_tr_b16 v[72:73], v14 offset:24576
  ds_read_b64_tr_b16 v[74:75], v15 offset:24576
  v_mfma_f32_32x32x16_bf16 v[96:111], v[84:87], v[76:79], v[96:111]
  v_mfma_f32_32x32x16_bf16 v[112:127], v[84:87], v[80:83], v[112:127]
  ds_read_b128 v[76:79], v11 offset:24576
  ds_read_b128 v[80:83], v11 offset:28672
  ds_read_b64_tr_b16 v[84:85], v14 offset:24832
  ds_read_b64_tr_b16 v[86:87], v15 offset:24832
  s_waitcnt lgkmcnt(4)
  v_mfma_f32_32x32x16_bf16 v[96:111], v[72:75], v[64:67], v[96:111]
  s_add_u32 m0, s34, 0
  s_add_u32 s27, s32, 0
  buffer_load_dwordx4 v6, s[12:15], s27 offen lds
  v_mfma_f32_32x32x16_bf16 v[112:127], v[72:75], v[68:71], v[112:127]
  s_add_u32 m0, s34, 1024
  s_add_u32 s27, s32, 32768
  buffer_load_dwordx4 v7, s[12:15], s27 offen lds
  ds_read_b128 v[64:67], v12 offset:24576
  ds_read_b128 v[68:71], v12 offset:28672
  ds_read_b64_tr_b16 v[72:73], v14 offset:28672
  ds_read_b64_tr_b16 v[74:75], v15 offset:28672
  s_waitcnt lgkmcnt(4)
  v_mfma_f32_32x32x16_bf16 v[96:111], v[84:87], v[76:79], v[96:111]
  s_add_u32 m0, s34, 2048
  s_add_u32 s27, s32, 65536
  buffer_load_dwordx4 v6, s[12:15], s27 offen lds
  v_mfma_f32_32x32x16_bf16 v[112:127], v[84:87], v[80:83], v[112:127]
  s_add_u32 m0, s34, 3072
  s_add_u32 s27, s32, 98304
  buffer_load_dwordx4 v7, s[12:15], s27 offen lds
  s_add_u32 s32, s32, 128
  ds_read_b128 v[76:79], v13 offset:24576
  ds_read_b128 v[80:83], v13 offset:28672
  ds_read_b64_tr_b16 v[84:85], v14 offset:28928
  ds_read_b64_tr_b16 v[86:87], v15 offset:28928
  s_waitcnt lgkmcnt(4)
  v_mfma_f32_32x32x16_bf16 v[96:111], v[72:75], v[64:67], v[96:111]
  s_add_u32 m0, s35, 0
  s_add_u32 s27, s33, 0
  buffer_load_dwordx4 v8, s[8:11], s27 offen lds
  v_mfma_f32_32x32x16_bf16 v[112:127], v[72:75], v[68:71], v[112:127]
  s_add_u32 m0, s35, 1024
  s_add_u32 s27, s33, 1024
  buffer_load_dwordx4 v9, s[8:11], s27 offen lds
  s_add_u32 s33, s33, 114688
  s_waitcnt vmcnt(6) lgkmcnt(0)
  s_barrier
  ds_read_b128 v[64:67], v10 offset:49152
  ds_read_b128 v[68:71], v10 offset:53248
  ds_read_b64_tr_b16 v[72:73], v14 offset:49152
  ds_read_b64_tr_b16 v[74:75], v15 offset:49152
  v_mfma_f32_32x32x16_bf16 v[96:111], v[84:87], v[76:79], v[96:111]
  v_mfma_f32_32x32x16_bf16 v[112:127], v[84:87], v[80:83], v[112:127]
  ds_read_b128 v[76:79], v11 offset:49152
  ds_read_b128 v[80:83], v11 offset:53248
  ds_read_b64_tr_b16 v[84:85], v14 offset:49408
  ds_read_b64_tr_b16 v[86:87], v15 offset:49408
  s_waitcnt lgkmcnt(4)
  v_mfma_f32_32x32x16_bf16 v[96:111], v[72:75], v[64:67], v[96:111]
  s_add_u32 m0, s34, 24576
  s_add_u32 s27, s32, 0
  buffer_load_dwordx4 v6, s[12:15], s27 offen lds
  v_mfma_f32_32x32x16_bf16 v[112:127], v[72:75], v[68:71], v[112:127]
  s_add_u32 m0, s34, 25600
  s_add_u32 s27, s32, 32768
  buffer_load_dwordx4 v7, s[12:15], s27 offen lds
  ds_read_b128 v[64:67], v12 offset:49152
  ds_read_b128 v[68:71], v12 offset:53248
  ds_read_b64_tr_b16 v[72:73], v14 offset:53248
  ds_read_b64_tr_b16 v[74:75], v15 offset:53248
  s_waitcnt lgkmcnt(4)
  v_mfma_f32_32x32x16_bf16 v[96:111], v[84:87], v[76:79], v[96:111]
  s_add_u32 m0, s34, 26624
  s_add_u32 s27, s32, 65536
  buffer_load_dwordx4 v6, s[12:15], s27 offen lds
  v_mfma_f32_32x32x16_bf16 v[112:127], v[84:87], v[80:83], v[112:127]
  s_add_u32 m0, s34, 27648
  s_add_u32 s27, s32, 98304
  buffer_load_dwordx4 v7, s[12:15], s27 offen lds
  s_add_u32 s32, s32, 128
  ds_read_b128 v[76:79], v13 offset:49152
  ds_read_b128 v[80:83], v13 offset:53248
  ds_read_b64_tr_b16 v[84:85], v14 offset:53504
  ds_read_b64_tr_b16 v[86:87], v15 offset:53504
  s_waitcnt lgkmcnt(4)
  v_mfma_f32_32x32x16_bf16 v[96:111], v[72:75], v[64:67], v[96:111]
  s_add_u32 m0, s35, 24576
  s_add_u32 s27, s33, 0
  buffer_load_dwordx4 v8, s[8:11], s27 offen lds
  v_mfma_f32_32x32x16_bf16 v[112:127], v[72:75], v[68:71], v[112:127]
  s_add_u32 m0, s35, 25600
  s_add_u32 s27, s33, 1024
  buffer_load_dwordx4 v9, s[8:11], s27 offen lds
  s_add_u32 s33, s33, 114688
  s_waitcnt vmcnt(6) lgkmcnt(0)
  s_barrier
  ds_read_b128 v[64:67], v10 offset:0
  ds_read_b128 v[68:71], v10 offset:4096
  ds_read_b64_tr_b16 v[72:73], v14 offset:0
  ds_read_b64_tr_b16 v[74:75], v15 offset:0
  v_mfma_f32_32x32x16_bf16 v[96:111], v[84:87], v[76:79], v[96:111]
  v_mfma_f32_32x32x16_bf16 v[112:127], v[84:87], v[80:83], v[112:127]
  s_sub_u32 s36, s36, 1
  s_cmp_lg_u32 s36, 0
  s_cbranch_scc1 L_sp_loop

  ds_read_b128 v[76:79], v11 offset:0
  ds_read_b128 v[80:83], v11 offset:4096
  ds_read_b64_tr_b16 v[84:85], v14 offset:256
  ds_read_b64_tr_b16 v[86:87], v15 offset:256
  s_waitcnt lgkmcnt(4)
  v_mfma_f32_32x32x16_bf16 v[96:111], v[72:75], v[64:67], v[96:111]
  s_lshl_b32 s37, s25, 2
  s_lshl_b32 s27, s29, 1
  s_add_u32 s37, s37, s27
  s_lshl_b32 s28, s26, 2
  s_lshl_b32 s27, s30, 1
  s_add_u32 s28, s28, s27
  s_lshl_b32 s28, s28, 10
  s_mul_i32 s32, s37, 57344
  s_add_u32 s32, s32, s28
  s_add_u32 s32, s32, 6291456
  s_mul_i32 s33, s37, 90112
  s_add_u32 s33, s33, s28
  s_add_u32 s33, s33, 18907136
  v_and_b32 v2, 31, v1
  v_lshlrev_b32 v2, 1, v2
  s_lshl_b32 s27, s37, 6
  buffer_load_ushort v144, v2, s[16:19], s27 offen
  buffer_load_ushort v145, v2, s[16:19], s27 offen offset:64
  s_add_u32 s27, s32, 57344
  buffer_load_dwordx4 v[128:131], v5, s[8:11], s32 offen
  buffer_load_dwordx4 v[132:135], v5, s[8:11], s32 offen offset:1024
  buffer_load_dwordx4 v[136:139], v5, s[8:11], s27 offen
  buffer_load_dwordx4 v[140:143], v5, s[8:11], s27 offen offset:1024

  v_mfma_f32_32x32x16_bf16 v[112:127], v[72:75], v[68:71], v[112:127]
  ds_read_b128 v[64:67], v12 offset:0
  ds_read_b128 v[68:71], v12 offset:4096
  ds_read_b64_tr_b16 v[72:73], v14 offset:4096
  ds_read_b64_tr_b16 v[74:75], v15 offset:4096
  s_waitcnt lgkmcnt(4)
  v_mfma_f32_32x32x16_bf16 v[96:111], v[84:87], v[76:79], v[96:111]
  v_mfma_f32_32x32x16_bf16 v[112:127], v[84:87], v[80:83], v[112:127]
  ds_read_b128 v[76:79], v13 offset:0
  ds_read_b128 v[80:83], v13 offset:4096
  ds_read_b64_tr_b16 v[84:85], v14 offset:4352
  ds_read_b64_tr_b16 v[86:87], v15 offset:4352
  s_waitcnt lgkmcnt(4)
  v_mfma_f32_32x32x16_bf16 v[96:111], v[72:75], v[64:67], v[96:111]
  v_mfma_f32_32x32x16_bf16 v[112:127], v[72:75], v[68:71], v[112:127]
  s_waitcnt vmcnt(6) lgkmcnt(0)
  s_barrier
  ds_read_b128 v[64:67], v10 offset:24576
  ds_read_b128 v[68:71], v10 offset:28672
  ds_read_b64_tr_b16 v[72:73], v14 offset:24576
  ds_read_b64_tr_b16 v[74:75], v15 offset:24576
  v_mfma_f32_32x32x16_bf16 v[96:111], v[84:87], v[76:79], v[96:111]
  v_mfma_f32_32x32x16_bf16 v[112:127], v[84:87], v[80:83], v[112:127]
  ds_read_b128 v[76:79], v11 offset:24576
  ds_read_b128 v[80:83], v11 offset:28672
  ds_read_b64_tr_b16 v[84:85], v14 offset:24832
  ds_read_b64_tr_b16 v[86:87], v15 offset:24832
  s_waitcnt lgkmcnt(4)
  v_mfma_f32_32x32x16_bf16 v[96:111], v[72:75], v[64:67], v[96:111]
  v_mfma_f32_32x32x16_bf16 v[112:127], v[72:75], v[68:71], v[112:127]
  ds_read_b128 v[64:67], v12 offset:24576
  ds_read_b128 v[68:71], v12 offset:28672
  ds_read_b64_tr_b16 v[72:73], v14 offset:28672
  ds_read_b64_tr_b16 v[74:75], v15 offset:28672
  s_waitcnt lgkmcnt(4)
  v_mfma_f32_32x32x16_bf16 v[96:111], v[84:87], v[76:79], v[96:111]
  v_mfma_f32_32x32x16_bf16 v[112:127], v[84:87], v[80:83], v[112:127]
  ds_read_b128 v[76:79], v13 offset:24576
  ds_read_b128 v[80:83], v13 offset:28672
  ds_read_b64_tr_b16 v[84:85], v14 offset:28928
  ds_read_b64_tr_b16 v[86:87], v15 offset:28928
  s_waitcnt lgkmcnt(4)
  v_mfma_f32_32x32x16_bf16 v[96:111], v[72:75], v[64:67], v[96:111]
  v_mfma_f32_32x32x16_bf16 v[112:127], v[72:75], v[68:71], v[112:127]
  s_waitcnt lgkmcnt(0)
  v_mfma_f32_32x32x16_bf16 v[96:111], v[84:87], v[76:79], v[96:111]
  v_mfma_f32_32x32x16_bf16 v[112:127], v[84:87], v[80:83], v[112:127]
  s_waitcnt vmcnt(0)

  v_lshlrev_b32 v144, 16, v144
  v_lshlrev_b32 v145, 16, v145

  s_nop 15
  v_lshlrev_b32 v52, 16, v128
  v_and_b32 v53, s31, v128
  v_add_f32 v96, v96, v144
  v_add_f32 v97, v97, v144
  v_mul_f32 v96, v96, v52
  v_mul_f32 v97, v97, v53
  v_cvt_pk_bf16_f32 v148, v96, v97

  v_lshlrev_b32 v54, 16, v129
  v_and_b32 v55, s31, v129
  v_add_f32 v98, v98, v144
  v_add_f32 v99, v99, v144
  v_mul_f32 v98, v98, v54
  v_mul_f32 v99, v99, v55
  v_cvt_pk_bf16_f32 v149, v98, v99

  v_lshlrev_b32 v56, 16, v130
  v_and_b32 v57, s31, v130
  v_add_f32 v100, v100, v144
  v_add_f32 v101, v101, v144
  v_mul_f32 v100, v100, v56
  v_mul_f32 v101, v101, v57
  v_cvt_pk_bf16_f32 v150, v100, v101

  v_lshlrev_b32 v58, 16, v131
  v_and_b32 v59, s31, v131
  v_add_f32 v102, v102, v144
  v_add_f32 v103, v103, v144
  v_mul_f32 v102, v102, v58
  v_mul_f32 v103, v103, v59
  v_cvt_pk_bf16_f32 v151, v102, v103

  s_add_u32 s27, s33, 0
  buffer_store_dwordx4 v[148:151], v5, s[8:11], s27 offen offset:0 sc1
  v_lshlrev_b32 v52, 16, v132
  v_and_b32 v53, s31, v132
  v_add_f32 v104, v104, v144
  v_add_f32 v105, v105, v144
  v_mul_f32 v104, v104, v52
  v_mul_f32 v105, v105, v53
  v_cvt_pk_bf16_f32 v152, v104, v105

  v_lshlrev_b32 v54, 16, v133
  v_and_b32 v55, s31, v133
  v_add_f32 v106, v106, v144
  v_add_f32 v107, v107, v144
  v_mul_f32 v106, v106, v54
  v_mul_f32 v107, v107, v55
  v_cvt_pk_bf16_f32 v153, v106, v107

  v_lshlrev_b32 v56, 16, v134
  v_and_b32 v57, s31, v134
  v_add_f32 v108, v108, v144
  v_add_f32 v109, v109, v144
  v_mul_f32 v108, v108, v56
  v_mul_f32 v109, v109, v57
  v_cvt_pk_bf16_f32 v154, v108, v109

  v_lshlrev_b32 v58, 16, v135
  v_and_b32 v59, s31, v135
  v_add_f32 v110, v110, v144
  v_add_f32 v111, v111, v144
  v_mul_f32 v110, v110, v58
  v_mul_f32 v111, v111, v59
  v_cvt_pk_bf16_f32 v155, v110, v111

  s_add_u32 s27, s33, 0
  buffer_store_dwordx4 v[152:155], v5, s[8:11], s27 offen offset:1024 sc1
  v_lshlrev_b32 v52, 16, v136
  v_and_b32 v53, s31, v136
  v_add_f32 v112, v112, v145
  v_add_f32 v113, v113, v145
  v_mul_f32 v112, v112, v52
  v_mul_f32 v113, v113, v53
  v_cvt_pk_bf16_f32 v156, v112, v113

  v_lshlrev_b32 v54, 16, v137
  v_and_b32 v55, s31, v137
  v_add_f32 v114, v114, v145
  v_add_f32 v115, v115, v145
  v_mul_f32 v114, v114, v54
  v_mul_f32 v115, v115, v55
  v_cvt_pk_bf16_f32 v157, v114, v115

  v_lshlrev_b32 v56, 16, v138
  v_and_b32 v57, s31, v138
  v_add_f32 v116, v116, v145
  v_add_f32 v117, v117, v145
  v_mul_f32 v116, v116, v56
  v_mul_f32 v117, v117, v57
  v_cvt_pk_bf16_f32 v158, v116, v117

  v_lshlrev_b32 v58, 16, v139
  v_and_b32 v59, s31, v139
  v_add_f32 v118, v118, v145
  v_add_f32 v119, v119, v145
  v_mul_f32 v118, v118, v58
  v_mul_f32 v119, v119, v59
  v_cvt_pk_bf16_f32 v159, v118, v119

  s_add_u32 s27, s33, 90112
  buffer_store_dwordx4 v[156:159], v5, s[8:11], s27 offen offset:0 sc1
  v_lshlrev_b32 v52, 16, v140
  v_and_b32 v53, s31, v140
  v_add_f32 v120, v120, v145
  v_add_f32 v121, v121, v145
  v_mul_f32 v120, v120, v52
  v_mul_f32 v121, v121, v53
  v_cvt_pk_bf16_f32 v160, v120, v121

  v_lshlrev_b32 v54, 16, v141
  v_and_b32 v55, s31, v141
  v_add_f32 v122, v122, v145
  v_add_f32 v123, v123, v145
  v_mul_f32 v122, v122, v54
  v_mul_f32 v123, v123, v55
  v_cvt_pk_bf16_f32 v161, v122, v123

  v_lshlrev_b32 v56, 16, v142
  v_and_b32 v57, s31, v142
  v_add_f32 v124, v124, v145
  v_add_f32 v125, v125, v145
  v_mul_f32 v124, v124, v56
  v_mul_f32 v125, v125, v57
  v_cvt_pk_bf16_f32 v162, v124, v125

  v_lshlrev_b32 v58, 16, v143
  v_and_b32 v59, s31, v143
  v_add_f32 v126, v126, v145
  v_add_f32 v127, v127, v145
  v_mul_f32 v126, v126, v58
  v_mul_f32 v127, v127, v59
  v_cvt_pk_bf16_f32 v163, v126, v127

  s_add_u32 s27, s33, 90112
  buffer_store_dwordx4 v[160:163], v5, s[8:11], s27 offen offset:1024 sc1
  s_lshl_b32 s27, s25, 1
  s_add_u32 s27, s27, s29
  s_lshl_b32 s27, s27, 2
  s_lshl_b32 s28, s26, 1
  s_add_u32 s28, s28, s30
  s_mul_i32 s28, s28, 37
  s_lshr_b32 s28, s28, 8
  s_add_u32 s27, s27, s28
  s_lshl_b32 s27, s27, 8
  s_add_u32 s27, s27, 25427968
  v_mov_b32 v2, 1
  s_mov_b64 exec, 1

  s_waitcnt vmcnt(0)
  buffer_atomic_add v2, off, s[8:11], s27 sc1
  s_mov_b64 exec, -1

L_k2_tail:
  s_load_dwordx2 s[44:45], s[0:1], 0
  s_load_dwordx2 s[46:47], s[0:1], 64
  s_and_b32 s27, s3, 7
  s_lshr_b32 s28, s3, 3
  s_lshl_b32 s25, s27, 2
  s_lshr_b32 s27, s28, 3
  s_add_u32 s25, s25, s27
  s_and_b32 s26, s28, 7
  v_lshlrev_b32 v4, 4, v1
  v_add_u32 v6, 90112, v4
  s_mul_i32 s27, s24, 14336
  s_add_u32 s27, s27, 32768
  s_mul_i32 s29, s25, 180224
  s_add_u32 s29, s29, s27
  s_add_u32 s29, s29, 18874368
  s_mul_i32 s30, s26, 180224
  s_add_u32 s30, s30, s27
  s_add_u32 s30, s30, 26214400
  s_lshl_b32 s33, s25, 2
  s_add_u32 s33, s33, s24
  s_lshl_b32 s33, s33, 8
  s_add_u32 s33, s33, 25427968
  s_mov_b32 s34, 7
  s_mov_b32 s35, 0
  s_mov_b32 s37, 0xffff0000
  s_and_b32 s27, s24, 1
  s_lshl_b32 s27, s27, 5
  s_lshl_b32 s28, s25, 6
  s_add_u32 s27, s27, s28
  v_and_b32 v2, 31, v1
  v_add_u32 v2, s27, v2
  v_lshlrev_b32 v2, 10, v2
  v_lshrrev_b32 v3, 5, v1
  v_lshl_add_u32 v2, v3, 4, v2
  s_lshr_b32 s27, s24, 1
  s_lshl_b32 s27, s27, 6
  s_lshl_b32 s28, s26, 7
  s_add_u32 s27, s27, s28
  v_add_u32 v5, s27, v2
  s_waitcnt lgkmcnt(0)

  s_mov_b32 s12, s44
  s_and_b32 s13, s45, 0xffff
  s_mov_b32 s14, 0x200000
  s_mov_b32 s15, 0x20000
  s_mov_b32 s16, s46
  s_and_b32 s17, s47, 0xffff
  s_mov_b32 s18, 0x200000
  s_mov_b32 s19, 0x20000
  buffer_load_dwordx4 v[8:11], v5, s[12:15], 0 offen
  buffer_load_dwordx4 v[12:15], v5, s[12:15], 0 offen offset:32
  s_lshl_b32 s27, s24, 12
  v_add_u32 v2, s27, v4
  s_lshl_b32 s27, s24, 14
  v_add_u32 v3, s27, v4

  v_mov_b32 v16, 0
  v_mov_b32 v17, 0
  v_mov_b32 v18, 0
  v_mov_b32 v19, 0
  v_mov_b32 v20, 0
  v_mov_b32 v21, 0
  v_mov_b32 v22, 0
  v_mov_b32 v23, 0
  v_mov_b32 v24, 0
  v_mov_b32 v25, 0
  v_mov_b32 v26, 0
  v_mov_b32 v27, 0
  v_mov_b32 v28, 0
  v_mov_b32 v29, 0
  v_mov_b32 v30, 0
  v_mov_b32 v31, 0
  v_mov_b32 v32, 0
  v_mov_b32 v33, 0
  v_mov_b32 v34, 0
  v_mov_b32 v35, 0
  v_mov_b32 v36, 0
  v_mov_b32 v37, 0
  v_mov_b32 v38, 0
  v_mov_b32 v39, 0
  v_mov_b32 v40, 0
  v_mov_b32 v41, 0
  v_mov_b32 v42, 0
  v_mov_b32 v43, 0
  v_mov_b32 v44, 0
  v_mov_b32 v45, 0
  v_mov_b32 v46, 0
  v_mov_b32 v47, 0
  v_mov_b32 v48, 0
  v_mov_b32 v49, 0
  v_mov_b32 v50, 0
  v_mov_b32 v51, 0
  v_mov_b32 v52, 0
  v_mov_b32 v53, 0
  v_mov_b32 v54, 0
  v_mov_b32 v55, 0
  v_mov_b32 v56, 0
  v_mov_b32 v57, 0
  v_mov_b32 v58, 0
  v_mov_b32 v59, 0
  v_mov_b32 v60, 0
  v_mov_b32 v61, 0
  v_mov_b32 v62, 0
  v_mov_b32 v63, 0
  v_mov_b32 v64, 0
  v_mov_b32 v65, 0
  v_mov_b32 v66, 0
  v_mov_b32 v67, 0
  v_mov_b32 v68, 0
  v_mov_b32 v69, 0
  v_mov_b32 v70, 0
  v_mov_b32 v71, 0
  v_mov_b32 v72, 0
  v_mov_b32 v73, 0
  v_mov_b32 v74, 0
  v_mov_b32 v75, 0
  v_mov_b32 v76, 0
  v_mov_b32 v77, 0
  v_mov_b32 v78, 0
  v_mov_b32 v79, 0
  s_barrier
L_tl_loop:
  s_add_u32 s32, s30, 4096
  s_add_u32 s31, s29, 4096
  s_mov_b32 s36, 0x100000
  buffer_load_dwordx4 v[144:147], v4, s[8:11], s30 offen offset:0
  buffer_load_dwordx4 v[148:151], v6, s[8:11], s30 offen offset:0
  buffer_load_dwordx4 v[152:155], v4, s[8:11], s30 offen offset:1024
  buffer_load_dwordx4 v[156:159], v6, s[8:11], s30 offen offset:1024
  buffer_load_dwordx4 v[160:163], v4, s[8:11], s30 offen offset:2048
  buffer_load_dwordx4 v[164:167], v6, s[8:11], s30 offen offset:2048
  buffer_load_dwordx4 v[168:171], v4, s[8:11], s30 offen offset:3072
  buffer_load_dwordx4 v[172:175], v6, s[8:11], s30 offen offset:3072
  buffer_load_dwordx4 v[176:179], v4, s[8:11], s32 offen offset:0
  buffer_load_dwordx4 v[180:183], v6, s[8:11], s32 offen offset:0
  buffer_load_dwordx4 v[184:187], v4, s[8:11], s32 offen offset:1024
  buffer_load_dwordx4 v[188:191], v6, s[8:11], s32 offen offset:1024
  buffer_load_dwordx4 v[192:195], v4, s[8:11], s32 offen offset:2048
  buffer_load_dwordx4 v[196:199], v6, s[8:11], s32 offen offset:2048
  buffer_load_dwordx4 v[200:203], v4, s[8:11], s32 offen offset:3072
  buffer_load_dwordx4 v[204:207], v6, s[8:11], s32 offen offset:3072
L_tl_poll:
  buffer_load_dword v208, off, s[8:11], s33 sc1
  s_waitcnt vmcnt(0)
  v_readfirstlane_b32 s27, v208
  s_sub_u32 s36, s36, 1
  s_cselect_b32 s28, 64, 0
  s_nop 1
  s_or_b32 s27, s27, s28
  s_cmp_ge_u32 s27, s34
  s_cbranch_scc1 L_tl_go
  s_sleep 16

  s_branch L_tl_poll
L_tl_go:
  s_cmp_lt_u32 s35, 2
  s_cbranch_scc1 L_tl_a7
  buffer_load_dwordx4 v[136:139], v4, s[8:11], s31 offen offset:3072 sc1
  buffer_load_dwordx4 v[140:143], v6, s[8:11], s31 offen offset:3072 sc1
L_tl_a7:
  buffer_load_dwordx4 v[80:83], v4, s[8:11], s29 offen offset:0 sc1
  buffer_load_dwordx4 v[84:87], v6, s[8:11], s29 offen offset:0 sc1
  buffer_load_dwordx4 v[88:91], v4, s[8:11], s29 offen offset:1024 sc1
  buffer_load_dwordx4 v[92:95], v6, s[8:11], s29 offen offset:1024 sc1
  buffer_load_dwordx4 v[96:99], v4, s[8:11], s29 offen offset:2048 sc1
  buffer_load_dwordx4 v[100:103], v6, s[8:11], s29 offen offset:2048 sc1
  buffer_load_dwordx4 v[104:107], v4, s[8:11], s29 offen offset:3072 sc1
  buffer_load_dwordx4 v[108:111], v6, s[8:11], s29 offen offset:3072 sc1
  buffer_load_dwordx4 v[112:115], v4, s[8:11], s31 offen offset:0 sc1
  buffer_load_dwordx4 v[116:119], v6, s[8:11], s31 offen offset:0 sc1
  buffer_load_dwordx4 v[120:123], v4, s[8:11], s31 offen offset:1024 sc1
  buffer_load_dwordx4 v[124:127], v6, s[8:11], s31 offen offset:1024 sc1
  buffer_load_dwordx4 v[128:131], v4, s[8:11], s31 offen offset:2048 sc1
  buffer_load_dwordx4 v[132:135], v6, s[8:11], s31 offen offset:2048 sc1
  s_waitcnt vmcnt(12)
  v_mfma_f32_32x32x16_bf16 v[16:31], v[144:147], v[80:83], v[16:31]
  v_mfma_f32_32x32x16_bf16 v[32:47], v[144:147], v[84:87], v[32:47]
  v_mfma_f32_32x32x16_bf16 v[48:63], v[148:151], v[80:83], v[48:63]
  v_mfma_f32_32x32x16_bf16 v[64:79], v[148:151], v[84:87], v[64:79]
  s_cbranch_scc1 L_tl_m7
  v_mfma_f32_32x32x16_bf16 v[16:31], v[200:203], v[136:139], v[16:31]
  v_mfma_f32_32x32x16_bf16 v[32:47], v[200:203], v[140:143], v[32:47]
  v_mfma_f32_32x32x16_bf16 v[48:63], v[204:207], v[136:139], v[48:63]
  v_mfma_f32_32x32x16_bf16 v[64:79], v[204:207], v[140:143], v[64:79]
L_tl_m7:
  s_waitcnt vmcnt(10)
  v_mfma_f32_32x32x16_bf16 v[16:31], v[152:155], v[88:91], v[16:31]
  v_mfma_f32_32x32x16_bf16 v[32:47], v[152:155], v[92:95], v[32:47]
  v_mfma_f32_32x32x16_bf16 v[48:63], v[156:159], v[88:91], v[48:63]
  v_mfma_f32_32x32x16_bf16 v[64:79], v[156:159], v[92:95], v[64:79]
  s_waitcnt vmcnt(8)
  v_mfma_f32_32x32x16_bf16 v[16:31], v[160:163], v[96:99], v[16:31]
  v_mfma_f32_32x32x16_bf16 v[32:47], v[160:163], v[100:103], v[32:47]
  v_mfma_f32_32x32x16_bf16 v[48:63], v[164:167], v[96:99], v[48:63]
  v_mfma_f32_32x32x16_bf16 v[64:79], v[164:167], v[100:103], v[64:79]
  s_waitcnt vmcnt(6)
  v_mfma_f32_32x32x16_bf16 v[16:31], v[168:171], v[104:107], v[16:31]
  v_mfma_f32_32x32x16_bf16 v[32:47], v[168:171], v[108:111], v[32:47]
  v_mfma_f32_32x32x16_bf16 v[48:63], v[172:175], v[104:107], v[48:63]
  v_mfma_f32_32x32x16_bf16 v[64:79], v[172:175], v[108:111], v[64:79]
  s_waitcnt vmcnt(4)
  v_mfma_f32_32x32x16_bf16 v[16:31], v[176:179], v[112:115], v[16:31]
  v_mfma_f32_32x32x16_bf16 v[32:47], v[176:179], v[116:119], v[32:47]
  v_mfma_f32_32x32x16_bf16 v[48:63], v[180:183], v[112:115], v[48:63]
  v_mfma_f32_32x32x16_bf16 v[64:79], v[180:183], v[116:119], v[64:79]
  s_waitcnt vmcnt(2)
  v_mfma_f32_32x32x16_bf16 v[16:31], v[184:187], v[120:123], v[16:31]
  v_mfma_f32_32x32x16_bf16 v[32:47], v[184:187], v[124:127], v[32:47]
  v_mfma_f32_32x32x16_bf16 v[48:63], v[188:191], v[120:123], v[48:63]
  v_mfma_f32_32x32x16_bf16 v[64:79], v[188:191], v[124:127], v[64:79]
  s_waitcnt vmcnt(0)
  v_mfma_f32_32x32x16_bf16 v[16:31], v[192:195], v[128:131], v[16:31]
  v_mfma_f32_32x32x16_bf16 v[32:47], v[192:195], v[132:135], v[32:47]
  v_mfma_f32_32x32x16_bf16 v[48:63], v[196:199], v[128:131], v[48:63]
  v_mfma_f32_32x32x16_bf16 v[64:79], v[196:199], v[132:135], v[64:79]
  s_cbranch_scc0 L_tl_fin
  s_mul_i32 s27, s24, 6144
  s_add_u32 s27, s27, 39936
  s_sub_u32 s27, 0, s27
  s_cmp_eq_u32 s35, 0
  s_cselect_b32 s27, 7168, s27
  s_cselect_b32 s28, 0, 128
  s_cselect_b32 s34, 7, 8
  s_add_u32 s29, s29, s27
  s_add_u32 s30, s30, s27
  s_add_u32 s33, s33, s28
  s_add_u32 s35, s35, 1

  s_branch L_tl_loop
L_tl_fin:
  s_nop 15
  ds_write_b128 v2, v[16:19] offset:0
  ds_write_b128 v2, v[20:23] offset:1024
  ds_write_b128 v2, v[24:27] offset:2048
  ds_write_b128 v2, v[28:31] offset:3072
  ds_write_b128 v2, v[32:35] offset:16384
  ds_write_b128 v2, v[36:39] offset:17408
  ds_write_b128 v2, v[40:43] offset:18432
  ds_write_b128 v2, v[44:47] offset:19456
  ds_write_b128 v2, v[48:51] offset:32768
  ds_write_b128 v2, v[52:55] offset:33792
  ds_write_b128 v2, v[56:59] offset:34816
  ds_write_b128 v2, v[60:63] offset:35840
  ds_write_b128 v2, v[64:67] offset:49152
  ds_write_b128 v2, v[68:71] offset:50176
  ds_write_b128 v2, v[72:75] offset:51200
  ds_write_b128 v2, v[76:79] offset:52224
  v_lshlrev_b32 v144, 16, v8
  v_and_b32 v145, s37, v8
  v_lshlrev_b32 v146, 16, v9
  v_and_b32 v147, s37, v9
  v_lshlrev_b32 v148, 16, v10
  v_and_b32 v149, s37, v10
  v_lshlrev_b32 v150, 16, v11
  v_and_b32 v151, s37, v11
  v_lshlrev_b32 v152, 16, v12
  v_and_b32 v153, s37, v12
  v_lshlrev_b32 v154, 16, v13
  v_and_b32 v155, s37, v13
  v_lshlrev_b32 v156, 16, v14
  v_and_b32 v157, s37, v14
  v_lshlrev_b32 v158, 16, v15
  v_and_b32 v159, s37, v15
  s_waitcnt lgkmcnt(0)
  s_barrier
  ds_read_b128 v[80:83], v3 offset:0
  ds_read_b128 v[84:87], v3 offset:1024
  ds_read_b128 v[88:91], v3 offset:2048
  ds_read_b128 v[92:95], v3 offset:3072
  ds_read_b128 v[96:99], v3 offset:4096
  ds_read_b128 v[100:103], v3 offset:5120
  ds_read_b128 v[104:107], v3 offset:6144
  ds_read_b128 v[108:111], v3 offset:7168
  ds_read_b128 v[112:115], v3 offset:8192
  ds_read_b128 v[116:119], v3 offset:9216
  ds_read_b128 v[120:123], v3 offset:10240
  ds_read_b128 v[124:127], v3 offset:11264
  ds_read_b128 v[128:131], v3 offset:12288
  ds_read_b128 v[132:135], v3 offset:13312
  ds_read_b128 v[136:139], v3 offset:14336
  ds_read_b128 v[140:143], v3 offset:15360
  s_waitcnt lgkmcnt(8)
  v_add_f32 v80, v80, v96
  v_add_f32 v81, v81, v97
  v_add_f32 v82, v82, v98
  v_add_f32 v83, v83, v99
  v_add_f32 v84, v84, v100
  v_add_f32 v85, v85, v101
  v_add_f32 v86, v86, v102
  v_add_f32 v87, v87, v103
  v_add_f32 v88, v88, v104
  v_add_f32 v89, v89, v105
  v_add_f32 v90, v90, v106
  v_add_f32 v91, v91, v107
  v_add_f32 v92, v92, v108
  v_add_f32 v93, v93, v109
  v_add_f32 v94, v94, v110
  v_add_f32 v95, v95, v111
  s_waitcnt lgkmcnt(0)
  v_add_f32 v112, v112, v128
  v_add_f32 v113, v113, v129
  v_add_f32 v114, v114, v130
  v_add_f32 v115, v115, v131
  v_add_f32 v116, v116, v132
  v_add_f32 v117, v117, v133
  v_add_f32 v118, v118, v134
  v_add_f32 v119, v119, v135
  v_add_f32 v120, v120, v136
  v_add_f32 v121, v121, v137
  v_add_f32 v122, v122, v138
  v_add_f32 v123, v123, v139
  v_add_f32 v124, v124, v140
  v_add_f32 v125, v125, v141
  v_add_f32 v126, v126, v142
  v_add_f32 v127, v127, v143
  v_add_f32 v80, v80, v112
  v_add_f32 v81, v81, v113
  v_add_f32 v82, v82, v114
  v_add_f32 v83, v83, v115
  v_add_f32 v84, v84, v116
  v_add_f32 v85, v85, v117
  v_add_f32 v86, v86, v118
  v_add_f32 v87, v87, v119
  v_add_f32 v88, v88, v120
  v_add_f32 v89, v89, v121
  v_add_f32 v90, v90, v122
  v_add_f32 v91, v91, v123
  v_add_f32 v92, v92, v124
  v_add_f32 v93, v93, v125
  v_add_f32 v94, v94, v126
  v_add_f32 v95, v95, v127
  v_add_f32 v80, v80, v144
  v_add_f32 v81, v81, v145
  v_add_f32 v82, v82, v146
  v_add_f32 v83, v83, v147
  v_add_f32 v84, v84, v148
  v_add_f32 v85, v85, v149
  v_add_f32 v86, v86, v150
  v_add_f32 v87, v87, v151
  v_add_f32 v88, v88, v152
  v_add_f32 v89, v89, v153
  v_add_f32 v90, v90, v154
  v_add_f32 v91, v91, v155
  v_add_f32 v92, v92, v156
  v_add_f32 v93, v93, v157
  v_add_f32 v94, v94, v158
  v_add_f32 v95, v95, v159
  v_cvt_pk_bf16_f32 v112, v80, v81
  v_cvt_pk_bf16_f32 v113, v82, v83
  v_cvt_pk_bf16_f32 v114, v84, v85
  v_cvt_pk_bf16_f32 v115, v86, v87
  v_cvt_pk_bf16_f32 v116, v88, v89
  v_cvt_pk_bf16_f32 v117, v90, v91
  v_cvt_pk_bf16_f32 v118, v92, v93
  v_cvt_pk_bf16_f32 v119, v94, v95
  buffer_store_dwordx4 v[112:115], v5, s[16:19], 0 offen
  buffer_store_dwordx4 v[116:119], v5, s[16:19], 0 offen offset:32

  s_endpgm
L_k2_attn:
  s_and_b32 s27, s2, 7
  s_lshr_b32 s28, s2, 3
  s_lshl_b32 s25, s27, 2
  s_lshr_b32 s27, s28, 3
  s_add_u32 s25, s25, s27
  s_and_b32 s26, s28, 7
  v_lshlrev_b32 v4, 4, v1
  s_lshl_b32 s29, s25, 16
  s_lshl_b32 s30, s24, 11
  s_add_u32 s29, s29, s30
  s_add_u32 s29, s29, 2097152

  s_lshl_b32 s27, s26, 3
  s_lshl_b32 s28, s24, 1
  s_add_u32 s27, s27, s28
  s_mul_i32 s34, s27, 90112
  s_lshl_b32 s27, s27, 10
  s_lshl_b32 s28, s25, 16
  s_add_u32 s27, s27, s28
  buffer_load_dwordx4 v[12:15], v4, s[8:11], s27 offen
  buffer_load_dwordx4 v[16:19], v4, s[8:11], s27 offen offset:1024
  s_lshl_b32 s28, s25, 10
  s_add_u32 s34, s34, s28
  s_add_u32 s34, s34, 18874368

  s_add_u32 m0, s30, 0
  s_add_u32 s27, s29, 2097152
  buffer_load_dwordx4 v4, s[8:11], s29 offen lds
  buffer_load_dwordx4 v4, s[8:11], s29 offen offset:1024 lds
  s_add_u32 m0, m0, 8192
  s_add_u32 s29, s29, 8192
  buffer_load_dwordx4 v4, s[8:11], s27 offen lds
  buffer_load_dwordx4 v4, s[8:11], s27 offen offset:1024 lds

  s_add_u32 m0, s30, 16384
  s_add_u32 s27, s29, 2097152
  buffer_load_dwordx4 v4, s[8:11], s29 offen lds
  buffer_load_dwordx4 v4, s[8:11], s29 offen offset:1024 lds
  s_add_u32 m0, m0, 8192
  s_add_u32 s29, s29, 8192
  buffer_load_dwordx4 v4, s[8:11], s27 offen lds
  buffer_load_dwordx4 v4, s[8:11], s27 offen offset:1024 lds

  s_add_u32 m0, s30, 32768
  s_add_u32 s27, s29, 2097152
  buffer_load_dwordx4 v4, s[8:11], s29 offen lds
  buffer_load_dwordx4 v4, s[8:11], s29 offen offset:1024 lds
  s_add_u32 m0, m0, 8192
  s_add_u32 s29, s29, 8192
  buffer_load_dwordx4 v4, s[8:11], s27 offen lds
  buffer_load_dwordx4 v4, s[8:11], s27 offen offset:1024 lds

  v_lshrrev_b32 v2, 5, v1
  v_and_b32 v3, 15, v1
  v_lshlrev_b32 v3, 4, v3
  v_lshl_add_u32 v5, v2, 8, v3
  s_mov_b32 s36, 0x0000ffff
  s_mov_b32 s37, 0x0000ffff
  v_mov_b32 v6, v4
  v_add_u32 v7, 8192, v5
  s_mov_b32 s27, 0x3f803f80

  v_and_b32 v2, 27, v1
  v_cmp_eq_u32 vcc, 16, v2
  v_mov_b32 v3, s27
  v_cndmask_b32 v3, 0, v3, vcc

  v_mov_b32 v28, v3
  v_mov_b32 v29, v3
  v_mov_b32 v30, v3
  v_mov_b32 v31, v3
  v_mov_b32 v32, v3
  v_mov_b32 v33, v3
  v_mov_b32 v34, v3
  v_mov_b32 v35, v3
  v_mov_b32 v36, v3
  v_mov_b32 v37, v3
  v_mov_b32 v38, v3
  v_mov_b32 v39, v3
  v_mov_b32 v40, v3
  v_mov_b32 v41, v3
  v_mov_b32 v42, v3
  v_mov_b32 v43, v3
  v_mov_b32 v44, 0
  v_mov_b32 v45, 0
  v_mov_b32 v46, 0
  v_mov_b32 v47, 0
  v_mov_b32 v48, 0
  v_mov_b32 v49, 0
  v_mov_b32 v50, 0
  v_mov_b32 v51, 0
  v_mov_b32 v52, 0
  v_mov_b32 v53, 0
  v_mov_b32 v54, 0
  v_mov_b32 v55, 0
  v_mov_b32 v56, 0
  v_mov_b32 v57, 0
  v_mov_b32 v58, 0
  v_mov_b32 v59, 0
  v_mov_b32 v128, 0
  v_mov_b32 v129, 0
  v_mov_b32 v130, 0
  v_mov_b32 v131, 0
  v_mov_b32 v132, 0
  v_mov_b32 v133, 0
  v_mov_b32 v134, 0
  v_mov_b32 v135, 0
  v_mov_b32 v136, 0
  v_mov_b32 v137, 0
  v_mov_b32 v138, 0
  v_mov_b32 v139, 0
  v_mov_b32 v140, 0
  v_mov_b32 v141, 0
  v_mov_b32 v142, 0
  v_mov_b32 v143, 0
  v_mov_b32 v144, 0
  v_mov_b32 v145, 0
  v_mov_b32 v146, 0
  v_mov_b32 v147, 0
  v_mov_b32 v148, 0
  v_mov_b32 v149, 0
  v_mov_b32 v150, 0
  v_mov_b32 v151, 0
  v_mov_b32 v152, 0
  v_mov_b32 v153, 0
  v_mov_b32 v154, 0
  v_mov_b32 v155, 0
  v_mov_b32 v156, 0
  v_mov_b32 v157, 0
  v_mov_b32 v158, 0
  v_mov_b32 v159, 0
  v_add_u32 v8, s30, v4
  s_waitcnt vmcnt(10)
  ds_read_b128 v[20:23], v8
  ds_read_b128 v[24:27], v8 offset:1024
  s_waitcnt lgkmcnt(0)

  v_mfma_f32_32x32x16_bf16 v[160:175], v[20:23], v[12:15], 0
  v_mfma_f32_32x32x16_bf16 v[176:191], v[24:27], v[12:15], 0
  v_mfma_f32_32x32x16_bf16 v[192:207], v[20:23], v[16:19], 0
  v_mfma_f32_32x32x16_bf16 v[208:223], v[24:27], v[16:19], 0
  s_nop 15
  v_max3_f32 v160, v160, v161, v162
  v_max3_f32 v163, v163, v164, v165
  v_max3_f32 v166, v166, v167, v168
  v_max3_f32 v169, v169, v170, v171
  v_max3_f32 v172, v172, v173, v174
  v_max3_f32 v175, v175, v176, v177
  v_max3_f32 v178, v178, v179, v180
  v_max3_f32 v181, v181, v182, v183
  v_max3_f32 v184, v184, v185, v186
  v_max3_f32 v187, v187, v188, v189
  v_max_f32 v190, v190, v191
  v_max3_f32 v160, v160, v163, v166
  v_max3_f32 v169, v169, v172, v175
  v_max3_f32 v178, v178, v181, v184
  v_max_f32 v187, v187, v190
  v_max3_f32 v160, v160, v169, v178
  v_max_f32 v160, v160, v187
  v_mov_b32 v161, v160
  s_nop 1
  v_permlane32_swap_b32 v160, v161
  s_nop 1
  v_max_f32 v160, v160, v161
  v_sub_f32 v160, 0xc2c80000, v160

  v_mov_b32 v96, v160
  v_mov_b32 v97, v160
  v_mov_b32 v98, v160
  v_mov_b32 v99, v160
  v_mov_b32 v100, v160
  v_mov_b32 v101, v160
  v_mov_b32 v102, v160
  v_mov_b32 v103, v160
  v_mov_b32 v104, v160
  v_mov_b32 v105, v160
  v_mov_b32 v106, v160
  v_mov_b32 v107, v160
  v_mov_b32 v108, v160
  v_mov_b32 v109, v160
  v_mov_b32 v110, v160
  v_mov_b32 v111, v160
  s_waitcnt vmcnt(8)
  s_barrier
  ds_read_b128 v[20:23], v6
  s_mov_b64 exec, s[36:37]
  ds_read_b128 v[28:31], v7
  ds_read_b128 v[32:35], v7 offset:512
  s_mov_b64 exec, -1

  v_max3_f32 v192, v192, v193, v194
  v_max3_f32 v195, v195, v196, v197
  v_max3_f32 v198, v198, v199, v200
  v_max3_f32 v201, v201, v202, v203
  v_max3_f32 v204, v204, v205, v206
  v_max3_f32 v207, v207, v208, v209
  v_max3_f32 v210, v210, v211, v212
  v_max3_f32 v213, v213, v214, v215
  v_max3_f32 v216, v216, v217, v218
  v_max3_f32 v219, v219, v220, v221
  v_max_f32 v222, v222, v223
  v_max3_f32 v192, v192, v195, v198
  v_max3_f32 v201, v201, v204, v207
  v_max3_f32 v210, v210, v213, v216
  v_max_f32 v219, v219, v222
  v_max3_f32 v192, v192, v201, v210
  v_max_f32 v192, v192, v219
  v_mov_b32 v193, v192
  s_nop 1
  v_permlane32_swap_b32 v192, v193
  s_nop 1
  v_max_f32 v192, v192, v193
  v_sub_f32 v192, 0xc2c80000, v192

  v_mov_b32 v112, v192
  v_mov_b32 v113, v192
  v_mov_b32 v114, v192
  v_mov_b32 v115, v192
  v_mov_b32 v116, v192
  v_mov_b32 v117, v192
  v_mov_b32 v118, v192
  v_mov_b32 v119, v192
  v_mov_b32 v120, v192
  v_mov_b32 v121, v192
  v_mov_b32 v122, v192
  v_mov_b32 v123, v192
  v_mov_b32 v124, v192
  v_mov_b32 v125, v192
  v_mov_b32 v126, v192
  v_mov_b32 v127, v192
  s_mov_b32 s31, 0
  s_mov_b32 s32, 0
  s_nop 1
  s_waitcnt lgkmcnt(2)

  v_mfma_f32_32x32x16_bf16 v[64:79], v[20:23], v[12:15], v[96:111]
  s_nop 11
  .p2align 7
L_att_loop:
  s_add_u32 s33, s32, 16384
  s_and_b32 s33, s33, 0xffff
  v_add_u32 v8, s33, v4
  s_add_u32 s27, s33, 8192
  v_add_u32 v9, s27, v5

  ds_read_b128 v[24:27], v6 offset:1024
  v_mfma_f32_32x32x16_bf16 v[80:95], v[20:23], v[16:19], v[112:127]
  v_exp_f32 v64, v64
  v_exp_f32 v65, v65
  v_exp_f32 v66, v66
  v_exp_f32 v67, v67
  v_mfma_f32_32x32x16_bf16 v[144:159], v[40:43], v[56:59], v[144:159]
  v_exp_f32 v68, v68
  v_exp_f32 v69, v69
  v_exp_f32 v70, v70
  v_exp_f32 v71, v71
  v_cvt_pk_bf16_f32 v44, v64, v65
  v_cvt_pk_bf16_f32 v45, v66, v67
  v_cvt_pk_bf16_f32 v46, v68, v69
  v_cvt_pk_bf16_f32 v47, v70, v71
  v_exp_f32 v72, v72
  v_exp_f32 v73, v73
  s_waitcnt lgkmcnt(1)
  v_mfma_f32_32x32x16_bf16 v[128:143], v[28:31], v[44:47], v[128:143]
  v_exp_f32 v74, v74
  v_exp_f32 v75, v75
  v_exp_f32 v76, v76
  v_exp_f32 v77, v77
  v_exp_f32 v78, v78
  v_exp_f32 v79, v79
  v_cvt_pk_bf16_f32 v48, v72, v73
  v_cvt_pk_bf16_f32 v49, v74, v75
  v_cvt_pk_bf16_f32 v50, v76, v77
  v_cvt_pk_bf16_f32 v51, v78, v79
  s_waitcnt lgkmcnt(0)
  v_mfma_f32_32x32x16_bf16 v[64:79], v[24:27], v[12:15], v[96:111]
  v_exp_f32 v80, v80
  v_exp_f32 v81, v81
  v_exp_f32 v82, v82
  v_exp_f32 v83, v83
  v_mfma_f32_32x32x16_bf16 v[128:143], v[32:35], v[48:51], v[128:143]
  s_mov_b64 exec, s[36:37]
  ds_read_b128 v[36:39], v7 offset:1024
  ds_read_b128 v[40:43], v7 offset:1536
  s_mov_b64 exec, -1
  v_exp_f32 v84, v84
  v_exp_f32 v85, v85
  v_exp_f32 v86, v86
  v_exp_f32 v87, v87
  v_cvt_pk_bf16_f32 v52, v80, v81
  v_cvt_pk_bf16_f32 v53, v82, v83
  v_cvt_pk_bf16_f32 v54, v84, v85
  v_cvt_pk_bf16_f32 v55, v86, v87
  v_exp_f32 v88, v88
  v_exp_f32 v89, v89
  v_mfma_f32_32x32x16_bf16 v[144:159], v[28:31], v[52:55], v[144:159]
  v_exp_f32 v90, v90
  v_exp_f32 v91, v91
  v_exp_f32 v92, v92
  v_exp_f32 v93, v93
  v_exp_f32 v94, v94
  v_exp_f32 v95, v95
  v_cvt_pk_bf16_f32 v56, v88, v89
  v_cvt_pk_bf16_f32 v57, v90, v91
  v_cvt_pk_bf16_f32 v58, v92, v93
  v_cvt_pk_bf16_f32 v59, v94, v95
  ds_read_b128 v[20:23], v6 offset:2048
  v_mfma_f32_32x32x16_bf16 v[80:95], v[24:27], v[16:19], v[112:127]
  v_exp_f32 v64, v64
  v_exp_f32 v65, v65
  v_exp_f32 v66, v66
  v_exp_f32 v67, v67
  v_mfma_f32_32x32x16_bf16 v[144:159], v[32:35], v[56:59], v[144:159]
  v_exp_f32 v68, v68
  v_exp_f32 v69, v69
  v_exp_f32 v70, v70
  v_exp_f32 v71, v71
  v_cvt_pk_bf16_f32 v44, v64, v65
  v_cvt_pk_bf16_f32 v45, v66, v67
  v_cvt_pk_bf16_f32 v46, v68, v69
  v_cvt_pk_bf16_f32 v47, v70, v71
  v_exp_f32 v72, v72
  v_exp_f32 v73, v73
  s_waitcnt lgkmcnt(1)
  v_mfma_f32_32x32x16_bf16 v[128:143], v[36:39], v[44:47], v[128:143]
  v_exp_f32 v74, v74
  v_exp_f32 v75, v75
  v_exp_f32 v76, v76
  v_exp_f32 v77, v77
  v_exp_f32 v78, v78
  v_exp_f32 v79, v79
  v_cvt_pk_bf16_f32 v48, v72, v73
  v_cvt_pk_bf16_f32 v49, v74, v75
  v_cvt_pk_bf16_f32 v50, v76, v77
  v_cvt_pk_bf16_f32 v51, v78, v79
  s_waitcnt lgkmcnt(0)
  v_mfma_f32_32x32x16_bf16 v[64:79], v[20:23], v[12:15], v[96:111]
  v_exp_f32 v80, v80
  v_exp_f32 v81, v81
  v_exp_f32 v82, v82
  v_exp_f32 v83, v83
  v_mfma_f32_32x32x16_bf16 v[128:143], v[40:43], v[48:51], v[128:143]
  s_mov_b64 exec, s[36:37]
  ds_read_b128 v[28:31], v7 offset:2048
  ds_read_b128 v[32:35], v7 offset:2560
  s_mov_b64 exec, -1
  v_exp_f32 v84, v84
  v_exp_f32 v85, v85
  v_exp_f32 v86, v86
  v_exp_f32 v87, v87
  v_cvt_pk_bf16_f32 v52, v80, v81
  v_cvt_pk_bf16_f32 v53, v82, v83
  v_cvt_pk_bf16_f32 v54, v84, v85
  v_cvt_pk_bf16_f32 v55, v86, v87
  v_exp_f32 v88, v88
  v_exp_f32 v89, v89
  v_mfma_f32_32x32x16_bf16 v[144:159], v[36:39], v[52:55], v[144:159]
  v_exp_f32 v90, v90
  v_exp_f32 v91, v91
  v_exp_f32 v92, v92
  v_exp_f32 v93, v93
  v_exp_f32 v94, v94
  v_exp_f32 v95, v95
  v_cvt_pk_bf16_f32 v56, v88, v89
  v_cvt_pk_bf16_f32 v57, v90, v91
  v_cvt_pk_bf16_f32 v58, v92, v93
  v_cvt_pk_bf16_f32 v59, v94, v95
  ds_read_b128 v[24:27], v6 offset:3072
  v_mfma_f32_32x32x16_bf16 v[80:95], v[20:23], v[16:19], v[112:127]
  v_exp_f32 v64, v64
  v_exp_f32 v65, v65
  v_exp_f32 v66, v66
  v_exp_f32 v67, v67
  v_mfma_f32_32x32x16_bf16 v[144:159], v[40:43], v[56:59], v[144:159]
  v_exp_f32 v68, v68
  v_exp_f32 v69, v69
  v_exp_f32 v70, v70
  v_exp_f32 v71, v71
  v_cvt_pk_bf16_f32 v44, v64, v65
  v_cvt_pk_bf16_f32 v45, v66, v67
  v_cvt_pk_bf16_f32 v46, v68, v69
  v_cvt_pk_bf16_f32 v47, v70, v71
  v_exp_f32 v72, v72
  v_exp_f32 v73, v73
  s_waitcnt lgkmcnt(1)
  v_mfma_f32_32x32x16_bf16 v[128:143], v[28:31], v[44:47], v[128:143]
  v_exp_f32 v74, v74
  v_exp_f32 v75, v75
  v_exp_f32 v76, v76
  v_exp_f32 v77, v77
  v_exp_f32 v78, v78
  v_exp_f32 v79, v79
  v_cvt_pk_bf16_f32 v48, v72, v73
  v_cvt_pk_bf16_f32 v49, v74, v75
  v_cvt_pk_bf16_f32 v50, v76, v77
  v_cvt_pk_bf16_f32 v51, v78, v79
  s_waitcnt lgkmcnt(0)
  v_mfma_f32_32x32x16_bf16 v[64:79], v[24:27], v[12:15], v[96:111]
  v_exp_f32 v80, v80
  v_exp_f32 v81, v81
  v_exp_f32 v82, v82
  v_exp_f32 v83, v83
  v_mfma_f32_32x32x16_bf16 v[128:143], v[32:35], v[48:51], v[128:143]
  s_mov_b64 exec, s[36:37]
  ds_read_b128 v[36:39], v7 offset:3072
  ds_read_b128 v[40:43], v7 offset:3584
  s_mov_b64 exec, -1
  v_exp_f32 v84, v84
  v_exp_f32 v85, v85
  v_exp_f32 v86, v86
  v_exp_f32 v87, v87
  v_cvt_pk_bf16_f32 v52, v80, v81
  v_cvt_pk_bf16_f32 v53, v82, v83
  v_cvt_pk_bf16_f32 v54, v84, v85
  v_cvt_pk_bf16_f32 v55, v86, v87
  v_exp_f32 v88, v88
  v_exp_f32 v89, v89
  v_mfma_f32_32x32x16_bf16 v[144:159], v[28:31], v[52:55], v[144:159]
  v_exp_f32 v90, v90
  v_exp_f32 v91, v91
  v_exp_f32 v92, v92
  v_exp_f32 v93, v93
  v_exp_f32 v94, v94
  v_exp_f32 v95, v95
  v_cvt_pk_bf16_f32 v56, v88, v89
  v_cvt_pk_bf16_f32 v57, v90, v91
  v_cvt_pk_bf16_f32 v58, v92, v93
  v_cvt_pk_bf16_f32 v59, v94, v95
  ds_read_b128 v[20:23], v6 offset:4096
  v_mfma_f32_32x32x16_bf16 v[80:95], v[24:27], v[16:19], v[112:127]
  v_exp_f32 v64, v64
  v_exp_f32 v65, v65
  v_exp_f32 v66, v66
  v_exp_f32 v67, v67
  v_mfma_f32_32x32x16_bf16 v[144:159], v[32:35], v[56:59], v[144:159]
  v_exp_f32 v68, v68
  v_exp_f32 v69, v69
  v_exp_f32 v70, v70
  v_exp_f32 v71, v71
  v_cvt_pk_bf16_f32 v44, v64, v65
  v_cvt_pk_bf16_f32 v45, v66, v67
  v_cvt_pk_bf16_f32 v46, v68, v69
  v_cvt_pk_bf16_f32 v47, v70, v71
  v_exp_f32 v72, v72
  v_exp_f32 v73, v73
  s_waitcnt lgkmcnt(1)
  v_mfma_f32_32x32x16_bf16 v[128:143], v[36:39], v[44:47], v[128:143]
  v_exp_f32 v74, v74
  v_exp_f32 v75, v75
  v_exp_f32 v76, v76
  v_exp_f32 v77, v77
  v_exp_f32 v78, v78
  v_exp_f32 v79, v79
  v_cvt_pk_bf16_f32 v48, v72, v73
  v_cvt_pk_bf16_f32 v49, v74, v75
  v_cvt_pk_bf16_f32 v50, v76, v77
  v_cvt_pk_bf16_f32 v51, v78, v79
  s_waitcnt lgkmcnt(0)
  v_mfma_f32_32x32x16_bf16 v[64:79], v[20:23], v[12:15], v[96:111]
  v_exp_f32 v80, v80
  v_exp_f32 v81, v81
  v_exp_f32 v82, v82
  v_exp_f32 v83, v83
  v_mfma_f32_32x32x16_bf16 v[128:143], v[40:43], v[48:51], v[128:143]
  s_mov_b64 exec, s[36:37]
  ds_read_b128 v[28:31], v7 offset:4096
  ds_read_b128 v[32:35], v7 offset:4608
  s_mov_b64 exec, -1
  v_exp_f32 v84, v84
  v_exp_f32 v85, v85
  v_exp_f32 v86, v86
  v_exp_f32 v87, v87
  v_cvt_pk_bf16_f32 v52, v80, v81
  v_cvt_pk_bf16_f32 v53, v82, v83
  v_cvt_pk_bf16_f32 v54, v84, v85
  v_cvt_pk_bf16_f32 v55, v86, v87
  v_exp_f32 v88, v88
  v_exp_f32 v89, v89
  v_mfma_f32_32x32x16_bf16 v[144:159], v[36:39], v[52:55], v[144:159]
  v_exp_f32 v90, v90
  v_exp_f32 v91, v91
  v_exp_f32 v92, v92
  v_exp_f32 v93, v93
  v_exp_f32 v94, v94
  v_exp_f32 v95, v95
  v_cvt_pk_bf16_f32 v56, v88, v89
  v_cvt_pk_bf16_f32 v57, v90, v91
  v_cvt_pk_bf16_f32 v58, v92, v93
  v_cvt_pk_bf16_f32 v59, v94, v95
  ds_read_b128 v[24:27], v6 offset:5120
  v_mfma_f32_32x32x16_bf16 v[80:95], v[20:23], v[16:19], v[112:127]
  v_exp_f32 v64, v64
  v_exp_f32 v65, v65
  v_exp_f32 v66, v66
  v_exp_f32 v67, v67
  v_mfma_f32_32x32x16_bf16 v[144:159], v[40:43], v[56:59], v[144:159]
  v_exp_f32 v68, v68
  v_exp_f32 v69, v69
  v_exp_f32 v70, v70
  v_exp_f32 v71, v71
  v_cvt_pk_bf16_f32 v44, v64, v65
  v_cvt_pk_bf16_f32 v45, v66, v67
  v_cvt_pk_bf16_f32 v46, v68, v69
  v_cvt_pk_bf16_f32 v47, v70, v71
  v_exp_f32 v72, v72
  v_exp_f32 v73, v73
  s_waitcnt lgkmcnt(1)
  v_mfma_f32_32x32x16_bf16 v[128:143], v[28:31], v[44:47], v[128:143]
  v_exp_f32 v74, v74
  v_exp_f32 v75, v75
  v_exp_f32 v76, v76
  v_exp_f32 v77, v77
  v_exp_f32 v78, v78
  v_exp_f32 v79, v79
  v_cvt_pk_bf16_f32 v48, v72, v73
  v_cvt_pk_bf16_f32 v49, v74, v75
  v_cvt_pk_bf16_f32 v50, v76, v77
  v_cvt_pk_bf16_f32 v51, v78, v79
  s_waitcnt lgkmcnt(0)
  v_mfma_f32_32x32x16_bf16 v[64:79], v[24:27], v[12:15], v[96:111]
  v_exp_f32 v80, v80
  v_exp_f32 v81, v81
  v_exp_f32 v82, v82
  v_exp_f32 v83, v83
  v_mfma_f32_32x32x16_bf16 v[128:143], v[32:35], v[48:51], v[128:143]
  s_mov_b64 exec, s[36:37]
  ds_read_b128 v[36:39], v7 offset:5120
  ds_read_b128 v[40:43], v7 offset:5632
  s_mov_b64 exec, -1
  v_exp_f32 v84, v84
  v_exp_f32 v85, v85
  v_exp_f32 v86, v86
  v_exp_f32 v87, v87
  v_cvt_pk_bf16_f32 v52, v80, v81
  v_cvt_pk_bf16_f32 v53, v82, v83
  v_cvt_pk_bf16_f32 v54, v84, v85
  v_cvt_pk_bf16_f32 v55, v86, v87
  v_exp_f32 v88, v88
  v_exp_f32 v89, v89
  v_mfma_f32_32x32x16_bf16 v[144:159], v[28:31], v[52:55], v[144:159]
  v_exp_f32 v90, v90
  v_exp_f32 v91, v91
  v_exp_f32 v92, v92
  v_exp_f32 v93, v93
  v_exp_f32 v94, v94
  v_exp_f32 v95, v95
  v_cvt_pk_bf16_f32 v56, v88, v89
  v_cvt_pk_bf16_f32 v57, v90, v91
  v_cvt_pk_bf16_f32 v58, v92, v93
  v_cvt_pk_bf16_f32 v59, v94, v95
  ds_read_b128 v[20:23], v6 offset:6144
  v_mfma_f32_32x32x16_bf16 v[80:95], v[24:27], v[16:19], v[112:127]
  v_exp_f32 v64, v64
  v_exp_f32 v65, v65
  v_exp_f32 v66, v66
  v_exp_f32 v67, v67
  v_mfma_f32_32x32x16_bf16 v[144:159], v[32:35], v[56:59], v[144:159]
  v_exp_f32 v68, v68
  v_exp_f32 v69, v69
  v_exp_f32 v70, v70
  v_exp_f32 v71, v71
  v_cvt_pk_bf16_f32 v44, v64, v65
  v_cvt_pk_bf16_f32 v45, v66, v67
  v_cvt_pk_bf16_f32 v46, v68, v69
  v_cvt_pk_bf16_f32 v47, v70, v71
  v_exp_f32 v72, v72
  v_exp_f32 v73, v73
  s_waitcnt lgkmcnt(1)
  v_mfma_f32_32x32x16_bf16 v[128:143], v[36:39], v[44:47], v[128:143]
  v_exp_f32 v74, v74
  v_exp_f32 v75, v75
  v_exp_f32 v76, v76
  v_exp_f32 v77, v77
  v_exp_f32 v78, v78
  v_exp_f32 v79, v79
  v_cvt_pk_bf16_f32 v48, v72, v73
  v_cvt_pk_bf16_f32 v49, v74, v75
  v_cvt_pk_bf16_f32 v50, v76, v77
  v_cvt_pk_bf16_f32 v51, v78, v79
  s_waitcnt lgkmcnt(0)
  v_mfma_f32_32x32x16_bf16 v[64:79], v[20:23], v[12:15], v[96:111]
  v_exp_f32 v80, v80
  v_exp_f32 v81, v81
  v_exp_f32 v82, v82
  v_exp_f32 v83, v83
  v_mfma_f32_32x32x16_bf16 v[128:143], v[40:43], v[48:51], v[128:143]
  s_mov_b64 exec, s[36:37]
  ds_read_b128 v[28:31], v7 offset:6144
  ds_read_b128 v[32:35], v7 offset:6656
  s_mov_b64 exec, -1
  v_exp_f32 v84, v84
  v_exp_f32 v85, v85
  v_exp_f32 v86, v86
  v_exp_f32 v87, v87
  v_cvt_pk_bf16_f32 v52, v80, v81
  v_cvt_pk_bf16_f32 v53, v82, v83
  v_cvt_pk_bf16_f32 v54, v84, v85
  v_cvt_pk_bf16_f32 v55, v86, v87
  v_exp_f32 v88, v88
  v_exp_f32 v89, v89
  v_mfma_f32_32x32x16_bf16 v[144:159], v[36:39], v[52:55], v[144:159]
  v_exp_f32 v90, v90
  v_exp_f32 v91, v91
  v_exp_f32 v92, v92
  v_exp_f32 v93, v93
  v_exp_f32 v94, v94
  v_exp_f32 v95, v95
  v_cvt_pk_bf16_f32 v56, v88, v89
  v_cvt_pk_bf16_f32 v57, v90, v91
  v_cvt_pk_bf16_f32 v58, v92, v93
  v_cvt_pk_bf16_f32 v59, v94, v95
  s_waitcnt vmcnt(4)
  s_cmp_lt_u32 s31, 6
  s_cbranch_scc1 L_att_w_85
  s_waitcnt vmcnt(0)

L_att_w_85:
  s_barrier
  s_cmp_ge_u32 s31, 5
  s_cbranch_scc1 L_att_d_86
  s_add_u32 s28, s32, 49152
  s_and_b32 s28, s28, 0xffff

  s_add_u32 m0, s30, s28
  s_add_u32 s27, s29, 2097152
  buffer_load_dwordx4 v4, s[8:11], s29 offen lds
  buffer_load_dwordx4 v4, s[8:11], s29 offen offset:1024 lds
  s_add_u32 m0, m0, 8192
  s_add_u32 s29, s29, 8192
  buffer_load_dwordx4 v4, s[8:11], s27 offen lds
  buffer_load_dwordx4 v4, s[8:11], s27 offen offset:1024 lds

L_att_d_86:
  ds_read_b128 v[24:27], v6 offset:7168
  v_mfma_f32_32x32x16_bf16 v[80:95], v[20:23], v[16:19], v[112:127]
  v_exp_f32 v64, v64
  v_exp_f32 v65, v65
  v_exp_f32 v66, v66
  v_exp_f32 v67, v67
  v_mfma_f32_32x32x16_bf16 v[144:159], v[40:43], v[56:59], v[144:159]
  v_exp_f32 v68, v68
  v_exp_f32 v69, v69
  v_exp_f32 v70, v70
  v_exp_f32 v71, v71
  v_cvt_pk_bf16_f32 v44, v64, v65
  v_cvt_pk_bf16_f32 v45, v66, v67
  v_cvt_pk_bf16_f32 v46, v68, v69
  v_cvt_pk_bf16_f32 v47, v70, v71
  v_exp_f32 v72, v72
  v_exp_f32 v73, v73
  s_waitcnt lgkmcnt(1)
  v_mfma_f32_32x32x16_bf16 v[128:143], v[28:31], v[44:47], v[128:143]
  v_exp_f32 v74, v74
  v_exp_f32 v75, v75
  v_exp_f32 v76, v76
  v_exp_f32 v77, v77
  v_exp_f32 v78, v78
  v_exp_f32 v79, v79
  v_cvt_pk_bf16_f32 v48, v72, v73
  v_cvt_pk_bf16_f32 v49, v74, v75
  v_cvt_pk_bf16_f32 v50, v76, v77
  v_cvt_pk_bf16_f32 v51, v78, v79
  s_waitcnt lgkmcnt(0)
  v_mfma_f32_32x32x16_bf16 v[64:79], v[24:27], v[12:15], v[96:111]
  v_exp_f32 v80, v80
  v_exp_f32 v81, v81
  v_exp_f32 v82, v82
  v_exp_f32 v83, v83
  v_mfma_f32_32x32x16_bf16 v[128:143], v[32:35], v[48:51], v[128:143]
  s_mov_b64 exec, s[36:37]
  ds_read_b128 v[36:39], v7 offset:7168
  ds_read_b128 v[40:43], v7 offset:7680
  s_mov_b64 exec, -1
  v_exp_f32 v84, v84
  v_exp_f32 v85, v85
  v_exp_f32 v86, v86
  v_exp_f32 v87, v87
  v_cvt_pk_bf16_f32 v52, v80, v81
  v_cvt_pk_bf16_f32 v53, v82, v83
  v_cvt_pk_bf16_f32 v54, v84, v85
  v_cvt_pk_bf16_f32 v55, v86, v87
  v_exp_f32 v88, v88
  v_exp_f32 v89, v89
  v_mfma_f32_32x32x16_bf16 v[144:159], v[28:31], v[52:55], v[144:159]
  v_exp_f32 v90, v90
  v_exp_f32 v91, v91
  v_exp_f32 v92, v92
  v_exp_f32 v93, v93
  v_exp_f32 v94, v94
  v_exp_f32 v95, v95
  v_cvt_pk_bf16_f32 v56, v88, v89
  v_cvt_pk_bf16_f32 v57, v90, v91
  v_cvt_pk_bf16_f32 v58, v92, v93
  v_cvt_pk_bf16_f32 v59, v94, v95
  ds_read_b128 v[20:23], v8
  v_mfma_f32_32x32x16_bf16 v[80:95], v[24:27], v[16:19], v[112:127]
  v_exp_f32 v64, v64
  v_exp_f32 v65, v65
  v_exp_f32 v66, v66
  v_exp_f32 v67, v67
  v_mfma_f32_32x32x16_bf16 v[144:159], v[32:35], v[56:59], v[144:159]
  v_exp_f32 v68, v68
  v_exp_f32 v69, v69
  v_exp_f32 v70, v70
  v_exp_f32 v71, v71
  v_cvt_pk_bf16_f32 v44, v64, v65
  v_cvt_pk_bf16_f32 v45, v66, v67
  v_cvt_pk_bf16_f32 v46, v68, v69
  v_cvt_pk_bf16_f32 v47, v70, v71
  v_exp_f32 v72, v72
  v_exp_f32 v73, v73
  s_waitcnt lgkmcnt(1)
  v_mfma_f32_32x32x16_bf16 v[128:143], v[36:39], v[44:47], v[128:143]
  v_exp_f32 v74, v74
  v_exp_f32 v75, v75
  v_exp_f32 v76, v76
  v_exp_f32 v77, v77
  v_exp_f32 v78, v78
  v_exp_f32 v79, v79
  v_cvt_pk_bf16_f32 v48, v72, v73
  v_cvt_pk_bf16_f32 v49, v74, v75
  v_cvt_pk_bf16_f32 v50, v76, v77
  v_cvt_pk_bf16_f32 v51, v78, v79
  s_waitcnt lgkmcnt(0)
  v_mfma_f32_32x32x16_bf16 v[64:79], v[20:23], v[12:15], v[96:111]
  v_exp_f32 v80, v80
  v_exp_f32 v81, v81
  v_exp_f32 v82, v82
  v_exp_f32 v83, v83
  v_mfma_f32_32x32x16_bf16 v[128:143], v[40:43], v[48:51], v[128:143]
  s_mov_b64 exec, s[36:37]
  ds_read_b128 v[28:31], v9
  ds_read_b128 v[32:35], v9 offset:512
  s_mov_b64 exec, -1
  v_exp_f32 v84, v84
  v_exp_f32 v85, v85
  v_exp_f32 v86, v86
  v_exp_f32 v87, v87
  v_cvt_pk_bf16_f32 v52, v80, v81
  v_cvt_pk_bf16_f32 v53, v82, v83
  v_cvt_pk_bf16_f32 v54, v84, v85
  v_cvt_pk_bf16_f32 v55, v86, v87
  v_exp_f32 v88, v88
  v_exp_f32 v89, v89
  v_mfma_f32_32x32x16_bf16 v[144:159], v[36:39], v[52:55], v[144:159]
  v_exp_f32 v90, v90
  v_exp_f32 v91, v91
  v_exp_f32 v92, v92
  v_exp_f32 v93, v93
  v_exp_f32 v94, v94
  v_exp_f32 v95, v95
  v_cvt_pk_bf16_f32 v56, v88, v89
  v_cvt_pk_bf16_f32 v57, v90, v91
  v_cvt_pk_bf16_f32 v58, v92, v93
  v_cvt_pk_bf16_f32 v59, v94, v95
  v_mov_b32 v6, v8
  v_mov_b32 v7, v9
  s_mov_b32 s32, s33
  s_add_u32 s31, s31, 1
  s_cmp_lt_u32 s31, 8
  s_cbranch_scc1 L_att_loop

  v_mfma_f32_32x32x16_bf16 v[144:159], v[40:43], v[56:59], v[144:159]
  s_setprio 0
  s_waitcnt lgkmcnt(0)
  s_nop 15
  s_nop 3
  s_mov_b32 s46, 0
L_att_fin:
  v_rcp_f32 v137, v136
  s_nop 0
  v_fma_f32 v138, -v136, v137, 1.0
  v_fma_f32 v137, v138, v137, v137
  v_mul_f32 v128, v128, v137
  v_mul_f32 v129, v129, v137
  v_mul_f32 v130, v130, v137
  v_mul_f32 v131, v131, v137
  v_mul_f32 v132, v132, v137
  v_mul_f32 v133, v133, v137
  v_mul_f32 v134, v134, v137
  v_mul_f32 v135, v135, v137
  v_cvt_pk_bf16_f32 v44, v128, v129
  v_cvt_pk_bf16_f32 v45, v130, v131
  v_cvt_pk_bf16_f32 v46, v132, v133
  v_cvt_pk_bf16_f32 v47, v134, v135
  s_add_u32 s27, s34, 0
  buffer_store_dwordx4 v[44:47], v4, s[8:11], s27 offen sc1
  v_rcp_f32 v153, v152
  s_nop 0
  v_fma_f32 v154, -v152, v153, 1.0
  v_fma_f32 v153, v154, v153, v153
  v_mul_f32 v144, v144, v153
  v_mul_f32 v145, v145, v153
  v_mul_f32 v146, v146, v153
  v_mul_f32 v147, v147, v153
  v_mul_f32 v148, v148, v153
  v_mul_f32 v149, v149, v153
  v_mul_f32 v150, v150, v153
  v_mul_f32 v151, v151, v153
  v_cvt_pk_bf16_f32 v48, v144, v145
  v_cvt_pk_bf16_f32 v49, v146, v147
  v_cvt_pk_bf16_f32 v50, v148, v149
  v_cvt_pk_bf16_f32 v51, v150, v151
  s_add_u32 s27, s34, 90112
  buffer_store_dwordx4 v[48:51], v4, s[8:11], s27 offen sc1
  s_cmp_lg_u32 s46, 0
  s_cbranch_scc1 L_att_sig
  s_mov_b32 s46, 1
  s_mov_b32 s38, 0x2ff
  s_mov_b64 s[40:41], 0

  v_cmp_class_f32 s[42:43], v136, s38
  s_or_b64 s[40:41], s[40:41], s[42:43]
  v_cmp_class_f32 s[42:43], v152, s38
  s_or_b64 s[40:41], s[40:41], s[42:43]
  s_mov_b32 s38, 0x207
  v_cmp_class_f32 s[42:43], v128, s38
  s_or_b64 s[40:41], s[40:41], s[42:43]
  v_cmp_class_f32 s[42:43], v129, s38
  s_or_b64 s[40:41], s[40:41], s[42:43]
  v_cmp_class_f32 s[42:43], v130, s38
  s_or_b64 s[40:41], s[40:41], s[42:43]
  v_cmp_class_f32 s[42:43], v131, s38
  s_or_b64 s[40:41], s[40:41], s[42:43]
  v_cmp_class_f32 s[42:43], v132, s38
  s_or_b64 s[40:41], s[40:41], s[42:43]
  v_cmp_class_f32 s[42:43], v133, s38
  s_or_b64 s[40:41], s[40:41], s[42:43]
  v_cmp_class_f32 s[42:43], v134, s38
  s_or_b64 s[40:41], s[40:41], s[42:43]
  v_cmp_class_f32 s[42:43], v135, s38
  s_or_b64 s[40:41], s[40:41], s[42:43]
  v_cmp_class_f32 s[42:43], v144, s38
  s_or_b64 s[40:41], s[40:41], s[42:43]
  v_cmp_class_f32 s[42:43], v145, s38
  s_or_b64 s[40:41], s[40:41], s[42:43]
  v_cmp_class_f32 s[42:43], v146, s38
  s_or_b64 s[40:41], s[40:41], s[42:43]
  v_cmp_class_f32 s[42:43], v147, s38
  s_or_b64 s[40:41], s[40:41], s[42:43]
  v_cmp_class_f32 s[42:43], v148, s38
  s_or_b64 s[40:41], s[40:41], s[42:43]
  v_cmp_class_f32 s[42:43], v149, s38
  s_or_b64 s[40:41], s[40:41], s[42:43]
  v_cmp_class_f32 s[42:43], v150, s38
  s_or_b64 s[40:41], s[40:41], s[42:43]
  v_cmp_class_f32 s[42:43], v151, s38
  s_or_b64 s[40:41], s[40:41], s[42:43]
  s_cmp_lg_u64 s[40:41], 0
  s_cbranch_scc1 L_att_fallback

L_att_sig:
  s_lshl_b32 s27, s26, 2
  s_add_u32 s27, s27, s24
  s_lshl_b32 s27, s27, 2
  s_lshr_b32 s28, s25, 3
  s_add_u32 s27, s27, s28
  s_lshl_b32 s27, s27, 8
  s_add_u32 s27, s27, 25428096
  v_mov_b32 v2, 1
  s_mov_b64 exec, 1
  s_waitcnt vmcnt(0)
  buffer_atomic_add v2, off, s[8:11], s27 sc1
  s_mov_b64 exec, -1

  s_endpgm
L_att_fallback:
  s_waitcnt vmcnt(0)
  s_lshl_b32 s29, s25, 16
  s_add_u32 s29, s29, 2097152
  s_mov_b32 s31, 0
  v_mov_b32 v160, 0xff61b1e6
  v_mov_b32 v161, 0xff61b1e6

  v_mov_b32 v128, 0
  v_mov_b32 v129, 0
  v_mov_b32 v130, 0
  v_mov_b32 v131, 0
  v_mov_b32 v132, 0
  v_mov_b32 v133, 0
  v_mov_b32 v134, 0
  v_mov_b32 v135, 0
  v_mov_b32 v136, 0
  v_mov_b32 v137, 0
  v_mov_b32 v138, 0
  v_mov_b32 v139, 0
  v_mov_b32 v140, 0
  v_mov_b32 v141, 0
  v_mov_b32 v142, 0
  v_mov_b32 v143, 0
  v_mov_b32 v144, 0
  v_mov_b32 v145, 0
  v_mov_b32 v146, 0
  v_mov_b32 v147, 0
  v_mov_b32 v148, 0
  v_mov_b32 v149, 0
  v_mov_b32 v150, 0
  v_mov_b32 v151, 0
  v_mov_b32 v152, 0
  v_mov_b32 v153, 0
  v_mov_b32 v154, 0
  v_mov_b32 v155, 0
  v_mov_b32 v156, 0
  v_mov_b32 v157, 0
  v_mov_b32 v158, 0
  v_mov_b32 v159, 0
L_att_fbloop:
  s_add_u32 s27, s29, 2097152
  buffer_load_dwordx4 v[20:23], v4, s[8:11], s29 offen
  s_mov_b64 exec, s[36:37]
  buffer_load_dwordx4 v[28:31], v5, s[8:11], s27 offen
  buffer_load_dwordx4 v[32:35], v5, s[8:11], s27 offen offset:512
  s_mov_b64 exec, -1
  s_waitcnt vmcnt(0)

  v_mfma_f32_32x32x16_bf16 v[64:79], v[20:23], v[12:15], 0
  s_nop 15
  s_nop 3
  v_max3_f32 v164, v64, v65, v66
  v_max3_f32 v164, v164, v67, v68
  v_max3_f32 v164, v164, v69, v70
  v_max3_f32 v164, v164, v71, v72
  v_max3_f32 v164, v164, v73, v74
  v_max3_f32 v164, v164, v75, v76
  v_max3_f32 v164, v164, v77, v78
  v_max3_f32 v164, v164, v79, v160
  v_mov_b32 v165, v164
  s_nop 1
  v_permlane32_swap_b32 v164, v165
  s_nop 1
  v_max_f32 v164, v164, v165
  v_sub_f32 v162, v160, v164
  v_exp_f32 v162, v162
  v_mov_b32 v160, v164

  v_mul_f32 v128, v128, v162
  v_mul_f32 v129, v129, v162
  v_mul_f32 v130, v130, v162
  v_mul_f32 v131, v131, v162
  v_mul_f32 v132, v132, v162
  v_mul_f32 v133, v133, v162
  v_mul_f32 v134, v134, v162
  v_mul_f32 v135, v135, v162
  v_mul_f32 v136, v136, v162
  v_mul_f32 v137, v137, v162
  v_mul_f32 v138, v138, v162
  v_mul_f32 v139, v139, v162
  v_mul_f32 v140, v140, v162
  v_mul_f32 v141, v141, v162
  v_mul_f32 v142, v142, v162
  v_mul_f32 v143, v143, v162
  v_sub_f32 v64, v64, v164
  v_sub_f32 v65, v65, v164
  v_sub_f32 v66, v66, v164
  v_sub_f32 v67, v67, v164
  v_sub_f32 v68, v68, v164
  v_sub_f32 v69, v69, v164
  v_sub_f32 v70, v70, v164
  v_sub_f32 v71, v71, v164
  v_sub_f32 v72, v72, v164
  v_sub_f32 v73, v73, v164
  v_sub_f32 v74, v74, v164
  v_sub_f32 v75, v75, v164
  v_sub_f32 v76, v76, v164
  v_sub_f32 v77, v77, v164
  v_sub_f32 v78, v78, v164
  v_sub_f32 v79, v79, v164
  v_exp_f32 v64, v64
  v_exp_f32 v65, v65
  v_exp_f32 v66, v66
  v_exp_f32 v67, v67
  v_exp_f32 v68, v68
  v_exp_f32 v69, v69
  v_exp_f32 v70, v70
  v_exp_f32 v71, v71
  v_exp_f32 v72, v72
  v_exp_f32 v73, v73
  v_exp_f32 v74, v74
  v_exp_f32 v75, v75
  v_exp_f32 v76, v76
  v_exp_f32 v77, v77
  v_exp_f32 v78, v78
  v_exp_f32 v79, v79
  s_nop 0
  v_cvt_pk_bf16_f32 v44, v64, v65
  v_cvt_pk_bf16_f32 v45, v66, v67
  v_cvt_pk_bf16_f32 v46, v68, v69
  v_cvt_pk_bf16_f32 v47, v70, v71
  v_cvt_pk_bf16_f32 v48, v72, v73
  v_cvt_pk_bf16_f32 v49, v74, v75
  v_cvt_pk_bf16_f32 v50, v76, v77
  v_cvt_pk_bf16_f32 v51, v78, v79
  s_nop 1
  v_mfma_f32_32x32x16_bf16 v[128:143], v[28:31], v[44:47], v[128:143]
  v_mfma_f32_32x32x16_bf16 v[128:143], v[32:35], v[48:51], v[128:143]
  s_nop 15
  s_nop 3
  v_mfma_f32_32x32x16_bf16 v[80:95], v[20:23], v[16:19], 0
  s_nop 15
  s_nop 3
  v_max3_f32 v164, v80, v81, v82
  v_max3_f32 v164, v164, v83, v84
  v_max3_f32 v164, v164, v85, v86
  v_max3_f32 v164, v164, v87, v88
  v_max3_f32 v164, v164, v89, v90
  v_max3_f32 v164, v164, v91, v92
  v_max3_f32 v164, v164, v93, v94
  v_max3_f32 v164, v164, v95, v161
  v_mov_b32 v165, v164
  s_nop 1
  v_permlane32_swap_b32 v164, v165
  s_nop 1
  v_max_f32 v164, v164, v165
  v_sub_f32 v162, v161, v164
  v_exp_f32 v162, v162
  v_mov_b32 v161, v164

  v_mul_f32 v144, v144, v162
  v_mul_f32 v145, v145, v162
  v_mul_f32 v146, v146, v162
  v_mul_f32 v147, v147, v162
  v_mul_f32 v148, v148, v162
  v_mul_f32 v149, v149, v162
  v_mul_f32 v150, v150, v162
  v_mul_f32 v151, v151, v162
  v_mul_f32 v152, v152, v162
  v_mul_f32 v153, v153, v162
  v_mul_f32 v154, v154, v162
  v_mul_f32 v155, v155, v162
  v_mul_f32 v156, v156, v162
  v_mul_f32 v157, v157, v162
  v_mul_f32 v158, v158, v162
  v_mul_f32 v159, v159, v162
  v_sub_f32 v80, v80, v164
  v_sub_f32 v81, v81, v164
  v_sub_f32 v82, v82, v164
  v_sub_f32 v83, v83, v164
  v_sub_f32 v84, v84, v164
  v_sub_f32 v85, v85, v164
  v_sub_f32 v86, v86, v164
  v_sub_f32 v87, v87, v164
  v_sub_f32 v88, v88, v164
  v_sub_f32 v89, v89, v164
  v_sub_f32 v90, v90, v164
  v_sub_f32 v91, v91, v164
  v_sub_f32 v92, v92, v164
  v_sub_f32 v93, v93, v164
  v_sub_f32 v94, v94, v164
  v_sub_f32 v95, v95, v164
  v_exp_f32 v80, v80
  v_exp_f32 v81, v81
  v_exp_f32 v82, v82
  v_exp_f32 v83, v83
  v_exp_f32 v84, v84
  v_exp_f32 v85, v85
  v_exp_f32 v86, v86
  v_exp_f32 v87, v87
  v_exp_f32 v88, v88
  v_exp_f32 v89, v89
  v_exp_f32 v90, v90
  v_exp_f32 v91, v91
  v_exp_f32 v92, v92
  v_exp_f32 v93, v93
  v_exp_f32 v94, v94
  v_exp_f32 v95, v95
  s_nop 0
  v_cvt_pk_bf16_f32 v44, v80, v81
  v_cvt_pk_bf16_f32 v45, v82, v83
  v_cvt_pk_bf16_f32 v46, v84, v85
  v_cvt_pk_bf16_f32 v47, v86, v87
  v_cvt_pk_bf16_f32 v48, v88, v89
  v_cvt_pk_bf16_f32 v49, v90, v91
  v_cvt_pk_bf16_f32 v50, v92, v93
  v_cvt_pk_bf16_f32 v51, v94, v95
  s_nop 1
  v_mfma_f32_32x32x16_bf16 v[144:159], v[28:31], v[44:47], v[144:159]
  v_mfma_f32_32x32x16_bf16 v[144:159], v[32:35], v[48:51], v[144:159]
  s_nop 15
  s_nop 3
  s_add_u32 s29, s29, 1024
  s_add_u32 s31, s31, 1
  s_cmp_lt_u32 s31, 64
  s_cbranch_scc1 L_att_fbloop
  s_branch L_att_fin

L_k2_end:
  s_endpgm
.section .rodata,"a"
.p2align 6
.amdhsa_kernel k2_kernel
  .amdhsa_next_free_vgpr 256
  .amdhsa_next_free_sgpr 102
  .amdhsa_accum_offset 256
  .amdhsa_group_segment_fixed_size 0
  .amdhsa_kernarg_size 88
  .amdhsa_user_sgpr_count 2
  .amdhsa_user_sgpr_kernarg_segment_ptr 1
  .amdhsa_system_sgpr_workgroup_id_x 1
.end_amdhsa_kernel
```
